```python
import torch

def _softmax(x, axis=-1):
    return torch.softmax(x, dim=axis)
def _gelu(x):
    return torch.nn.functional.gelu(x, approximate="tanh")
def _silu(x):
    return torch.nn.functional.silu(x)
def _sigmoid(x):
    return torch.sigmoid(x)
def _layernorm(x, axis=-1, eps=1e-5):
    m = x.mean(dim=axis, keepdim=True)
    v = x.var(dim=axis, keepdim=True, unbiased=False)
    return (x - m) / torch.sqrt(v + eps)
def _scatter_add(tgt, idx, src, axis=0):
    return tgt.clone().index_add_(axis, idx, src)
def _segment_sum(src, seg, n):
    out = torch.zeros((n,) + src.shape[1:], dtype=src.dtype)
    return out.index_add_(0, seg, src)
def _pad(x, pw):
    flat = tuple(v for pair in reversed(pw) for v in pair)
    return torch.nn.functional.pad(x, flat)

kernel_name = 'concat_heads__ssm_conv_s4__ssm_conv_h3__prompt'

def setup_inputs():

    _w = (lambda a: (lambda t: t.to(torch.bfloat16) if t.is_floating_point() else t)(torch.as_tensor(a)))
    def _A_setup():
        B, L, D, N = 1, 2048, 1024, 128
        A_re = -(lambda _x: torch.exp(torch.as_tensor(_x)))((lambda *s: torch.randn(*s, dtype=torch.bfloat16) * 3.2)(D, N))
        A_im = torch.pi * (lambda *s: torch.randn(*s, dtype=torch.bfloat16) * 0.05)(D, N)
        B_re = (lambda *s: torch.randn(*s, dtype=torch.bfloat16) * 0.1)(D, N)
        B_im = (lambda *s: torch.randn(*s, dtype=torch.bfloat16) * 0.1)(D, N)
        C_re = (lambda *s: torch.randn(*s, dtype=torch.bfloat16) * 0.1)(D, N)
        C_im = (lambda *s: torch.randn(*s, dtype=torch.bfloat16) * 0.1)(D, N)
        log_dt = (lambda *s: torch.randn(*s, dtype=torch.bfloat16) * 0.05)(D) * 0.5 - 4.0
        Dskip = (lambda *s: torch.randn(*s, dtype=torch.bfloat16) * 0.05)(D)
        return {
            "u": _w((lambda *s: torch.randn(*s, dtype=torch.bfloat16) * 0.05)(B, L, D)),
            "A_re": _w(A_re),
            "A_im": _w(A_im),
            "B_re": _w(B_re),
            "B_im": _w(B_im),
            "C_re": _w(C_re),
            "C_im": _w(C_im),
            "log_dt": _w(log_dt),
            "Dskip": _w(Dskip),
        }
    _A_in = _A_setup()

    def _B_setup():
        B, S, D = 1, 2048, 1024
        ks = 4
        return {
            "q": _w((lambda *s: torch.randn(*s, dtype=torch.bfloat16) * 0.05)(B, S, D)),
            "k": _w((lambda *s: torch.randn(*s, dtype=torch.bfloat16) * 0.2)(B, S, D)),
            "v": _w((lambda *s: torch.randn(*s, dtype=torch.bfloat16) * 0.2)(B, S, D)),
            "shift_k": _w((lambda *s: torch.randn(*s, dtype=torch.bfloat16) * 0.2)(D, ks) * 0.5),
            "ssm_k": _w((lambda *s: torch.randn(*s, dtype=torch.bfloat16) * 0.8)(D, S) * (1.0 / S ** 0.5)),
            "ssm_D": _w((lambda *s: torch.randn(*s, dtype=torch.bfloat16) * 0.2)(D)),
        }
    _B_in = _B_setup()

    return {
        "A_u": _A_in["u"],
        "A_A_re": _A_in["A_re"],
        "A_A_im": _A_in["A_im"],
        "A_B_re": _A_in["B_re"],
        "A_B_im": _A_in["B_im"],
        "A_C_re": _A_in["C_re"],
        "A_C_im": _A_in["C_im"],
        "A_log_dt": _A_in["log_dt"],
        "A_Dskip": _A_in["Dskip"],
        "B_q": _B_in["q"],
        "B_k": _B_in["k"],
        "B_v": _B_in["v"],
        "B_shift_k": _B_in["shift_k"],
        "B_ssm_k": _B_in["ssm_k"],
        "B_ssm_D": _B_in["ssm_D"],
    }

def reference(A_u, A_A_re, A_A_im, A_B_re, A_B_im, A_C_re, A_C_im, A_log_dt, A_Dskip, B_q, B_k, B_v, B_shift_k, B_ssm_k, B_ssm_D):
    def _A_ref(u, A_re, A_im, B_re, B_im, C_re, C_im, log_dt, Dskip):
        Bsz, L, D = u.shape
        dt = torch.exp(log_dt)[:, None]
        A = A_re + 1j * A_im
        Bc = B_re + 1j * B_im
        Cc = C_re + 1j * C_im
        logdA = dt * A
        dB = dt * Bc
        l = (lambda x, dt: x.to(dt))(torch.arange(L), A_re.dtype)
        P = torch.exp(logdA[:, :, None] * l[None, None, :])
        K = torch.einsum("dn,dnl,dn->dl", Cc, P, dB).real
        L2 = 2 * L
        Kp = _pad(K, ((0, 0), (0, L)))
        up = (lambda x, *d: x.permute(*d))(u, 0, 2, 1)
        up = _pad(up, ((0, 0), (0, 0), (0, L)))
        Kf = (lambda x, axes=(-2,-1): torch.fft.rfft2(x.float(), dim=axes))(Kp[:, None, :], axes=(-2, -1))
        Uf = (lambda x, axes=(-2,-1): torch.fft.rfft2(x.float(), dim=axes))(up[:, :, None, :], axes=(-2, -1))
        Yf = Uf * Kf[None, :, :, :]
        y = (lambda x, s, axes=(-2,-1): torch.fft.irfft2(x, s=s, dim=axes).to(torch.bfloat16))(Yf, (1, L2), axes=(-2, -1))[:, :, 0, :L]
        y = (lambda x, *d: x.permute(*d))(y, 0, 2, 1) + u * Dskip[None, None, :]
        return y

    def _B_ref(q, k, v, shift_k, ssm_k, ssm_D):
        B, S, D = q.shape
        ks = shift_k.shape[-1]
        k_pad = _pad(k, ((0, 0), (ks - 1, 0), (0, 0)))
        k_shift = torch.zeros_like(k)
        for t in range(ks):
            k_shift = k_shift + k_pad[:, t:t + S, :] * shift_k[:, ks - 1 - t][None, None, :]
        kv = k_shift * v
        L = 2 * S
        kv_pad = _pad(kv, ((0, 0), (0, S), (0, 0)))
        kf_pad = _pad(ssm_k, ((0, 0), (0, S)))
        kv_f = (lambda x, axes=(-2,-1): torch.fft.rfft2(x.float(), dim=axes))(kv_pad[:, None, :, :], axes=(1, 2))
        kf_f = (lambda x, axes=(-2,-1): torch.fft.rfft2(x.float(), dim=axes))(kf_pad[:, None, :], axes=(1, 2))
        kf_f = (lambda x, *d: x.permute(*d))(kf_f, 1, 2, 0)
        y_f = kv_f * kf_f[None, :, :, :]
        y = (lambda x, s, axes=(-2,-1): torch.fft.irfft2(x, s=s, dim=axes).to(torch.bfloat16))(y_f, (1, L), axes=(1, 2))[:, 0, :S, :]
        y = y + kv * ssm_D[None, None, :]
        return q * y

    a = _A_ref(A_u, A_A_re, A_A_im, A_B_re, A_B_im, A_C_re, A_C_im, A_log_dt, A_Dskip)
    b = _B_ref(B_q, B_k, B_v, B_shift_k, B_ssm_k, B_ssm_D)
    return torch.concatenate([a, b], axis=-1)
```

```asm
; @launch grid=(256,1,1) block=(512,1,1) lds=157600
.amdgcn_target "amdgcn-amd-amdhsa--gfx950"
.text
.globl concat_heads__ssm_conv_s4__ssm_conv_h3__prompt_kernel
.p2align 8
.type concat_heads__ssm_conv_s4__ssm_conv_h3__prompt_kernel,@function
concat_heads__ssm_conv_s4__ssm_conv_h3__prompt_kernel:
    s_cmp_ge_u32 s2, 256
    s_cbranch_scc1 L_exit
    s_load_dwordx16 s[16:31], s[0:1], 0
    s_load_dwordx16 s[32:47], s[0:1], 64
    s_getpc_b64 s[6:7]
    s_lshr_b32 s86, s2, 3
    v_and_b32 v2, 0x1e0, v0
    v_add_lshl_u32 v2, v2, s86, 7
    v_min_u32 v2, L_hot_end-concat_heads__ssm_conv_s4__ssm_conv_h3__prompt_kernel-64, v2
    global_load_dword v4, v2, s[6:7]
    v_lshrrev_b32 v1, 6, v0
    v_and_b32 v0, 63, v0
    v_readfirstlane_b32 s83, v1
    v_mov_b32 v3, 157568
    v_lshl_add_u32 v6, v1, 2, v3
    v_mov_b32 v3, 0
    ds_write_b32 v6, v3
    s_and_b32 s5, s2, 7
    s_lshl_b32 s86, s5, 4
    s_bfe_u32 s87, s2, 0x40003
    s_add_u32 s84, s86, s87
    s_lshl_b32 s85, s84, 3
    s_add_u32 s85, s85, s83
    s_and_b32 s3, s83, 3
    s_cmp_ge_u32 s2, 128
    s_cbranch_scc1 L_B
    v_lshlrev_b32 v1, 2, v0
    v_lshl_add_u32 v1, s85, 8, v1
    s_lshl_b32 s86, s85, 1
    s_and_b32 s86, s86, -4
    s_waitcnt lgkmcnt(0)
    global_load_dword v60, v1, s[18:19]
    global_load_dword v61, v1, s[20:21]
    s_load_dword s12, s[30:31], s86
    s_load_dword s13, s[32:33], s86
    global_load_dword v62, v1, s[22:23]
    global_load_dword v63, v1, s[24:25]
    global_load_dword v64, v1, s[26:27]
    global_load_dword v65, v1, s[28:29]
    s_cmp_lt_u32 s83, 4
    s_cbranch_scc1 L_AM_body
    s_branch L_AH_body
L_B:
    s_cmp_ge_u32 s83, 4
    s_cbranch_scc1 L_BH
    s_bfe_u32 s4, s2, 0x40003
    s_lshl_b32 s4, s4, 2
    s_add_u32 s4, s4, s3
    s_lshl_b32 s87, s5, 8
    s_lshl_b32 s86, s4, 14
    s_add_u32 s86, s86, s87
    v_lshrrev_b32 v12, 3, v0
    v_lshlrev_b32 v12, 11, v12
    v_and_b32 v13, 4, v0
    v_lshl_add_u32 v12, v13, 5, v12
    v_add_u32 v20, s86, v12
    s_waitcnt lgkmcnt(0)
    global_load_dword v4, v20, s[36:37]
    s_branch L_BM_body
L_BH:
    s_movk_i32 s72, 4096
    s_movk_i32 s73, 8192
    s_movk_i32 s74, 12288
    s_mul_i32 s86, s3, 0x60
    s_and_b32 s87, s86, 0x20
    s_lshl_b32 s86, s3, 6
    s_and_b32 s86, s86, 0x80
    s_or_b32 s86, s86, s87
    v_and_b32 v1, 32, v0
    v_add3_u32 v15, v1, v0, s86
    v_lshrrev_b32 v1, 2, v15
    v_lshlrev_b32 v16, 14, v1
    v_and_b32 v2, 3, v0
    v_lshl_add_u32 v16, v2, 2, v16
    v_lshl_add_u32 v16, s84, 4, v16
    v_lshlrev_b32 v2, 4, v2
    s_lshl_b32 s87, s84, 6
    v_add_u32 v2, s87, v2
    s_mov_b32 s50, 0x400000
    s_mov_b32 s51, 0x20000
    s_mov_b32 s54, 0x400000
    s_mov_b32 s55, 0x20000
    s_waitcnt lgkmcnt(0)
    s_mov_b64 s[48:49], s[36:37]
    s_mov_b64 s[52:53], s[38:39]
    global_load_dwordx4 v[144:147], v2, s[40:41]
    buffer_load_dword v39, v16, s[48:51], 0 offen
    buffer_load_dword v40, v16, s[48:51], 0 offen offset:2048
    buffer_load_dword v41, v16, s[48:51], s72 offen
    buffer_load_dword v42, v16, s[48:51], s72 offen offset:2048
    s_branch L_BH_body
L_start_end:
L_BH_body:
    s_barrier
    s_mov_b32 s90, 0xffff0000
    s_mul_i32 s91, s83, 9120
    s_lshl_b32 s86, s83, 2
    s_and_b32 s86, s86, 16
    s_sub_u32 s86, 157584, s86
    v_mov_b32 v5, s86
    s_mov_b32 s75, 0x100000
    s_mov_b32 s76, 0x200000
    s_mov_b32 s77, 0x300000
    s_mov_b32 s78, 0x400000
    s_mov_b32 s79, 0x600000
    v_add_u32 v17, s75, v16
    v_add_u32 v18, s76, v16
    v_add_u32 v19, s77, v16
    v_subrev_u32 v20, 6144, v16
    v_subrev_u32 v21, 6144, v17
    v_subrev_u32 v22, 6144, v18
    v_subrev_u32 v23, 6144, v19
    v_and_b32 v20, 0x0fffffff, v20
    v_and_b32 v3, 12, v0
    v_lshl_add_u32 v20, v3, 26, v20
    v_lshl_add_u32 v21, v3, 26, v21
    v_lshl_add_u32 v22, v3, 26, v22
    v_lshl_add_u32 v23, v3, 26, v23
    s_mov_b32 s58, 0x400000
    s_mov_b32 s59, 0x20000
    s_mov_b32 s62, 0x800000
    s_mov_b32 s63, 0x20000
    s_mov_b64 s[56:57], s[34:35]
    s_mov_b64 s[60:61], s[46:47]
    v_and_b32 v2, 3, v0
    v_mul_u32_u24 v7, 16804, v2
    v_lshlrev_b32 v3, 2, v15
    v_sub_u32 v7, v7, v3
    v_add_u32 v7, 73968, v7
    v_and_b32 v3, 1, v0
    v_lshl_add_u32 v8, v3, 3, v7
    v_add_u32 v8, 4220, v8
    v_add_u32 v9, 8400, v8
    v_lshl_add_u32 v15, s3, 6, v0
    s_mul_i32 s86, s3, 0x90
    s_and_b32 s86, s86, 0xa0
    v_and_b32 v1, 32, v0
    v_add3_u32 v1, v1, v0, s86
    s_lshl_b32 s87, s84, 4
    v_lshl_add_u32 v24, v1, 11, s87
    v_add_u32 v25, 0x80000, v24
    s_add_u32 s87, s87, 2048
    v_lshl_add_u32 v26, v1, 12, s87
    v_add_u32 v27, s75, v26
    v_and_b32 v3, 0xf0, v15
    v_lshlrev_b32 v3, 1, v3
    v_lshl_add_u32 v3, v2, 3, v3
    v_bfe_u32 v1, v0, 2, 2
    s_movk_i32 s86, 1088
    v_mad_u32_u24 v10, v1, s86, v3
    v_add_u32 v10, 140160, v10
    s_movk_i32 s86, 8400
    v_mad_u32_u24 v11, v1, s86, v3
    v_add_u32 v11, 76032, v11
    v_lshlrev_b32 v252, 4, v0
    v_lshl_add_u32 v253, s85, 12, v252
    s_lshl_b32 s86, s85, 1
    v_lshlrev_b32 v254, 12, v0
    v_add_u32 v254, s86, v254
    s_mov_b32 s66, 0x400000
    s_mov_b32 s67, 0x20000
    s_mov_b32 s70, 0x800
    s_mov_b32 s71, 0x20000
    s_mov_b64 s[64:65], s[42:43]
    s_mov_b64 s[68:69], s[44:45]
    v_add_u32 v252, s91, v252
    v_mov_b32 v228, 0
    v_mov_b32 v229, 0
    v_mov_b32 v230, 0
    v_mov_b32 v231, 0
    v_mov_b32 v244, 0
    v_and_b32 v1, 31, v0
    v_min_u32 v1, 27, v1
    v_lshlrev_b32 v1, 4, v1
    v_lshrrev_b32 v3, 5, v0
    v_mul_u32_u24 v3, 4576, v3
    v_add3_u32 v1, v1, v3, s91
    ds_write_b128 v1, v[228:231]
    buffer_load_dword v43, v16, s[48:51], s73 offen
    buffer_load_dword v44, v16, s[48:51], s73 offen offset:2048
    buffer_load_dword v45, v16, s[48:51], s74 offen
    buffer_load_dword v46, v16, s[48:51], s74 offen offset:2048
    buffer_load_dword v36, v20, s[48:51], 0 offen
    buffer_load_dword v37, v20, s[48:51], 0 offen offset:2048
    buffer_load_dword v38, v20, s[48:51], s72 offen
    buffer_load_dword v47, v16, s[52:55], 0 offen
    buffer_load_dword v48, v16, s[52:55], 0 offen offset:2048
    buffer_load_dword v49, v16, s[52:55], s72 offen
    buffer_load_dword v50, v16, s[52:55], s72 offen offset:2048
    buffer_load_dword v51, v16, s[52:55], s73 offen
    buffer_load_dword v52, v16, s[52:55], s73 offen offset:2048
    buffer_load_dword v53, v16, s[52:55], s74 offen
    buffer_load_dword v54, v16, s[52:55], s74 offen offset:2048
    s_waitcnt vmcnt(19)
    v_lshlrev_b32 v28, 16, v144
    v_and_b32 v30, s90, v144
    v_lshlrev_b32 v32, 16, v145
    v_and_b32 v34, s90, v145
    v_lshlrev_b32 v29, 16, v146
    v_and_b32 v31, s90, v146
    v_lshlrev_b32 v33, 16, v147
    v_and_b32 v35, s90, v147
    s_waitcnt vmcnt(8)
    s_setprio 2
    v_mov_b32_dpp v36, v44 row_shr:4 row_mask:0xf bank_mask:0xf
    v_mov_b32_dpp v37, v45 row_shr:4 row_mask:0xf bank_mask:0xf
    v_mov_b32_dpp v38, v46 row_shr:4 row_mask:0xf bank_mask:0xf
    v_lshlrev_b32 v172, 16, v36
    v_and_b32 v173, s90, v36
    v_lshlrev_b32 v174, 16, v37
    v_and_b32 v175, s90, v37
    v_lshlrev_b32 v176, 16, v38
    v_and_b32 v177, s90, v38
    v_lshlrev_b32 v178, 16, v39
    v_and_b32 v179, s90, v39
    v_lshlrev_b32 v180, 16, v40
    v_and_b32 v181, s90, v40
    v_lshlrev_b32 v182, 16, v41
    v_and_b32 v183, s90, v41
    v_lshlrev_b32 v184, 16, v42
    v_and_b32 v185, s90, v42
    v_lshlrev_b32 v186, 16, v43
    v_and_b32 v187, s90, v43
    v_lshlrev_b32 v188, 16, v44
    v_and_b32 v189, s90, v44
    v_lshlrev_b32 v190, 16, v45
    v_and_b32 v191, s90, v45
    v_lshlrev_b32 v192, 16, v46
    v_and_b32 v193, s90, v46
    v_pk_mul_f32 v[196:197], v[172:173], v[34:35]
    v_pk_mul_f32 v[198:199], v[174:175], v[34:35]
    v_pk_mul_f32 v[200:201], v[176:177], v[34:35]
    v_pk_mul_f32 v[202:203], v[178:179], v[34:35]
    v_pk_mul_f32 v[204:205], v[180:181], v[34:35]
    v_pk_mul_f32 v[206:207], v[182:183], v[34:35]
    v_pk_mul_f32 v[208:209], v[184:185], v[34:35]
    v_pk_mul_f32 v[210:211], v[186:187], v[34:35]
    v_pk_fma_f32 v[196:197], v[174:175], v[32:33], v[196:197]
    v_pk_fma_f32 v[198:199], v[176:177], v[32:33], v[198:199]
    v_pk_fma_f32 v[200:201], v[178:179], v[32:33], v[200:201]
    v_pk_fma_f32 v[202:203], v[180:181], v[32:33], v[202:203]
    v_pk_fma_f32 v[204:205], v[182:183], v[32:33], v[204:205]
    v_pk_fma_f32 v[206:207], v[184:185], v[32:33], v[206:207]
    v_pk_fma_f32 v[208:209], v[186:187], v[32:33], v[208:209]
    v_pk_fma_f32 v[210:211], v[188:189], v[32:33], v[210:211]
    v_pk_fma_f32 v[196:197], v[176:177], v[30:31], v[196:197]
    v_pk_fma_f32 v[198:199], v[178:179], v[30:31], v[198:199]
    v_pk_fma_f32 v[200:201], v[180:181], v[30:31], v[200:201]
    v_pk_fma_f32 v[202:203], v[182:183], v[30:31], v[202:203]
    v_pk_fma_f32 v[204:205], v[184:185], v[30:31], v[204:205]
    v_pk_fma_f32 v[206:207], v[186:187], v[30:31], v[206:207]
    v_pk_fma_f32 v[208:209], v[188:189], v[30:31], v[208:209]
    v_pk_fma_f32 v[210:211], v[190:191], v[30:31], v[210:211]
    v_pk_fma_f32 v[196:197], v[178:179], v[28:29], v[196:197]
    v_pk_fma_f32 v[198:199], v[180:181], v[28:29], v[198:199]
    v_pk_fma_f32 v[200:201], v[182:183], v[28:29], v[200:201]
    v_pk_fma_f32 v[202:203], v[184:185], v[28:29], v[202:203]
    v_pk_fma_f32 v[204:205], v[186:187], v[28:29], v[204:205]
    v_pk_fma_f32 v[206:207], v[188:189], v[28:29], v[206:207]
    v_pk_fma_f32 v[208:209], v[190:191], v[28:29], v[208:209]
    v_pk_fma_f32 v[210:211], v[192:193], v[28:29], v[210:211]
    buffer_load_dword v58, v17, s[48:51], 0 offen
    buffer_load_dword v59, v17, s[48:51], 0 offen offset:2048
    s_waitcnt vmcnt(2)
    v_lshlrev_b32 v172, 16, v47
    v_and_b32 v173, s90, v47
    v_lshlrev_b32 v174, 16, v48
    v_and_b32 v175, s90, v48
    v_lshlrev_b32 v176, 16, v49
    v_and_b32 v177, s90, v49
    v_lshlrev_b32 v178, 16, v50
    v_and_b32 v179, s90, v50
    v_lshlrev_b32 v180, 16, v51
    v_and_b32 v181, s90, v51
    v_lshlrev_b32 v182, 16, v52
    v_and_b32 v183, s90, v52
    v_lshlrev_b32 v184, 16, v53
    v_and_b32 v185, s90, v53
    v_lshlrev_b32 v186, 16, v54
    v_and_b32 v187, s90, v54
    v_pk_mul_f32 v[196:197], v[196:197], v[172:173]
    v_pk_mul_f32 v[198:199], v[198:199], v[174:175]
    v_pk_mul_f32 v[200:201], v[200:201], v[176:177]
    v_pk_mul_f32 v[202:203], v[202:203], v[178:179]
    v_pk_mul_f32 v[204:205], v[204:205], v[180:181]
    v_pk_mul_f32 v[206:207], v[206:207], v[182:183]
    v_pk_mul_f32 v[208:209], v[208:209], v[184:185]
    v_pk_mul_f32 v[210:211], v[210:211], v[186:187]
    v_cvt_pk_bf16_f32 v164, v210, v208
    v_cvt_pk_bf16_f32 v165, v206, v204
    v_cvt_pk_bf16_f32 v166, v202, v200
    v_cvt_pk_bf16_f32 v167, v198, v196
    v_add_u32 v1, 3072, v8
    ds_write_b128 v7, v[164:167] offset:3072
    ds_write2_b32 v1, v164, v165 offset0:0 offset1:1
    ds_write2_b32 v1, v166, v167 offset0:2 offset1:3
    v_cvt_pk_bf16_f32 v168, v211, v209
    v_cvt_pk_bf16_f32 v169, v207, v205
    v_cvt_pk_bf16_f32 v170, v203, v201
    v_cvt_pk_bf16_f32 v171, v199, v197
    v_add_u32 v2, 3072, v9
    ds_write_b128 v7, v[168:171] offset:11472
    ds_write2_b32 v2, v168, v169 offset0:0 offset1:1
    ds_write2_b32 v2, v170, v171 offset0:2 offset1:3
    v_mov_b32 v3, 1
    ds_write_b32 v6, v3
    buffer_load_dword v60, v17, s[48:51], s72 offen
    buffer_load_dword v61, v17, s[48:51], s72 offen offset:2048
    buffer_load_dword v62, v17, s[48:51], s73 offen
    buffer_load_dword v63, v17, s[48:51], s73 offen offset:2048
    buffer_load_dword v64, v17, s[48:51], s74 offen
    buffer_load_dword v65, v17, s[48:51], s74 offen offset:2048
    buffer_load_dword v55, v21, s[48:51], 0 offen
    buffer_load_dword v56, v21, s[48:51], 0 offen offset:2048
    buffer_load_dword v57, v21, s[48:51], s72 offen
    buffer_load_dword v66, v17, s[52:55], 0 offen
    buffer_load_dword v67, v17, s[52:55], 0 offen offset:2048
    buffer_load_dword v68, v17, s[52:55], s72 offen
    buffer_load_dwordx4 v[212:215], v253, s[64:67], 0 offen offset:0
    buffer_load_dwordx4 v[216:219], v253, s[64:67], 0 offen offset:1024
    buffer_load_dwordx4 v[220:223], v253, s[64:67], 0 offen offset:2048
    buffer_load_dwordx4 v[224:227], v253, s[64:67], 0 offen offset:3072
    buffer_load_ushort v248, v254, s[68:71], 0 offen offset:0
    buffer_load_dword v69, v17, s[52:55], s72 offen offset:2048
    buffer_load_dword v70, v17, s[52:55], s73 offen
    buffer_load_dword v71, v17, s[52:55], s73 offen offset:2048
    buffer_load_dword v72, v17, s[52:55], s74 offen
    buffer_load_dword v73, v17, s[52:55], s74 offen offset:2048
    s_waitcnt vmcnt(5)
    v_mov_b32_dpp v245, v215 wave_ror:1 row_mask:0xf bank_mask:0xf
    v_mov_b32_dpp v246, v219 wave_ror:1 row_mask:0xf bank_mask:0xf
    v_mov_b32_dpp v247, v223 wave_ror:1 row_mask:0xf bank_mask:0xf
    v_lshlrev_b32 v248, 16, v248
    v_lshlrev_b32 v249, 16, v212
    v_mov_b32_dpp v244, v215 wave_shr:1 row_mask:0xf bank_mask:0xf
    v_mov_b32_dpp v245, v219 wave_shr:1 row_mask:0xf bank_mask:0xf
    v_mov_b32_dpp v246, v223 wave_shr:1 row_mask:0xf bank_mask:0xf
    v_mov_b32_dpp v247, v227 wave_shr:1 row_mask:0xf bank_mask:0xf
    v_and_b32 v250, s90, v212
    v_add_f32 v249, v249, v248
    v_cvt_pk_bf16_f32 v212, v249, v250
    ds_write_b128 v252, v[212:215] offset:448
    v_alignbit_b32 v228, v212, v244, 16
    v_alignbit_b32 v229, v213, v212, 16
    v_alignbit_b32 v230, v214, v213, 16
    v_alignbit_b32 v231, v215, v214, 16
    ds_write_b128 v252, v[228:231] offset:5024
    ds_write_b128 v252, v[216:219] offset:1472
    v_alignbit_b32 v232, v216, v245, 16
    v_alignbit_b32 v233, v217, v216, 16
    v_alignbit_b32 v234, v218, v217, 16
    v_alignbit_b32 v235, v219, v218, 16
    ds_write_b128 v252, v[232:235] offset:6048
    ds_write_b128 v252, v[220:223] offset:2496
    v_alignbit_b32 v236, v220, v246, 16
    v_alignbit_b32 v237, v221, v220, 16
    v_alignbit_b32 v238, v222, v221, 16
    v_alignbit_b32 v239, v223, v222, 16
    ds_write_b128 v252, v[236:239] offset:7072
    ds_write_b128 v252, v[224:227] offset:3520
    v_alignbit_b32 v240, v224, v247, 16
    v_alignbit_b32 v241, v225, v224, 16
    v_alignbit_b32 v242, v226, v225, 16
    v_alignbit_b32 v243, v227, v226, 16
    ds_write_b128 v252, v[240:243] offset:8096
    v_mov_b32 v3, 2
    ds_write_b32 v6, v3
    s_and_b32 s87, s84, 1
    s_cmp_gt_u32 s87, 0
    s_cbranch_scc1 L_rot41
    buffer_load_dwordx4 v[112:115], v24, s[56:59], 0 offen
L_rot41:
    buffer_load_dwordx4 v[116:119], v25, s[56:59], 0 offen
    s_cmp_le_u32 s87, 0
    s_cbranch_scc1 L_rot42
    buffer_load_dwordx4 v[112:115], v24, s[56:59], 0 offen
L_rot42:
    s_waitcnt vmcnt(2)
    v_mov_b32_dpp v55, v63 row_shr:4 row_mask:0xf bank_mask:0xf
    v_mov_b32_dpp v56, v64 row_shr:4 row_mask:0xf bank_mask:0xf
    v_mov_b32_dpp v57, v65 row_shr:4 row_mask:0xf bank_mask:0xf
    v_lshlrev_b32 v144, 16, v55
    v_lshlrev_b32 v145, 16, v56
    v_lshlrev_b32 v146, 16, v57
    v_lshlrev_b32 v147, 16, v58
    v_lshlrev_b32 v148, 16, v59
    v_lshlrev_b32 v149, 16, v60
    v_lshlrev_b32 v150, 16, v61
    v_lshlrev_b32 v151, 16, v62
    v_lshlrev_b32 v152, 16, v63
    v_lshlrev_b32 v153, 16, v64
    v_lshlrev_b32 v154, 16, v65
    v_mul_f32 v156, v144, v34
    v_mul_f32 v157, v145, v34
    v_mul_f32 v158, v146, v34
    v_mul_f32 v159, v147, v34
    v_mul_f32 v160, v148, v34
    v_mul_f32 v161, v149, v34
    v_mul_f32 v162, v150, v34
    v_mul_f32 v163, v151, v34
    v_fmac_f32 v156, v145, v32
    v_fmac_f32 v157, v146, v32
    v_fmac_f32 v158, v147, v32
    v_fmac_f32 v159, v148, v32
    v_fmac_f32 v160, v149, v32
    v_fmac_f32 v161, v150, v32
    v_fmac_f32 v162, v151, v32
    v_fmac_f32 v163, v152, v32
    v_fmac_f32 v156, v146, v30
    v_fmac_f32 v157, v147, v30
    v_fmac_f32 v158, v148, v30
    v_fmac_f32 v159, v149, v30
    v_fmac_f32 v160, v150, v30
    v_fmac_f32 v161, v151, v30
    v_fmac_f32 v162, v152, v30
    v_fmac_f32 v163, v153, v30
    v_fmac_f32 v156, v147, v28
    v_fmac_f32 v157, v148, v28
    v_fmac_f32 v158, v149, v28
    v_fmac_f32 v159, v150, v28
    v_fmac_f32 v160, v151, v28
    v_fmac_f32 v161, v152, v28
    v_fmac_f32 v162, v153, v28
    v_fmac_f32 v163, v154, v28
    v_lshlrev_b32 v144, 16, v66
    v_lshlrev_b32 v145, 16, v67
    v_lshlrev_b32 v146, 16, v68
    v_lshlrev_b32 v147, 16, v69
    v_lshlrev_b32 v148, 16, v70
    v_lshlrev_b32 v149, 16, v71
    v_lshlrev_b32 v150, 16, v72
    v_lshlrev_b32 v151, 16, v73
    v_mul_f32 v156, v156, v144
    v_mul_f32 v157, v157, v145
    v_mul_f32 v158, v158, v146
    v_mul_f32 v159, v159, v147
    v_mul_f32 v160, v160, v148
    v_mul_f32 v161, v161, v149
    v_mul_f32 v162, v162, v150
    v_mul_f32 v163, v163, v151
    v_cvt_pk_bf16_f32 v164, v163, v162
    v_cvt_pk_bf16_f32 v165, v161, v160
    v_cvt_pk_bf16_f32 v166, v159, v158
    v_cvt_pk_bf16_f32 v167, v157, v156
    v_add_u32 v1, 2048, v8
    v_and_b32 v144, s90, v55
    v_and_b32 v145, s90, v56
    v_and_b32 v146, s90, v57
    v_and_b32 v147, s90, v58
    ds_write_b128 v7, v[164:167] offset:2048
    v_and_b32 v148, s90, v59
    v_and_b32 v149, s90, v60
    v_and_b32 v150, s90, v61
    v_and_b32 v151, s90, v62
    v_and_b32 v152, s90, v63
    v_and_b32 v153, s90, v64
    v_and_b32 v154, s90, v65
    v_mul_f32 v156, v144, v35
    v_mul_f32 v157, v145, v35
    v_mul_f32 v158, v146, v35
    v_mul_f32 v159, v147, v35
    v_mul_f32 v160, v148, v35
    v_mul_f32 v161, v149, v35
    v_mul_f32 v162, v150, v35
    v_mul_f32 v163, v151, v35
    v_fmac_f32 v156, v145, v33
    ds_write2_b32 v1, v164, v165 offset0:0 offset1:1
    v_fmac_f32 v157, v146, v33
    v_fmac_f32 v158, v147, v33
    v_fmac_f32 v159, v148, v33
    v_fmac_f32 v160, v149, v33
    v_fmac_f32 v161, v150, v33
    v_fmac_f32 v162, v151, v33
    v_fmac_f32 v163, v152, v33
    v_fmac_f32 v156, v146, v31
    v_fmac_f32 v157, v147, v31
    v_fmac_f32 v158, v148, v31
    v_fmac_f32 v159, v149, v31
    v_fmac_f32 v160, v150, v31
    v_fmac_f32 v161, v151, v31
    v_fmac_f32 v162, v152, v31
    v_fmac_f32 v163, v153, v31
    v_fmac_f32 v156, v147, v29
    ds_write2_b32 v1, v166, v167 offset0:2 offset1:3
    v_fmac_f32 v157, v148, v29
    v_fmac_f32 v158, v149, v29
    v_fmac_f32 v159, v150, v29
    v_fmac_f32 v160, v151, v29
    v_fmac_f32 v161, v152, v29
    v_fmac_f32 v162, v153, v29
    v_fmac_f32 v163, v154, v29
    v_and_b32 v144, s90, v66
    v_and_b32 v145, s90, v67
    v_and_b32 v146, s90, v68
    v_and_b32 v147, s90, v69
    v_and_b32 v148, s90, v70
    v_and_b32 v149, s90, v71
    v_and_b32 v150, s90, v72
    v_and_b32 v151, s90, v73
    v_mul_f32 v156, v156, v144
    v_mul_f32 v157, v157, v145
    v_mul_f32 v158, v158, v146
    v_mul_f32 v159, v159, v147
    v_mul_f32 v160, v160, v148
    v_mul_f32 v161, v161, v149
    v_mul_f32 v162, v162, v150
    v_mul_f32 v163, v163, v151
    v_cvt_pk_bf16_f32 v168, v163, v162
    v_cvt_pk_bf16_f32 v169, v161, v160
    v_cvt_pk_bf16_f32 v170, v159, v158
    v_cvt_pk_bf16_f32 v171, v157, v156
    v_add_u32 v2, 2048, v9
    ds_write_b128 v7, v[168:171] offset:10448
    ds_write2_b32 v2, v168, v169 offset0:0 offset1:1
    ds_write2_b32 v2, v170, v171 offset0:2 offset1:3
    v_mov_b32 v3, 3
    ds_write_b32 v6, v3
    buffer_load_dword v96, v19, s[48:51], 0 offen
    buffer_load_dword v97, v19, s[48:51], 0 offen offset:2048
    buffer_load_dword v98, v19, s[48:51], s72 offen
    buffer_load_dword v99, v19, s[48:51], s72 offen offset:2048
    buffer_load_dword v100, v19, s[48:51], s73 offen
    buffer_load_dword v101, v19, s[48:51], s73 offen offset:2048
    buffer_load_dword v102, v19, s[48:51], s74 offen
    buffer_load_dword v103, v19, s[48:51], s74 offen offset:2048
    buffer_load_dword v93, v23, s[48:51], 0 offen
    buffer_load_dword v94, v23, s[48:51], 0 offen offset:2048
    buffer_load_dword v95, v23, s[48:51], s72 offen
    buffer_load_dword v104, v19, s[52:55], 0 offen
    buffer_load_dword v105, v19, s[52:55], 0 offen offset:2048
    buffer_load_dword v106, v19, s[52:55], s72 offen
    buffer_load_dword v107, v19, s[52:55], s72 offen offset:2048
    buffer_load_dword v108, v19, s[52:55], s73 offen
    buffer_load_dword v109, v19, s[52:55], s73 offen offset:2048
    buffer_load_dword v110, v19, s[52:55], s74 offen
    buffer_load_dword v111, v19, s[52:55], s74 offen offset:2048
    buffer_load_dword v77, v18, s[48:51], 0 offen
    buffer_load_dword v78, v18, s[48:51], 0 offen offset:2048
    buffer_load_dword v79, v18, s[48:51], s72 offen
    buffer_load_dword v80, v18, s[48:51], s72 offen offset:2048
    buffer_load_dword v81, v18, s[48:51], s73 offen
    buffer_load_dword v82, v18, s[48:51], s73 offen offset:2048
    buffer_load_dword v83, v18, s[48:51], s74 offen
    buffer_load_dword v84, v18, s[48:51], s74 offen offset:2048
    buffer_load_dword v74, v22, s[48:51], 0 offen
    buffer_load_dword v75, v22, s[48:51], 0 offen offset:2048
    buffer_load_dword v76, v22, s[48:51], s72 offen
    buffer_load_dword v85, v18, s[52:55], 0 offen
    buffer_load_dword v86, v18, s[52:55], 0 offen offset:2048
    buffer_load_dword v87, v18, s[52:55], s72 offen
    buffer_load_dword v88, v18, s[52:55], s72 offen offset:2048
    buffer_load_dword v89, v18, s[52:55], s73 offen
    buffer_load_dword v90, v18, s[52:55], s73 offen offset:2048
    buffer_load_dword v91, v18, s[52:55], s74 offen
    buffer_load_dword v92, v18, s[52:55], s74 offen offset:2048
    ds_read_b128 v[12:15], v5
    s_waitcnt lgkmcnt(0)
    v_min3_u32 v12, v12, v13, v14
    v_min_u32 v12, v12, v15
    s_nop 0
    v_readfirstlane_b32 s86, v12
    s_cmp_ge_u32 s86, 2
    s_cbranch_scc1 L_ok43
L_spin44:
    s_sleep 2
    ds_read_b128 v[12:15], v5
    s_waitcnt lgkmcnt(0)
    v_min3_u32 v12, v12, v13, v14
    v_min_u32 v12, v12, v15
    s_nop 0
    v_readfirstlane_b32 s86, v12
    s_cmp_ge_u32 s86, 2
    s_cbranch_scc0 L_spin44
L_ok43:
    ds_read_b64_tr_b16 v[144:145], v10 offset:0
    ds_read_b64_tr_b16 v[146:147], v10 offset:4352
    ds_read_b64_tr_b16 v[148:149], v10 offset:512
    ds_read_b64_tr_b16 v[150:151], v10 offset:4864
    s_waitcnt vmcnt(38)
    v_lshlrev_b32 v152, 16, v112
    v_and_b32 v153, s90, v112
    v_lshlrev_b32 v154, 16, v113
    v_and_b32 v155, s90, v113
    v_lshlrev_b32 v156, 16, v114
    v_and_b32 v157, s90, v114
    v_lshlrev_b32 v158, 16, v115
    v_and_b32 v159, s90, v115
    s_waitcnt lgkmcnt(2)
    v_lshlrev_b32 v160, 16, v144
    v_and_b32 v161, s90, v144
    v_lshlrev_b32 v162, 16, v145
    v_and_b32 v163, s90, v145
    v_lshlrev_b32 v164, 16, v146
    v_and_b32 v165, s90, v146
    v_lshlrev_b32 v166, 16, v147
    v_and_b32 v167, s90, v147
    v_mul_f32 v152, v152, v160
    v_mul_f32 v153, v153, v161
    v_mul_f32 v154, v154, v162
    v_mul_f32 v155, v155, v163
    v_mul_f32 v156, v156, v164
    v_mul_f32 v157, v157, v165
    v_mul_f32 v158, v158, v166
    v_mul_f32 v159, v159, v167
    v_cvt_pk_bf16_f32 v112, v152, v153
    v_cvt_pk_bf16_f32 v113, v154, v155
    v_cvt_pk_bf16_f32 v114, v156, v157
    v_cvt_pk_bf16_f32 v115, v158, v159
    buffer_store_dwordx4 v[112:115], v26, s[60:63], 0 offen
    v_lshlrev_b32 v152, 16, v116
    v_and_b32 v153, s90, v116
    v_lshlrev_b32 v154, 16, v117
    v_and_b32 v155, s90, v117
    v_lshlrev_b32 v156, 16, v118
    v_and_b32 v157, s90, v118
    v_lshlrev_b32 v158, 16, v119
    v_and_b32 v159, s90, v119
    s_waitcnt lgkmcnt(0)
    v_lshlrev_b32 v160, 16, v148
    v_and_b32 v161, s90, v148
    v_lshlrev_b32 v162, 16, v149
    v_and_b32 v163, s90, v149
    v_lshlrev_b32 v164, 16, v150
    v_and_b32 v165, s90, v150
    v_lshlrev_b32 v166, 16, v151
    v_and_b32 v167, s90, v151
    v_mul_f32 v152, v152, v160
    v_mul_f32 v153, v153, v161
    v_mul_f32 v154, v154, v162
    v_mul_f32 v155, v155, v163
    v_mul_f32 v156, v156, v164
    v_mul_f32 v157, v157, v165
    v_mul_f32 v158, v158, v166
    v_mul_f32 v159, v159, v167
    v_cvt_pk_bf16_f32 v116, v152, v153
    v_cvt_pk_bf16_f32 v117, v154, v155
    v_cvt_pk_bf16_f32 v118, v156, v157
    v_cvt_pk_bf16_f32 v119, v158, v159
    buffer_store_dwordx4 v[116:119], v27, s[60:63], 0 offen
    s_waitcnt vmcnt(2)
    v_mov_b32_dpp v74, v82 row_shr:4 row_mask:0xf bank_mask:0xf
    v_mov_b32_dpp v75, v83 row_shr:4 row_mask:0xf bank_mask:0xf
    v_mov_b32_dpp v76, v84 row_shr:4 row_mask:0xf bank_mask:0xf
    v_lshlrev_b32 v144, 16, v74
    v_lshlrev_b32 v145, 16, v75
    v_lshlrev_b32 v146, 16, v76
    v_lshlrev_b32 v147, 16, v77
    v_lshlrev_b32 v148, 16, v78
    v_lshlrev_b32 v149, 16, v79
    v_lshlrev_b32 v150, 16, v80
    v_lshlrev_b32 v151, 16, v81
    v_lshlrev_b32 v152, 16, v82
    v_lshlrev_b32 v153, 16, v83
    v_lshlrev_b32 v154, 16, v84
    v_mul_f32 v156, v144, v34
    v_mul_f32 v157, v145, v34
    v_mul_f32 v158, v146, v34
    v_mul_f32 v159, v147, v34
    v_mul_f32 v160, v148, v34
    v_mul_f32 v161, v149, v34
    v_mul_f32 v162, v150, v34
    v_mul_f32 v163, v151, v34
    v_fmac_f32 v156, v145, v32
    v_fmac_f32 v157, v146, v32
    v_fmac_f32 v158, v147, v32
    v_fmac_f32 v159, v148, v32
    v_fmac_f32 v160, v149, v32
    v_fmac_f32 v161, v150, v32
    v_fmac_f32 v162, v151, v32
    v_fmac_f32 v163, v152, v32
    v_fmac_f32 v156, v146, v30
    v_fmac_f32 v157, v147, v30
    v_fmac_f32 v158, v148, v30
    v_fmac_f32 v159, v149, v30
    v_fmac_f32 v160, v150, v30
    v_fmac_f32 v161, v151, v30
    v_fmac_f32 v162, v152, v30
    v_fmac_f32 v163, v153, v30
    v_fmac_f32 v156, v147, v28
    v_fmac_f32 v157, v148, v28
    v_fmac_f32 v158, v149, v28
    v_fmac_f32 v159, v150, v28
    v_fmac_f32 v160, v151, v28
    v_fmac_f32 v161, v152, v28
    v_fmac_f32 v162, v153, v28
    v_fmac_f32 v163, v154, v28
    v_lshlrev_b32 v144, 16, v85
    v_lshlrev_b32 v145, 16, v86
    v_lshlrev_b32 v146, 16, v87
    v_lshlrev_b32 v147, 16, v88
    v_lshlrev_b32 v148, 16, v89
    v_lshlrev_b32 v149, 16, v90
    v_lshlrev_b32 v150, 16, v91
    v_lshlrev_b32 v151, 16, v92
    v_mul_f32 v156, v156, v144
    v_mul_f32 v157, v157, v145
    v_mul_f32 v158, v158, v146
    v_mul_f32 v159, v159, v147
    v_mul_f32 v160, v160, v148
    v_mul_f32 v161, v161, v149
    v_mul_f32 v162, v162, v150
    v_mul_f32 v163, v163, v151
    v_cvt_pk_bf16_f32 v164, v163, v162
    v_cvt_pk_bf16_f32 v165, v161, v160
    v_cvt_pk_bf16_f32 v166, v159, v158
    v_cvt_pk_bf16_f32 v167, v157, v156
    v_add_u32 v1, 1024, v8
    v_and_b32 v144, s90, v74
    v_and_b32 v145, s90, v75
    v_and_b32 v146, s90, v76
    v_and_b32 v147, s90, v77
    ds_write_b128 v7, v[164:167] offset:1024
    v_and_b32 v148, s90, v78
    v_and_b32 v149, s90, v79
    v_and_b32 v150, s90, v80
    v_and_b32 v151, s90, v81
    v_and_b32 v152, s90, v82
    v_and_b32 v153, s90, v83
    v_and_b32 v154, s90, v84
    v_mul_f32 v156, v144, v35
    v_mul_f32 v157, v145, v35
    v_mul_f32 v158, v146, v35
    v_mul_f32 v159, v147, v35
    v_mul_f32 v160, v148, v35
    v_mul_f32 v161, v149, v35
    v_mul_f32 v162, v150, v35
    v_mul_f32 v163, v151, v35
    v_fmac_f32 v156, v145, v33
    ds_write2_b32 v1, v164, v165 offset0:0 offset1:1
    v_fmac_f32 v157, v146, v33
    v_fmac_f32 v158, v147, v33
    v_fmac_f32 v159, v148, v33
    v_fmac_f32 v160, v149, v33
    v_fmac_f32 v161, v150, v33
    v_fmac_f32 v162, v151, v33
    v_fmac_f32 v163, v152, v33
    v_fmac_f32 v156, v146, v31
    v_fmac_f32 v157, v147, v31
    v_fmac_f32 v158, v148, v31
    v_fmac_f32 v159, v149, v31
    v_fmac_f32 v160, v150, v31
    v_fmac_f32 v161, v151, v31
    v_fmac_f32 v162, v152, v31
    v_fmac_f32 v163, v153, v31
    v_fmac_f32 v156, v147, v29
    ds_write2_b32 v1, v166, v167 offset0:2 offset1:3
    v_fmac_f32 v157, v148, v29
    v_fmac_f32 v158, v149, v29
    v_fmac_f32 v159, v150, v29
    v_fmac_f32 v160, v151, v29
    v_fmac_f32 v161, v152, v29
    v_fmac_f32 v162, v153, v29
    v_fmac_f32 v163, v154, v29
    v_and_b32 v144, s90, v85
    v_and_b32 v145, s90, v86
    v_and_b32 v146, s90, v87
    v_and_b32 v147, s90, v88
    v_and_b32 v148, s90, v89
    v_and_b32 v149, s90, v90
    v_and_b32 v150, s90, v91
    v_and_b32 v151, s90, v92
    v_mul_f32 v156, v156, v144
    v_mul_f32 v157, v157, v145
    v_mul_f32 v158, v158, v146
    v_mul_f32 v159, v159, v147
    v_mul_f32 v160, v160, v148
    v_mul_f32 v161, v161, v149
    v_mul_f32 v162, v162, v150
    v_mul_f32 v163, v163, v151
    v_cvt_pk_bf16_f32 v168, v163, v162
    v_cvt_pk_bf16_f32 v169, v161, v160
    v_cvt_pk_bf16_f32 v170, v159, v158
    v_cvt_pk_bf16_f32 v171, v157, v156
    v_add_u32 v2, 1024, v9
    ds_write_b128 v7, v[168:171] offset:9424
    ds_write2_b32 v2, v168, v169 offset0:0 offset1:1
    ds_write2_b32 v2, v170, v171 offset0:2 offset1:3
    v_mov_b32 v3, 4
    ds_write_b32 v6, v3
    s_and_b32 s87, s84, 1
    s_cmp_gt_u32 s87, 0
    s_cbranch_scc1 L_rot45
    buffer_load_dwordx4 v[120:123], v24, s[56:59], s75 offen
L_rot45:
    buffer_load_dwordx4 v[124:127], v25, s[56:59], s75 offen
    s_cmp_le_u32 s87, 0
    s_cbranch_scc1 L_rot46
    buffer_load_dwordx4 v[120:123], v24, s[56:59], s75 offen
L_rot46:
    ds_read_b128 v[12:15], v5
    s_waitcnt lgkmcnt(0)
    v_min3_u32 v12, v12, v13, v14
    v_min_u32 v12, v12, v15
    s_nop 0
    v_readfirstlane_b32 s86, v12
    s_cmp_ge_u32 s86, 4
    s_cbranch_scc1 L_ok47
L_spin48:
    s_sleep 2
    ds_read_b128 v[12:15], v5
    s_waitcnt lgkmcnt(0)
    v_min3_u32 v12, v12, v13, v14
    v_min_u32 v12, v12, v15
    s_nop 0
    v_readfirstlane_b32 s86, v12
    s_cmp_ge_u32 s86, 4
    s_cbranch_scc0 L_spin48
L_ok47:
    ds_read_b64_tr_b16 v[144:145], v10 offset:8704
    ds_read_b64_tr_b16 v[146:147], v10 offset:13056
    ds_read_b64_tr_b16 v[148:149], v10 offset:9216
    ds_read_b64_tr_b16 v[150:151], v10 offset:13568
    s_waitcnt vmcnt(0)
    v_lshlrev_b32 v152, 16, v120
    v_and_b32 v153, s90, v120
    v_lshlrev_b32 v154, 16, v121
    v_and_b32 v155, s90, v121
    v_lshlrev_b32 v156, 16, v122
    v_and_b32 v157, s90, v122
    v_lshlrev_b32 v158, 16, v123
    v_and_b32 v159, s90, v123
    s_waitcnt lgkmcnt(2)
    v_lshlrev_b32 v160, 16, v144
    v_and_b32 v161, s90, v144
    v_lshlrev_b32 v162, 16, v145
    v_and_b32 v163, s90, v145
    v_lshlrev_b32 v164, 16, v146
    v_and_b32 v165, s90, v146
    v_lshlrev_b32 v166, 16, v147
    v_and_b32 v167, s90, v147
    v_mul_f32 v152, v152, v160
    v_mul_f32 v153, v153, v161
    v_mul_f32 v154, v154, v162
    v_mul_f32 v155, v155, v163
    v_mul_f32 v156, v156, v164
    v_mul_f32 v157, v157, v165
    v_mul_f32 v158, v158, v166
    v_mul_f32 v159, v159, v167
    v_cvt_pk_bf16_f32 v120, v152, v153
    v_cvt_pk_bf16_f32 v121, v154, v155
    v_cvt_pk_bf16_f32 v122, v156, v157
    v_cvt_pk_bf16_f32 v123, v158, v159
    buffer_store_dwordx4 v[120:123], v26, s[60:63], s76 offen
    v_lshlrev_b32 v152, 16, v124
    v_and_b32 v153, s90, v124
    v_lshlrev_b32 v154, 16, v125
    v_and_b32 v155, s90, v125
    v_lshlrev_b32 v156, 16, v126
    v_and_b32 v157, s90, v126
    v_lshlrev_b32 v158, 16, v127
    v_and_b32 v159, s90, v127
    s_waitcnt lgkmcnt(0)
    v_lshlrev_b32 v160, 16, v148
    v_and_b32 v161, s90, v148
    v_lshlrev_b32 v162, 16, v149
    v_and_b32 v163, s90, v149
    v_lshlrev_b32 v164, 16, v150
    v_and_b32 v165, s90, v150
    v_lshlrev_b32 v166, 16, v151
    v_and_b32 v167, s90, v151
    v_mul_f32 v152, v152, v160
    v_mul_f32 v153, v153, v161
    v_mul_f32 v154, v154, v162
    v_mul_f32 v155, v155, v163
    v_mul_f32 v156, v156, v164
    v_mul_f32 v157, v157, v165
    v_mul_f32 v158, v158, v166
    v_mul_f32 v159, v159, v167
    v_cvt_pk_bf16_f32 v124, v152, v153
    v_cvt_pk_bf16_f32 v125, v154, v155
    v_cvt_pk_bf16_f32 v126, v156, v157
    v_cvt_pk_bf16_f32 v127, v158, v159
    buffer_store_dwordx4 v[124:127], v27, s[60:63], s76 offen
    v_mov_b32_dpp v93, v101 row_shr:4 row_mask:0xf bank_mask:0xf
    v_mov_b32_dpp v94, v102 row_shr:4 row_mask:0xf bank_mask:0xf
    v_mov_b32_dpp v95, v103 row_shr:4 row_mask:0xf bank_mask:0xf
    v_lshlrev_b32 v144, 16, v93
    v_lshlrev_b32 v145, 16, v94
    v_lshlrev_b32 v146, 16, v95
    v_lshlrev_b32 v147, 16, v96
    v_lshlrev_b32 v148, 16, v97
    v_lshlrev_b32 v149, 16, v98
    v_lshlrev_b32 v150, 16, v99
    v_lshlrev_b32 v151, 16, v100
    v_lshlrev_b32 v152, 16, v101
    v_lshlrev_b32 v153, 16, v102
    v_lshlrev_b32 v154, 16, v103
    v_mul_f32 v156, v144, v34
    v_mul_f32 v157, v145, v34
    v_mul_f32 v158, v146, v34
    v_mul_f32 v159, v147, v34
    v_mul_f32 v160, v148, v34
    v_mul_f32 v161, v149, v34
    v_mul_f32 v162, v150, v34
    v_mul_f32 v163, v151, v34
    v_fmac_f32 v156, v145, v32
    v_fmac_f32 v157, v146, v32
    v_fmac_f32 v158, v147, v32
    v_fmac_f32 v159, v148, v32
    v_fmac_f32 v160, v149, v32
    v_fmac_f32 v161, v150, v32
    v_fmac_f32 v162, v151, v32
    v_fmac_f32 v163, v152, v32
    v_fmac_f32 v156, v146, v30
    v_fmac_f32 v157, v147, v30
    v_fmac_f32 v158, v148, v30
    v_fmac_f32 v159, v149, v30
    v_fmac_f32 v160, v150, v30
    v_fmac_f32 v161, v151, v30
    v_fmac_f32 v162, v152, v30
    v_fmac_f32 v163, v153, v30
    v_fmac_f32 v156, v147, v28
    v_fmac_f32 v157, v148, v28
    v_fmac_f32 v158, v149, v28
    v_fmac_f32 v159, v150, v28
    v_fmac_f32 v160, v151, v28
    v_fmac_f32 v161, v152, v28
    v_fmac_f32 v162, v153, v28
    v_fmac_f32 v163, v154, v28
    v_lshlrev_b32 v144, 16, v104
    v_lshlrev_b32 v145, 16, v105
    v_lshlrev_b32 v146, 16, v106
    v_lshlrev_b32 v147, 16, v107
    v_lshlrev_b32 v148, 16, v108
    v_lshlrev_b32 v149, 16, v109
    v_lshlrev_b32 v150, 16, v110
    v_lshlrev_b32 v151, 16, v111
    v_mul_f32 v156, v156, v144
    v_mul_f32 v157, v157, v145
    v_mul_f32 v158, v158, v146
    v_mul_f32 v159, v159, v147
    v_mul_f32 v160, v160, v148
    v_mul_f32 v161, v161, v149
    v_mul_f32 v162, v162, v150
    v_mul_f32 v163, v163, v151
    v_cvt_pk_bf16_f32 v164, v163, v162
    v_cvt_pk_bf16_f32 v165, v161, v160
    v_cvt_pk_bf16_f32 v166, v159, v158
    v_cvt_pk_bf16_f32 v167, v157, v156
    v_and_b32 v144, s90, v93
    v_and_b32 v145, s90, v94
    v_and_b32 v146, s90, v95
    v_and_b32 v147, s90, v96
    ds_write_b128 v7, v[164:167] offset:0
    v_and_b32 v148, s90, v97
    v_and_b32 v149, s90, v98
    v_and_b32 v150, s90, v99
    v_and_b32 v151, s90, v100
    v_and_b32 v152, s90, v101
    v_and_b32 v153, s90, v102
    v_and_b32 v154, s90, v103
    v_mul_f32 v156, v144, v35
    v_mul_f32 v157, v145, v35
    v_mul_f32 v158, v146, v35
    v_mul_f32 v159, v147, v35
    v_mul_f32 v160, v148, v35
    v_mul_f32 v161, v149, v35
    v_mul_f32 v162, v150, v35
    v_mul_f32 v163, v151, v35
    v_fmac_f32 v156, v145, v33
    ds_write2_b32 v8, v164, v165 offset0:0 offset1:1
    v_fmac_f32 v157, v146, v33
    v_fmac_f32 v158, v147, v33
    v_fmac_f32 v159, v148, v33
    v_fmac_f32 v160, v149, v33
    v_fmac_f32 v161, v150, v33
    v_fmac_f32 v162, v151, v33
    v_fmac_f32 v163, v152, v33
    v_fmac_f32 v156, v146, v31
    v_fmac_f32 v157, v147, v31
    v_fmac_f32 v158, v148, v31
    v_fmac_f32 v159, v149, v31
    v_fmac_f32 v160, v150, v31
    v_fmac_f32 v161, v151, v31
    v_fmac_f32 v162, v152, v31
    v_fmac_f32 v163, v153, v31
    v_fmac_f32 v156, v147, v29
    ds_write2_b32 v8, v166, v167 offset0:2 offset1:3
    v_fmac_f32 v157, v148, v29
    v_fmac_f32 v158, v149, v29
    v_fmac_f32 v159, v150, v29
    v_fmac_f32 v160, v151, v29
    v_fmac_f32 v161, v152, v29
    v_fmac_f32 v162, v153, v29
    v_fmac_f32 v163, v154, v29
    v_and_b32 v144, s90, v104
    v_and_b32 v145, s90, v105
    v_and_b32 v146, s90, v106
    v_and_b32 v147, s90, v107
    v_and_b32 v148, s90, v108
    v_and_b32 v149, s90, v109
    v_and_b32 v150, s90, v110
    v_and_b32 v151, s90, v111
    v_mul_f32 v156, v156, v144
    v_mul_f32 v157, v157, v145
    v_mul_f32 v158, v158, v146
    v_mul_f32 v159, v159, v147
    v_mul_f32 v160, v160, v148
    v_mul_f32 v161, v161, v149
    v_mul_f32 v162, v162, v150
    v_mul_f32 v163, v163, v151
    v_cvt_pk_bf16_f32 v168, v163, v162
    v_cvt_pk_bf16_f32 v169, v161, v160
    v_cvt_pk_bf16_f32 v170, v159, v158
    v_cvt_pk_bf16_f32 v171, v157, v156
    ds_write_b128 v7, v[168:171] offset:8400
    ds_write2_b32 v9, v168, v169 offset0:0 offset1:1
    ds_write2_b32 v9, v170, v171 offset0:2 offset1:3
    v_mov_b32 v3, 5
    ds_write_b32 v6, v3
    s_and_b32 s87, s84, 1
    s_cmp_gt_u32 s87, 0
    s_cbranch_scc1 L_rot49
    buffer_load_dwordx4 v[128:131], v24, s[56:59], s76 offen
L_rot49:
    buffer_load_dwordx4 v[132:135], v25, s[56:59], s76 offen
    s_cmp_le_u32 s87, 0
    s_cbranch_scc1 L_rot50
    buffer_load_dwordx4 v[128:131], v24, s[56:59], s76 offen
L_rot50:
    s_and_b32 s87, s84, 1
    s_cmp_gt_u32 s87, 0
    s_cbranch_scc1 L_rot51
    buffer_load_dwordx4 v[136:139], v24, s[56:59], s77 offen
L_rot51:
    buffer_load_dwordx4 v[140:143], v25, s[56:59], s77 offen
    s_cmp_le_u32 s87, 0
    s_cbranch_scc1 L_rot52
    buffer_load_dwordx4 v[136:139], v24, s[56:59], s77 offen
L_rot52:
    ds_read_b128 v[12:15], v5
    s_waitcnt lgkmcnt(0)
    v_min3_u32 v12, v12, v13, v14
    v_min_u32 v12, v12, v15
    s_nop 0
    v_readfirstlane_b32 s86, v12
    s_cmp_ge_u32 s86, 6
    s_cbranch_scc1 L_ok53
L_spin54:
    s_sleep 2
    ds_read_b128 v[12:15], v5
    s_waitcnt lgkmcnt(0)
    v_min3_u32 v12, v12, v13, v14
    v_min_u32 v12, v12, v15
    s_nop 0
    v_readfirstlane_b32 s86, v12
    s_cmp_ge_u32 s86, 6
    s_cbranch_scc0 L_spin54
L_ok53:
    ds_read_b64_tr_b16 v[144:145], v11 offset:0
    ds_read_b64_tr_b16 v[146:147], v11 offset:33600
    ds_read_b64_tr_b16 v[148:149], v11 offset:512
    ds_read_b64_tr_b16 v[150:151], v11 offset:34112
    s_waitcnt vmcnt(2)
    v_lshlrev_b32 v152, 16, v128
    v_and_b32 v153, s90, v128
    v_lshlrev_b32 v154, 16, v129
    v_and_b32 v155, s90, v129
    v_lshlrev_b32 v156, 16, v130
    v_and_b32 v157, s90, v130
    v_lshlrev_b32 v158, 16, v131
    v_and_b32 v159, s90, v131
    s_waitcnt lgkmcnt(2)
    v_lshlrev_b32 v160, 16, v144
    v_and_b32 v161, s90, v144
    v_lshlrev_b32 v162, 16, v145
    v_and_b32 v163, s90, v145
    v_lshlrev_b32 v164, 16, v146
    v_and_b32 v165, s90, v146
    v_lshlrev_b32 v166, 16, v147
    v_and_b32 v167, s90, v147
    v_mul_f32 v152, v152, v160
    v_mul_f32 v153, v153, v161
    v_mul_f32 v154, v154, v162
    v_mul_f32 v155, v155, v163
    v_mul_f32 v156, v156, v164
    v_mul_f32 v157, v157, v165
    v_mul_f32 v158, v158, v166
    v_mul_f32 v159, v159, v167
    v_cvt_pk_bf16_f32 v128, v152, v153
    v_cvt_pk_bf16_f32 v129, v154, v155
    v_cvt_pk_bf16_f32 v130, v156, v157
    v_cvt_pk_bf16_f32 v131, v158, v159
    buffer_store_dwordx4 v[128:131], v26, s[60:63], s78 offen
    v_lshlrev_b32 v152, 16, v132
    v_and_b32 v153, s90, v132
    v_lshlrev_b32 v154, 16, v133
    v_and_b32 v155, s90, v133
    v_lshlrev_b32 v156, 16, v134
    v_and_b32 v157, s90, v134
    v_lshlrev_b32 v158, 16, v135
    v_and_b32 v159, s90, v135
    s_waitcnt lgkmcnt(0)
    v_lshlrev_b32 v160, 16, v148
    v_and_b32 v161, s90, v148
    v_lshlrev_b32 v162, 16, v149
    v_and_b32 v163, s90, v149
    v_lshlrev_b32 v164, 16, v150
    v_and_b32 v165, s90, v150
    v_lshlrev_b32 v166, 16, v151
    v_and_b32 v167, s90, v151
    v_mul_f32 v152, v152, v160
    v_mul_f32 v153, v153, v161
    v_mul_f32 v154, v154, v162
    v_mul_f32 v155, v155, v163
    v_mul_f32 v156, v156, v164
    v_mul_f32 v157, v157, v165
    v_mul_f32 v158, v158, v166
    v_mul_f32 v159, v159, v167
    v_cvt_pk_bf16_f32 v132, v152, v153
    v_cvt_pk_bf16_f32 v133, v154, v155
    v_cvt_pk_bf16_f32 v134, v156, v157
    v_cvt_pk_bf16_f32 v135, v158, v159
    buffer_store_dwordx4 v[132:135], v27, s[60:63], s78 offen
    ds_read_b128 v[12:15], v5
    s_waitcnt lgkmcnt(0)
    v_min3_u32 v12, v12, v13, v14
    v_min_u32 v12, v12, v15
    s_nop 0
    v_readfirstlane_b32 s86, v12
    s_cmp_ge_u32 s86, 7
    s_cbranch_scc1 L_ok55
L_spin56:
    s_sleep 2
    ds_read_b128 v[12:15], v5
    s_waitcnt lgkmcnt(0)
    v_min3_u32 v12, v12, v13, v14
    v_min_u32 v12, v12, v15
    s_nop 0
    v_readfirstlane_b32 s86, v12
    s_cmp_ge_u32 s86, 7
    s_cbranch_scc0 L_spin56
L_ok55:
    ds_read_b64_tr_b16 v[144:145], v11 offset:4224
    ds_read_b64_tr_b16 v[146:147], v11 offset:37824
    s_waitcnt vmcnt(2)
    v_lshlrev_b32 v152, 16, v136
    v_and_b32 v153, s90, v136
    v_lshlrev_b32 v154, 16, v137
    v_and_b32 v155, s90, v137
    v_lshlrev_b32 v156, 16, v138
    v_and_b32 v157, s90, v138
    v_lshlrev_b32 v158, 16, v139
    v_and_b32 v159, s90, v139
    s_waitcnt lgkmcnt(0)
    v_lshlrev_b32 v160, 16, v144
    v_and_b32 v161, s90, v144
    v_lshlrev_b32 v162, 16, v145
    v_and_b32 v163, s90, v145
    v_lshlrev_b32 v164, 16, v146
    v_and_b32 v165, s90, v146
    v_lshlrev_b32 v166, 16, v147
    v_and_b32 v167, s90, v147
    v_mul_f32 v152, v152, v160
    v_mul_f32 v153, v153, v161
    v_mul_f32 v154, v154, v162
    v_mul_f32 v155, v155, v163
    v_mul_f32 v156, v156, v164
    v_mul_f32 v157, v157, v165
    v_mul_f32 v158, v158, v166
    v_mul_f32 v159, v159, v167
    v_cvt_pk_bf16_f32 v136, v152, v153
    v_cvt_pk_bf16_f32 v137, v154, v155
    v_cvt_pk_bf16_f32 v138, v156, v157
    v_cvt_pk_bf16_f32 v139, v158, v159
    buffer_store_dwordx4 v[136:139], v26, s[60:63], s79 offen
    ds_read_b128 v[12:15], v5
    s_waitcnt lgkmcnt(0)
    v_min3_u32 v12, v12, v13, v14
    v_min_u32 v12, v12, v15
    s_nop 0
    v_readfirstlane_b32 s86, v12
    s_cmp_ge_u32 s86, 8
    s_cbranch_scc1 L_ok57
L_spin58:
    ds_read_b128 v[12:15], v5
    s_waitcnt lgkmcnt(0)
    v_min3_u32 v12, v12, v13, v14
    v_min_u32 v12, v12, v15
    s_nop 0
    v_readfirstlane_b32 s86, v12
    s_cmp_ge_u32 s86, 8
    s_cbranch_scc0 L_spin58
L_ok57:
    ds_read_b64_tr_b16 v[148:149], v11 offset:4736
    ds_read_b64_tr_b16 v[150:151], v11 offset:38336
    v_lshlrev_b32 v152, 16, v140
    v_and_b32 v153, s90, v140
    v_lshlrev_b32 v154, 16, v141
    v_and_b32 v155, s90, v141
    v_lshlrev_b32 v156, 16, v142
    v_and_b32 v157, s90, v142
    v_lshlrev_b32 v158, 16, v143
    v_and_b32 v159, s90, v143
    s_waitcnt lgkmcnt(0)
    v_lshlrev_b32 v160, 16, v148
    v_and_b32 v161, s90, v148
    v_lshlrev_b32 v162, 16, v149
    v_and_b32 v163, s90, v149
    v_lshlrev_b32 v164, 16, v150
    v_and_b32 v165, s90, v150
    v_lshlrev_b32 v166, 16, v151
    v_and_b32 v167, s90, v151
    v_mul_f32 v152, v152, v160
    v_mul_f32 v153, v153, v161
    v_mul_f32 v154, v154, v162
    v_mul_f32 v155, v155, v163
    v_mul_f32 v156, v156, v164
    v_mul_f32 v157, v157, v165
    v_mul_f32 v158, v158, v166
    v_mul_f32 v159, v159, v167
    v_cvt_pk_bf16_f32 v140, v152, v153
    v_cvt_pk_bf16_f32 v141, v154, v155
    v_cvt_pk_bf16_f32 v142, v156, v157
    v_cvt_pk_bf16_f32 v143, v158, v159
    buffer_store_dwordx4 v[140:143], v27, s[60:63], s79 offen
    s_endpgm
L_AH_body:
    s_barrier
    s_mov_b32 s90, 0xffff0000
    s_mul_i32 s91, s83, 9120
    s_lshl_b32 s86, s83, 2
    s_and_b32 s86, s86, 16
    s_sub_u32 s86, 157584, s86
    v_mov_b32 v5, s86
    s_mov_b32 s94, 0x400000
    s_mov_b32 s95, 0x20000
    s_mov_b32 s54, 0x400000
    s_mov_b32 s55, 0x20000
    s_mov_b64 s[92:93], s[36:37]
    s_mov_b64 s[52:53], s[38:39]
    s_bfe_u32 s4, s2, 0x40003
    s_lshl_b32 s4, s4, 2
    s_add_u32 s4, s4, s3
    s_lshl_b32 s87, s5, 8
    s_lshl_b32 s86, s4, 14
    s_add_u32 s86, s86, s87
    v_lshrrev_b32 v12, 3, v0
    v_lshlrev_b32 v12, 11, v12
    v_and_b32 v13, 4, v0
    v_lshl_add_u32 v12, v13, 5, v12
    v_add_u32 v20, s86, v12
    s_mov_b32 s88, 0x05040100
    s_mov_b32 s89, 0x07060302
    s_mov_b32 s50, 0x400000
    s_mov_b32 s51, 0x20000
    s_mov_b32 s58, 0x400000
    s_mov_b32 s59, 0x20000
    s_mov_b32 s66, 0x400000
    s_mov_b32 s67, 0x20000
    s_mov_b32 s62, 0x800000
    s_mov_b32 s63, 0x20000
    s_mov_b64 s[48:49], s[16:17]
    s_mov_b64 s[56:57], s[34:35]
    s_mov_b64 s[64:65], s[42:43]
    s_mov_b64 s[60:61], s[46:47]
    s_lshl_b32 s86, s4, 15
    s_add_u32 s86, s86, s87
    v_lshrrev_b32 v12, 2, v0
    v_lshlrev_b32 v12, 11, v12
    v_and_b32 v13, 2, v0
    v_lshl_add_u32 v12, v13, 6, v12
    v_add_u32 v21, s86, v12
    s_lshl_b32 s86, s85, 12
    s_sub_u32 s86, s86, 0x4000
    v_lshlrev_b32 v12, 6, v0
    v_add_u32 v22, s86, v12
    s_movk_i32 s6, 0x4000
    s_mov_b32 s75, 0x100000
    s_mov_b32 s76, 0x200000
    s_mov_b32 s77, 0x300000
    s_mov_b32 s78, 0x400000
    s_mov_b32 s79, 0x600000
    s_lshl_b32 s86, s3, 18
    s_lshl_b32 s87, s84, 4
    s_add_u32 s86, s86, s87
    s_add_u32 s86, s86, 258048
    v_lshlrev_b32 v16, 12, v0
    v_sub_u32 v16, s86, v16
    s_lshl_b32 s86, s3, 8
    s_sub_u32 s82, 73728, s86
    buffer_load_dword v4, v20, s[48:51], 0 offen
    s_mov_b32 m0, s91
    s_mov_b32 s8, 0x41000000
    s_mov_b32 s9, 0x43000000
    s_mov_b32 s7, 0x3a000000
    s_mov_b32 s86, 0x85324210
    s_mov_b32 s87, 0xa97c765
    s_movk_i32 s10, 544
    v_and_b32 v2, 48, v0
    v_add_u32 v2, s91, v2
    v_and_b32 v1, 15, v0
    v_mad_u32_u24 v112, v1, s10, v2
    v_lshlrev_b32 v1, 2, v1
    v_lshrrev_b64 v[114:115], v1, s[86:87]
    v_and_b32 v1, 15, v114
    v_mad_u32_u24 v114, v1, s10, v2
    s_setprio 1
    v_mov_b32 v86, 0x3c00
    ds_write_addtid_b32 v86 offset:0
    ds_write_addtid_b32 v86 offset:256
    s_waitcnt lgkmcnt(0)
    s_lshl_b32 s86, s12, 16
    s_and_b32 s12, s12, s90
    s_bitcmp1_b32 s85, 0
    s_cselect_b32 s12, s12, s86
    s_lshl_b32 s86, s13, 16
    s_and_b32 s13, s13, s90
    s_bitcmp1_b32 s85, 0
    s_cselect_b32 s13, s13, s86
    v_mov_b32 v66, 0x3fb8aa3b
    v_mul_f32 v66, s12, v66
    v_exp_f32 v66, v66
    v_mov_b32 v113, 0
    v_cvt_pk_bf16_f32 v66, v66, v66
    v_writelane_b32 v113, s13, 0
    v_and_b32 v118, s90, v66
    v_mul_f32 v66, 0x3fb8aa3b, v118
    v_mul_f32 v67, 0.15915494, v118
    s_waitcnt vmcnt(5)
    v_lshlrev_b32 v68, 16, v60
    v_and_b32 v69, s90, v60
    v_lshlrev_b32 v70, 16, v61
    v_and_b32 v71, s90, v61
    v_pk_mul_f32 v[68:69], v[68:69], v[66:67] op_sel_hi:[1,0]
    v_pk_mul_f32 v[70:71], v[70:71], v[66:67] op_sel:[0,1] op_sel_hi:[1,1]
    v_pk_mul_f32 v[94:95], v[70:71], s[8:9] op_sel_hi:[1,0]
    v_pk_mul_f32 v[92:93], v[68:69], s[8:9] op_sel_hi:[1,0]
    v_fract_f32 v94, v94
    v_fract_f32 v95, v95
    v_exp_f32 v92, v92
    v_exp_f32 v93, v93
    v_cos_f32 v96, v94
    v_cos_f32 v97, v95
    v_sin_f32 v98, v94
    v_sin_f32 v99, v95
    v_pk_mul_f32 v[96:97], v[96:97], v[92:93]
    v_pk_mul_f32 v[98:99], v[98:99], v[92:93]
    v_cvt_pk_f16_f32 v84, v96, -v98
    v_cvt_pk_f16_f32 v85, v97, -v99
    buffer_load_dwordx4 v[28:31], v16, s[48:51], 0 offen
    buffer_load_dwordx4 v[32:35], v16, s[48:51], 0 offen offset:2048
    v_pk_mul_f16 v86, v84, v84 op_sel_hi:[0,1]
    v_pk_mul_f16 v87, v85, v85 op_sel_hi:[0,1]
    v_pk_fma_f16 v122, v84, v84, v86 op_sel:[1,1,0] op_sel_hi:[1,0,1] neg_lo:[0,1,0]
    v_pk_fma_f16 v123, v85, v85, v87 op_sel:[1,1,0] op_sel_hi:[1,0,1] neg_lo:[0,1,0]
    v_pk_mul_f32 v[94:95], v[70:71], s[8:9] op_sel:[0,1] op_sel_hi:[1,1]
    v_pk_mul_f32 v[92:93], v[68:69], s[8:9] op_sel:[0,1] op_sel_hi:[1,1]
    v_fract_f32 v94, v94
    v_fract_f32 v95, v95
    v_exp_f32 v92, v92
    ds_write_addtid_b32 v84 offset:544
    ds_write_addtid_b32 v85 offset:800
    v_pk_mul_f16 v86, v122, v84 op_sel_hi:[0,1]
    v_pk_mul_f16 v87, v123, v85 op_sel_hi:[0,1]
    v_pk_fma_f16 v124, v122, v84, v86 op_sel:[1,1,0] op_sel_hi:[1,0,1] neg_lo:[0,1,0]
    v_pk_fma_f16 v125, v123, v85, v87 op_sel:[1,1,0] op_sel_hi:[1,0,1] neg_lo:[0,1,0]
    v_exp_f32 v93, v93
    v_cos_f32 v96, v94
    v_cos_f32 v97, v95
    v_sin_f32 v98, v94
    v_sin_f32 v99, v95
    ds_write_addtid_b32 v122 offset:1088
    ds_write_addtid_b32 v123 offset:1344
    v_pk_mul_f16 v86, v124, v84 op_sel_hi:[0,1]
    v_pk_mul_f16 v87, v125, v85 op_sel_hi:[0,1]
    v_pk_fma_f16 v126, v124, v84, v86 op_sel:[1,1,0] op_sel_hi:[1,0,1] neg_lo:[0,1,0]
    v_pk_fma_f16 v127, v125, v85, v87 op_sel:[1,1,0] op_sel_hi:[1,0,1] neg_lo:[0,1,0]
    v_pk_mul_f32 v[96:97], v[96:97], v[92:93]
    v_pk_mul_f32 v[98:99], v[98:99], v[92:93]
    v_cvt_pk_f16_f32 v82, v96, v98
    v_cvt_pk_f16_f32 v83, v97, v99
    s_waitcnt vmcnt(3)
    ds_write_addtid_b32 v124 offset:1632
    ds_write_addtid_b32 v125 offset:1888
    v_pk_mul_f16 v86, v126, v84 op_sel_hi:[0,1]
    v_pk_mul_f16 v87, v127, v85 op_sel_hi:[0,1]
    v_pk_fma_f16 v128, v126, v84, v86 op_sel:[1,1,0] op_sel_hi:[1,0,1] neg_lo:[0,1,0]
    v_pk_fma_f16 v129, v127, v85, v87 op_sel:[1,1,0] op_sel_hi:[1,0,1] neg_lo:[0,1,0]
    v_lshlrev_b32 v72, 16, v62
    v_and_b32 v73, s90, v62
    v_lshlrev_b32 v74, 16, v63
    v_and_b32 v75, s90, v63
    v_lshlrev_b32 v76, 16, v64
    ds_write_addtid_b32 v126 offset:2176
    ds_write_addtid_b32 v127 offset:2432
    v_pk_mul_f16 v86, v128, v84 op_sel_hi:[0,1]
    v_pk_mul_f16 v87, v129, v85 op_sel_hi:[0,1]
    v_pk_fma_f16 v130, v128, v84, v86 op_sel:[1,1,0] op_sel_hi:[1,0,1] neg_lo:[0,1,0]
    v_pk_fma_f16 v131, v129, v85, v87 op_sel:[1,1,0] op_sel_hi:[1,0,1] neg_lo:[0,1,0]
    v_and_b32 v77, s90, v64
    v_lshlrev_b32 v78, 16, v65
    v_and_b32 v79, s90, v65
    v_max_f32 v109, v68, v69
    v_cmp_nge_f32 s[14:15], s7, v109
    ds_write_addtid_b32 v128 offset:2720
    ds_write_addtid_b32 v129 offset:2976
    v_pk_mul_f16 v86, v130, v84 op_sel_hi:[0,1]
    v_pk_mul_f16 v87, v131, v85 op_sel_hi:[0,1]
    v_pk_fma_f16 v132, v130, v84, v86 op_sel:[1,1,0] op_sel_hi:[1,0,1] neg_lo:[0,1,0]
    v_pk_fma_f16 v133, v131, v85, v87 op_sel:[1,1,0] op_sel_hi:[1,0,1] neg_lo:[0,1,0]
    v_pk_mul_f32 v[88:89], v[76:77], v[72:73]
    v_pk_mul_f32 v[90:91], v[76:77], v[74:75]
    v_pk_fma_f32 v[88:89], v[78:79], v[74:75], v[88:89] neg_lo:[1,0,0] neg_hi:[1,0,0]
    v_pk_fma_f32 v[90:91], v[78:79], v[72:73], v[90:91]
    v_max_f32_e64 v117, abs(v88), abs(v90)
    ds_write_addtid_b32 v130 offset:3264
    ds_write_addtid_b32 v131 offset:3520
    v_pk_mul_f16 v86, v132, v84 op_sel_hi:[0,1]
    v_pk_mul_f16 v87, v133, v85 op_sel_hi:[0,1]
    v_pk_fma_f16 v134, v132, v84, v86 op_sel:[1,1,0] op_sel_hi:[1,0,1] neg_lo:[0,1,0]
    v_pk_fma_f16 v135, v133, v85, v87 op_sel:[1,1,0] op_sel_hi:[1,0,1] neg_lo:[0,1,0]
    v_max3_f32 v117, v117, abs(v89), abs(v91)
    v_fract_f32 v94, v70
    v_fract_f32 v95, v71
    v_max_f32_dpp v117, v117, v117 row_shr:1 row_mask:0xf bank_mask:0xf
    v_exp_f32 v92, v68
    ds_write_addtid_b32 v132 offset:3808
    ds_write_addtid_b32 v133 offset:4064
    v_pk_mul_f16 v86, v134, v84 op_sel_hi:[0,1]
    v_pk_mul_f16 v87, v135, v85 op_sel_hi:[0,1]
    v_pk_fma_f16 v136, v134, v84, v86 op_sel:[1,1,0] op_sel_hi:[1,0,1] neg_lo:[0,1,0]
    v_pk_fma_f16 v137, v135, v85, v87 op_sel:[1,1,0] op_sel_hi:[1,0,1] neg_lo:[0,1,0]
    v_exp_f32 v93, v69
    v_max_f32_dpp v117, v117, v117 row_shr:2 row_mask:0xf bank_mask:0xf
    v_cos_f32 v96, v94
    v_cos_f32 v97, v95
    v_max_f32_dpp v117, v117, v117 row_shr:4 row_mask:0xf bank_mask:0xf
    ds_write_addtid_b32 v134 offset:4352
    ds_write_addtid_b32 v135 offset:4608
    v_pk_mul_f16 v86, v136, v84 op_sel_hi:[0,1]
    v_pk_mul_f16 v87, v137, v85 op_sel_hi:[0,1]
    v_pk_fma_f16 v138, v136, v84, v86 op_sel:[1,1,0] op_sel_hi:[1,0,1] neg_lo:[0,1,0]
    v_pk_fma_f16 v139, v137, v85, v87 op_sel:[1,1,0] op_sel_hi:[1,0,1] neg_lo:[0,1,0]
    v_sin_f32 v98, v94
    v_sin_f32 v99, v95
    v_max_f32_dpp v117, v117, v117 row_shr:8 row_mask:0xf bank_mask:0xf
    v_pk_mul_f32 v[96:97], v[96:97], v[92:93]
    v_pk_mul_f32 v[98:99], v[98:99], v[92:93]
    ds_write_addtid_b32 v136 offset:4896
    ds_write_addtid_b32 v137 offset:5152
    v_pk_mul_f16 v86, v138, v84 op_sel_hi:[0,1]
    v_pk_mul_f16 v87, v139, v85 op_sel_hi:[0,1]
    v_pk_fma_f16 v140, v138, v84, v86 op_sel:[1,1,0] op_sel_hi:[1,0,1] neg_lo:[0,1,0]
    v_pk_fma_f16 v141, v139, v85, v87 op_sel:[1,1,0] op_sel_hi:[1,0,1] neg_lo:[0,1,0]
    v_max_f32_dpp v117, v117, v117 row_bcast:15 row_mask:0xa bank_mask:0xf
    v_cvt_pk_f16_f32 v80, v96, v98
    v_cvt_pk_f16_f32 v81, v97, v99
    v_max_f32_dpp v117, v117, v117 row_bcast:31 row_mask:0xc bank_mask:0xf
    s_nop 0
    ds_write_addtid_b32 v138 offset:5440
    ds_write_addtid_b32 v139 offset:5696
    v_pk_mul_f16 v86, v140, v84 op_sel_hi:[0,1]
    v_pk_mul_f16 v87, v141, v85 op_sel_hi:[0,1]
    v_pk_fma_f16 v142, v140, v84, v86 op_sel:[1,1,0] op_sel_hi:[1,0,1] neg_lo:[0,1,0]
    v_pk_fma_f16 v143, v141, v85, v87 op_sel:[1,1,0] op_sel_hi:[1,0,1] neg_lo:[0,1,0]
    v_readlane_b32 s10, v117, 63
    s_nop 0
    s_nop 0
    s_lshr_b32 s10, s10, 23
    s_max_u32 s10, s10, 30
    ds_write_addtid_b32 v140 offset:5984
    ds_write_addtid_b32 v141 offset:6240
    v_pk_mul_f16 v86, v142, v84 op_sel_hi:[0,1]
    v_pk_mul_f16 v87, v143, v85 op_sel_hi:[0,1]
    v_pk_fma_f16 v144, v142, v84, v86 op_sel:[1,1,0] op_sel_hi:[1,0,1] neg_lo:[0,1,0]
    v_pk_fma_f16 v145, v143, v85, v87 op_sel:[1,1,0] op_sel_hi:[1,0,1] neg_lo:[0,1,0]
    s_min_u32 s10, s10, 250
    s_sub_u32 s11, s10, 13
    s_lshl_b32 s11, s11, 23
    s_sub_u32 s10, 267, s10
    s_lshl_b32 s10, s10, 23
    ds_write_addtid_b32 v142 offset:6528
    ds_write_addtid_b32 v143 offset:6784
    v_pk_mul_f16 v86, v144, v84 op_sel_hi:[0,1]
    v_pk_mul_f16 v87, v145, v85 op_sel_hi:[0,1]
    v_pk_fma_f16 v146, v144, v84, v86 op_sel:[1,1,0] op_sel_hi:[1,0,1] neg_lo:[0,1,0]
    v_pk_fma_f16 v147, v145, v85, v87 op_sel:[1,1,0] op_sel_hi:[1,0,1] neg_lo:[0,1,0]
    v_mul_f32 v118, s11, v118
    v_pk_mul_f32 v[88:89], v[88:89], s[10:11] op_sel_hi:[1,0]
    v_pk_mul_f32 v[90:91], v[90:91], s[10:11] op_sel_hi:[1,0]
    v_cvt_pk_f16_f32 v120, v88, v90
    v_cvt_pk_f16_f32 v121, v89, v91
    ds_write_addtid_b32 v144 offset:7072
    ds_write_addtid_b32 v145 offset:7328
    v_pk_mul_f16 v86, v146, v84 op_sel_hi:[0,1]
    v_pk_mul_f16 v87, v147, v85 op_sel_hi:[0,1]
    v_pk_fma_f16 v148, v146, v84, v86 op_sel:[1,1,0] op_sel_hi:[1,0,1] neg_lo:[0,1,0]
    v_pk_fma_f16 v149, v147, v85, v87 op_sel:[1,1,0] op_sel_hi:[1,0,1] neg_lo:[0,1,0]
    ds_write_addtid_b32 v146 offset:7616
    ds_write_addtid_b32 v147 offset:7872
    v_pk_mul_f16 v86, v120, v80 op_sel_hi:[0,1]
    v_pk_mul_f16 v87, v121, v81 op_sel_hi:[0,1]
    v_pk_fma_f16 v150, v120, v80, v86 op_sel:[1,1,0] op_sel_hi:[1,0,1] neg_lo:[0,1,0]
    v_pk_fma_f16 v151, v121, v81, v87 op_sel:[1,1,0] op_sel_hi:[1,0,1] neg_lo:[0,1,0]
    ds_write_addtid_b32 v148 offset:8160
    ds_write_addtid_b32 v149 offset:8416
    ds_read_b128 v[184:187], v112 offset:0
    v_pk_mul_f16 v86, v150, v80 op_sel_hi:[0,1]
    v_pk_mul_f16 v87, v151, v81 op_sel_hi:[0,1]
    v_pk_fma_f16 v152, v150, v80, v86 op_sel:[1,1,0] op_sel_hi:[1,0,1] neg_lo:[0,1,0]
    v_pk_fma_f16 v153, v151, v81, v87 op_sel:[1,1,0] op_sel_hi:[1,0,1] neg_lo:[0,1,0]
    ds_read_b128 v[188:191], v112 offset:64
    ds_read_b128 v[192:195], v112 offset:128
    v_pk_mul_f16 v86, v152, v80 op_sel_hi:[0,1]
    v_pk_mul_f16 v87, v153, v81 op_sel_hi:[0,1]
    v_pk_fma_f16 v154, v152, v80, v86 op_sel:[1,1,0] op_sel_hi:[1,0,1] neg_lo:[0,1,0]
    v_pk_fma_f16 v155, v153, v81, v87 op_sel:[1,1,0] op_sel_hi:[1,0,1] neg_lo:[0,1,0]
    ds_read_b128 v[196:199], v112 offset:192
    ds_read_b128 v[200:203], v112 offset:256
    v_pk_mul_f16 v86, v154, v80 op_sel_hi:[0,1]
    v_pk_mul_f16 v87, v155, v81 op_sel_hi:[0,1]
    v_pk_fma_f16 v156, v154, v80, v86 op_sel:[1,1,0] op_sel_hi:[1,0,1] neg_lo:[0,1,0]
    v_pk_fma_f16 v157, v155, v81, v87 op_sel:[1,1,0] op_sel_hi:[1,0,1] neg_lo:[0,1,0]
    ds_read_b128 v[204:207], v112 offset:320
    ds_read_b128 v[208:211], v112 offset:384
    v_pk_mul_f16 v86, v156, v80 op_sel_hi:[0,1]
    v_pk_mul_f16 v87, v157, v81 op_sel_hi:[0,1]
    v_pk_fma_f16 v158, v156, v80, v86 op_sel:[1,1,0] op_sel_hi:[1,0,1] neg_lo:[0,1,0]
    v_pk_fma_f16 v159, v157, v81, v87 op_sel:[1,1,0] op_sel_hi:[1,0,1] neg_lo:[0,1,0]
    ds_read_b128 v[212:215], v112 offset:448
    ds_write_addtid_b32 v120 offset:0
    ds_write_addtid_b32 v121 offset:256
    v_pk_mul_f16 v86, v158, v80 op_sel_hi:[0,1]
    v_pk_mul_f16 v87, v159, v81 op_sel_hi:[0,1]
    v_pk_fma_f16 v160, v158, v80, v86 op_sel:[1,1,0] op_sel_hi:[1,0,1] neg_lo:[0,1,0]
    v_pk_fma_f16 v161, v159, v81, v87 op_sel:[1,1,0] op_sel_hi:[1,0,1] neg_lo:[0,1,0]
    ds_write_addtid_b32 v150 offset:544
    ds_write_addtid_b32 v151 offset:800
    ds_write_addtid_b32 v152 offset:1088
    ds_write_addtid_b32 v153 offset:1344
    buffer_load_dword v4, v20, s[52:55], s75 offen
    buffer_load_dword v4, v20, s[92:95], s75 offen
    v_pk_mul_f16 v86, v160, v80 op_sel_hi:[0,1]
    v_pk_mul_f16 v87, v161, v81 op_sel_hi:[0,1]
    v_pk_fma_f16 v162, v160, v80, v86 op_sel:[1,1,0] op_sel_hi:[1,0,1] neg_lo:[0,1,0]
    v_pk_fma_f16 v163, v161, v81, v87 op_sel:[1,1,0] op_sel_hi:[1,0,1] neg_lo:[0,1,0]
    ds_write_addtid_b32 v154 offset:1632
    ds_write_addtid_b32 v155 offset:1888
    ds_write_addtid_b32 v156 offset:2176
    ds_write_addtid_b32 v157 offset:2432
    v_pk_mul_f16 v86, v120, v82 op_sel_hi:[0,1]
    v_pk_mul_f16 v87, v121, v83 op_sel_hi:[0,1]
    v_pk_fma_f16 v164, v120, v82, v86 op_sel:[1,1,0] op_sel_hi:[1,0,1] neg_lo:[0,1,0]
    v_pk_fma_f16 v165, v121, v83, v87 op_sel:[1,1,0] op_sel_hi:[1,0,1] neg_lo:[0,1,0]
    ds_write_addtid_b32 v158 offset:2720
    ds_write_addtid_b32 v159 offset:2976
    ds_write_addtid_b32 v160 offset:3264
    ds_write_addtid_b32 v161 offset:3520
    v_pk_mul_f16 v86, v150, v82 op_sel_hi:[0,1]
    v_pk_mul_f16 v87, v151, v83 op_sel_hi:[0,1]
    v_pk_fma_f16 v166, v150, v82, v86 op_sel:[1,1,0] op_sel_hi:[1,0,1] neg_lo:[0,1,0]
    v_pk_fma_f16 v167, v151, v83, v87 op_sel:[1,1,0] op_sel_hi:[1,0,1] neg_lo:[0,1,0]
    ds_write_addtid_b32 v162 offset:3808
    ds_write_addtid_b32 v163 offset:4064
    ds_write_addtid_b32 v164 offset:4352
    ds_write_addtid_b32 v165 offset:4608
    v_pk_mul_f16 v86, v152, v82 op_sel_hi:[0,1]
    v_pk_mul_f16 v87, v153, v83 op_sel_hi:[0,1]
    v_pk_fma_f16 v168, v152, v82, v86 op_sel:[1,1,0] op_sel_hi:[1,0,1] neg_lo:[0,1,0]
    v_pk_fma_f16 v169, v153, v83, v87 op_sel:[1,1,0] op_sel_hi:[1,0,1] neg_lo:[0,1,0]
    ds_write_addtid_b32 v166 offset:4896
    ds_write_addtid_b32 v167 offset:5152
    v_pk_mul_f16 v86, v154, v82 op_sel_hi:[0,1]
    v_pk_mul_f16 v87, v155, v83 op_sel_hi:[0,1]
    v_pk_fma_f16 v170, v154, v82, v86 op_sel:[1,1,0] op_sel_hi:[1,0,1] neg_lo:[0,1,0]
    v_pk_fma_f16 v171, v155, v83, v87 op_sel:[1,1,0] op_sel_hi:[1,0,1] neg_lo:[0,1,0]
    ds_write_addtid_b32 v168 offset:5440
    ds_write_addtid_b32 v169 offset:5696
    v_pk_mul_f16 v86, v156, v82 op_sel_hi:[0,1]
    v_pk_mul_f16 v87, v157, v83 op_sel_hi:[0,1]
    v_pk_fma_f16 v172, v156, v82, v86 op_sel:[1,1,0] op_sel_hi:[1,0,1] neg_lo:[0,1,0]
    v_pk_fma_f16 v173, v157, v83, v87 op_sel:[1,1,0] op_sel_hi:[1,0,1] neg_lo:[0,1,0]
    ds_write_addtid_b32 v170 offset:5984
    ds_write_addtid_b32 v171 offset:6240
    v_pk_mul_f16 v86, v158, v82 op_sel_hi:[0,1]
    v_pk_mul_f16 v87, v159, v83 op_sel_hi:[0,1]
    v_pk_fma_f16 v174, v158, v82, v86 op_sel:[1,1,0] op_sel_hi:[1,0,1] neg_lo:[0,1,0]
    v_pk_fma_f16 v175, v159, v83, v87 op_sel:[1,1,0] op_sel_hi:[1,0,1] neg_lo:[0,1,0]
    ds_write_addtid_b32 v172 offset:6528
    ds_write_addtid_b32 v173 offset:6784
    v_pk_mul_f16 v86, v160, v82 op_sel_hi:[0,1]
    v_pk_mul_f16 v87, v161, v83 op_sel_hi:[0,1]
    v_pk_fma_f16 v122, v160, v82, v86 op_sel:[1,1,0] op_sel_hi:[1,0,1] neg_lo:[0,1,0]
    v_pk_fma_f16 v123, v161, v83, v87 op_sel:[1,1,0] op_sel_hi:[1,0,1] neg_lo:[0,1,0]
    ds_write_addtid_b32 v174 offset:7072
    ds_write_addtid_b32 v175 offset:7328
    v_pk_mul_f16 v86, v162, v82 op_sel_hi:[0,1]
    v_pk_mul_f16 v87, v163, v83 op_sel_hi:[0,1]
    v_pk_fma_f16 v124, v162, v82, v86 op_sel:[1,1,0] op_sel_hi:[1,0,1] neg_lo:[0,1,0]
    v_pk_fma_f16 v125, v163, v83, v87 op_sel:[1,1,0] op_sel_hi:[1,0,1] neg_lo:[0,1,0]
    ds_write_addtid_b32 v122 offset:7616
    ds_write_addtid_b32 v123 offset:7872
    v_pk_mul_f16 v86, v164, v82 op_sel_hi:[0,1]
    v_pk_mul_f16 v87, v165, v83 op_sel_hi:[0,1]
    v_pk_fma_f16 v126, v164, v82, v86 op_sel:[1,1,0] op_sel_hi:[1,0,1] neg_lo:[0,1,0]
    v_pk_fma_f16 v127, v165, v83, v87 op_sel:[1,1,0] op_sel_hi:[1,0,1] neg_lo:[0,1,0]
    ds_write_addtid_b32 v124 offset:8160
    ds_write_addtid_b32 v125 offset:8416
    ds_read_b128 v[216:219], v112 offset:0
    v_pk_mul_f16 v86, v168, v82 op_sel_hi:[0,1]
    v_pk_mul_f16 v87, v169, v83 op_sel_hi:[0,1]
    v_pk_fma_f16 v128, v168, v82, v86 op_sel:[1,1,0] op_sel_hi:[1,0,1] neg_lo:[0,1,0]
    v_pk_fma_f16 v129, v169, v83, v87 op_sel:[1,1,0] op_sel_hi:[1,0,1] neg_lo:[0,1,0]
    ds_read_b128 v[220:223], v112 offset:64
    ds_read_b128 v[224:227], v112 offset:128
    v_pk_mul_f16 v86, v172, v82 op_sel_hi:[0,1]
    v_pk_mul_f16 v87, v173, v83 op_sel_hi:[0,1]
    v_pk_fma_f16 v130, v172, v82, v86 op_sel:[1,1,0] op_sel_hi:[1,0,1] neg_lo:[0,1,0]
    v_pk_fma_f16 v131, v173, v83, v87 op_sel:[1,1,0] op_sel_hi:[1,0,1] neg_lo:[0,1,0]
    ds_read_b128 v[228:231], v112 offset:192
    ds_read_b128 v[232:235], v112 offset:256
    buffer_load_dword v4, v22, s[64:67], s6 offen
    v_pk_mul_f16 v86, v122, v82 op_sel_hi:[0,1]
    v_pk_mul_f16 v87, v123, v83 op_sel_hi:[0,1]
    v_pk_fma_f16 v132, v122, v82, v86 op_sel:[1,1,0] op_sel_hi:[1,0,1] neg_lo:[0,1,0]
    v_pk_fma_f16 v133, v123, v83, v87 op_sel:[1,1,0] op_sel_hi:[1,0,1] neg_lo:[0,1,0]
    ds_read_b128 v[236:239], v112 offset:320
    ds_read_b128 v[240:243], v112 offset:384
    v_pk_mul_f16 v86, v126, v82 op_sel_hi:[0,1]
    v_pk_mul_f16 v87, v127, v83 op_sel_hi:[0,1]
    v_pk_fma_f16 v134, v126, v82, v86 op_sel:[1,1,0] op_sel_hi:[1,0,1] neg_lo:[0,1,0]
    v_pk_fma_f16 v135, v127, v83, v87 op_sel:[1,1,0] op_sel_hi:[1,0,1] neg_lo:[0,1,0]
    ds_read_b128 v[244:247], v112 offset:448
    ds_write_addtid_b32 v126 offset:0
    ds_write_addtid_b32 v127 offset:256
    s_waitcnt lgkmcnt(2)
    v_mfma_f32_16x16x32_f16 v[248:251], v[216:219], v[184:187], 0
    v_mfma_f32_16x16x32_f16 v[248:251], v[220:223], v[188:191], v[248:251]
    v_pk_mul_f16 v86, v128, v82 op_sel_hi:[0,1]
    v_pk_mul_f16 v87, v129, v83 op_sel_hi:[0,1]
    v_pk_fma_f16 v136, v128, v82, v86 op_sel:[1,1,0] op_sel_hi:[1,0,1] neg_lo:[0,1,0]
    v_pk_fma_f16 v137, v129, v83, v87 op_sel:[1,1,0] op_sel_hi:[1,0,1] neg_lo:[0,1,0]
    ds_write_addtid_b32 v128 offset:544
    ds_write_addtid_b32 v129 offset:800
    ds_write_addtid_b32 v130 offset:1088
    ds_write_addtid_b32 v131 offset:1344
    v_mfma_f32_16x16x32_f16 v[248:251], v[224:227], v[192:195], v[248:251]
    v_mfma_f32_16x16x32_f16 v[248:251], v[228:231], v[196:199], v[248:251]
    v_pk_mul_f16 v86, v130, v82 op_sel_hi:[0,1]
    v_pk_mul_f16 v87, v131, v83 op_sel_hi:[0,1]
    v_pk_fma_f16 v138, v130, v82, v86 op_sel:[1,1,0] op_sel_hi:[1,0,1] neg_lo:[0,1,0]
    v_pk_fma_f16 v139, v131, v83, v87 op_sel:[1,1,0] op_sel_hi:[1,0,1] neg_lo:[0,1,0]
    ds_write_addtid_b32 v132 offset:1632
    ds_write_addtid_b32 v133 offset:1888
    ds_write_addtid_b32 v134 offset:2176
    ds_write_addtid_b32 v135 offset:2432
    v_mfma_f32_16x16x32_f16 v[248:251], v[232:235], v[200:203], v[248:251]
    v_mfma_f32_16x16x32_f16 v[248:251], v[236:239], v[204:207], v[248:251]
    v_pk_mul_f16 v86, v132, v82 op_sel_hi:[0,1]
    v_pk_mul_f16 v87, v133, v83 op_sel_hi:[0,1]
    v_pk_fma_f16 v140, v132, v82, v86 op_sel:[1,1,0] op_sel_hi:[1,0,1] neg_lo:[0,1,0]
    v_pk_fma_f16 v141, v133, v83, v87 op_sel:[1,1,0] op_sel_hi:[1,0,1] neg_lo:[0,1,0]
    ds_write_addtid_b32 v136 offset:2720
    ds_write_addtid_b32 v137 offset:2976
    ds_write_addtid_b32 v138 offset:3264
    ds_write_addtid_b32 v139 offset:3520
    v_mfma_f32_16x16x32_f16 v[248:251], v[240:243], v[208:211], v[248:251]
    v_mfma_f32_16x16x32_f16 v[248:251], v[244:247], v[212:215], v[248:251]
    v_pk_mul_f16 v86, v134, v82 op_sel_hi:[0,1]
    v_pk_mul_f16 v87, v135, v83 op_sel_hi:[0,1]
    v_pk_fma_f16 v142, v134, v82, v86 op_sel:[1,1,0] op_sel_hi:[1,0,1] neg_lo:[0,1,0]
    v_pk_fma_f16 v143, v135, v83, v87 op_sel:[1,1,0] op_sel_hi:[1,0,1] neg_lo:[0,1,0]
    ds_write_addtid_b32 v140 offset:3808
    ds_write_addtid_b32 v141 offset:4064
    s_waitcnt vmcnt(3)
    s_add_u32 m0, s82, 3072
    v_perm_b32 v60, v28, v32, s88
    ds_write_addtid_b32 v60 offset:0
    v_perm_b32 v61, v28, v32, s89
    ds_write_addtid_b32 v60 offset:4220
    ds_write_addtid_b32 v61 offset:8400
    v_perm_b32 v62, v29, v33, s88
    ds_write_addtid_b32 v61 offset:12620
    ds_write_addtid_b32 v62 offset:16800
    v_perm_b32 v63, v29, v33, s89
    ds_write_addtid_b32 v62 offset:21028
    ds_write_addtid_b32 v63 offset:25200
    v_perm_b32 v64, v30, v34, s88
    ds_write_addtid_b32 v63 offset:29428
    ds_write_addtid_b32 v64 offset:33600
    v_perm_b32 v65, v30, v34, s89
    ds_write_addtid_b32 v64 offset:37820
    ds_write_addtid_b32 v65 offset:42000
    v_perm_b32 v66, v31, v35, s88
    ds_write_addtid_b32 v65 offset:46220
    ds_write_addtid_b32 v66 offset:50400
    v_perm_b32 v67, v31, v35, s89
    ds_write_addtid_b32 v66 offset:54628
    ds_write_addtid_b32 v67 offset:58800
    ds_write_addtid_b32 v67 offset:63028
    s_mov_b32 m0, s91
    v_mov_b32 v3, 1
    ds_write_b32 v6, v3
    buffer_load_dword v4, v20, s[52:55], s76 offen
    buffer_load_dword v4, v20, s[92:95], s76 offen
    buffer_load_dword v4, v20, s[92:95], s77 offen
    buffer_load_dword v4, v20, s[52:55], s77 offen
    buffer_load_dword v4, v20, s[56:59], 0 offen
    v_pk_mul_f16 v86, v138, v82 op_sel_hi:[0,1]
    v_pk_mul_f16 v87, v139, v83 op_sel_hi:[0,1]
    v_pk_fma_f16 v144, v138, v82, v86 op_sel:[1,1,0] op_sel_hi:[1,0,1] neg_lo:[0,1,0]
    v_pk_fma_f16 v145, v139, v83, v87 op_sel:[1,1,0] op_sel_hi:[1,0,1] neg_lo:[0,1,0]
    ds_write_addtid_b32 v142 offset:4352
    ds_write_addtid_b32 v143 offset:4608
    v_pk_mul_f16 v86, v142, v82 op_sel_hi:[0,1]
    v_pk_mul_f16 v87, v143, v83 op_sel_hi:[0,1]
    v_pk_fma_f16 v146, v142, v82, v86 op_sel:[1,1,0] op_sel_hi:[1,0,1] neg_lo:[0,1,0]
    v_pk_fma_f16 v147, v143, v83, v87 op_sel:[1,1,0] op_sel_hi:[1,0,1] neg_lo:[0,1,0]
    ds_write_addtid_b32 v144 offset:4896
    ds_write_addtid_b32 v145 offset:5152
    v_pk_mul_f16 v86, v144, v82 op_sel_hi:[0,1]
    v_pk_mul_f16 v87, v145, v83 op_sel_hi:[0,1]
    v_pk_fma_f16 v148, v144, v82, v86 op_sel:[1,1,0] op_sel_hi:[1,0,1] neg_lo:[0,1,0]
    v_pk_fma_f16 v149, v145, v83, v87 op_sel:[1,1,0] op_sel_hi:[1,0,1] neg_lo:[0,1,0]
    ds_write_addtid_b32 v146 offset:5440
    ds_write_addtid_b32 v147 offset:5696
    v_pk_mul_f16 v86, v146, v82 op_sel_hi:[0,1]
    v_pk_mul_f16 v87, v147, v83 op_sel_hi:[0,1]
    v_pk_fma_f16 v150, v146, v82, v86 op_sel:[1,1,0] op_sel_hi:[1,0,1] neg_lo:[0,1,0]
    v_pk_fma_f16 v151, v147, v83, v87 op_sel:[1,1,0] op_sel_hi:[1,0,1] neg_lo:[0,1,0]
    ds_write_addtid_b32 v148 offset:5984
    ds_write_addtid_b32 v149 offset:6240
    v_pk_mul_f16 v86, v148, v82 op_sel_hi:[0,1]
    v_pk_mul_f16 v87, v149, v83 op_sel_hi:[0,1]
    v_pk_fma_f16 v152, v148, v82, v86 op_sel:[1,1,0] op_sel_hi:[1,0,1] neg_lo:[0,1,0]
    v_pk_fma_f16 v153, v149, v83, v87 op_sel:[1,1,0] op_sel_hi:[1,0,1] neg_lo:[0,1,0]
    ds_write_addtid_b32 v150 offset:6528
    ds_write_addtid_b32 v151 offset:6784
    v_pk_mul_f16 v86, v150, v82 op_sel_hi:[0,1]
    v_pk_mul_f16 v87, v151, v83 op_sel_hi:[0,1]
    v_pk_fma_f16 v154, v150, v82, v86 op_sel:[1,1,0] op_sel_hi:[1,0,1] neg_lo:[0,1,0]
    v_pk_fma_f16 v155, v151, v83, v87 op_sel:[1,1,0] op_sel_hi:[1,0,1] neg_lo:[0,1,0]
    ds_write_addtid_b32 v152 offset:7072
    ds_write_addtid_b32 v153 offset:7328
    v_pk_mul_f16 v86, v152, v82 op_sel_hi:[0,1]
    v_pk_mul_f16 v87, v153, v83 op_sel_hi:[0,1]
    v_pk_fma_f16 v156, v152, v82, v86 op_sel:[1,1,0] op_sel_hi:[1,0,1] neg_lo:[0,1,0]
    v_pk_fma_f16 v157, v153, v83, v87 op_sel:[1,1,0] op_sel_hi:[1,0,1] neg_lo:[0,1,0]
    ds_write_addtid_b32 v154 offset:7616
    ds_write_addtid_b32 v155 offset:7872
    v_pk_mul_f16 v86, v154, v82 op_sel_hi:[0,1]
    v_pk_mul_f16 v87, v155, v83 op_sel_hi:[0,1]
    v_pk_fma_f16 v158, v154, v82, v86 op_sel:[1,1,0] op_sel_hi:[1,0,1] neg_lo:[0,1,0]
    v_pk_fma_f16 v159, v155, v83, v87 op_sel:[1,1,0] op_sel_hi:[1,0,1] neg_lo:[0,1,0]
    ds_write_addtid_b32 v156 offset:8160
    ds_write_addtid_b32 v157 offset:8416
    ds_read_b128 v[216:219], v112 offset:0
    v_pk_mul_f16 v86, v158, v82 op_sel_hi:[0,1]
    v_pk_mul_f16 v87, v159, v83 op_sel_hi:[0,1]
    v_pk_fma_f16 v160, v158, v82, v86 op_sel:[1,1,0] op_sel_hi:[1,0,1] neg_lo:[0,1,0]
    v_pk_fma_f16 v161, v159, v83, v87 op_sel:[1,1,0] op_sel_hi:[1,0,1] neg_lo:[0,1,0]
    ds_read_b128 v[220:223], v112 offset:64
    ds_read_b128 v[224:227], v112 offset:128
    v_pk_mul_f16 v86, v160, v82 op_sel_hi:[0,1]
    v_pk_mul_f16 v87, v161, v83 op_sel_hi:[0,1]
    v_pk_fma_f16 v162, v160, v82, v86 op_sel:[1,1,0] op_sel_hi:[1,0,1] neg_lo:[0,1,0]
    v_pk_fma_f16 v163, v161, v83, v87 op_sel:[1,1,0] op_sel_hi:[1,0,1] neg_lo:[0,1,0]
    ds_read_b128 v[228:231], v112 offset:192
    ds_read_b128 v[232:235], v112 offset:256
    v_pk_mul_f16 v86, v162, v82 op_sel_hi:[0,1]
    v_pk_mul_f16 v87, v163, v83 op_sel_hi:[0,1]
    v_pk_fma_f16 v164, v162, v82, v86 op_sel:[1,1,0] op_sel_hi:[1,0,1] neg_lo:[0,1,0]
    v_pk_fma_f16 v165, v163, v83, v87 op_sel:[1,1,0] op_sel_hi:[1,0,1] neg_lo:[0,1,0]
    ds_read_b128 v[236:239], v112 offset:320
    ds_read_b128 v[240:243], v112 offset:384
    v_pk_mul_f16 v86, v164, v82 op_sel_hi:[0,1]
    v_pk_mul_f16 v87, v165, v83 op_sel_hi:[0,1]
    v_pk_fma_f16 v166, v164, v82, v86 op_sel:[1,1,0] op_sel_hi:[1,0,1] neg_lo:[0,1,0]
    v_pk_fma_f16 v167, v165, v83, v87 op_sel:[1,1,0] op_sel_hi:[1,0,1] neg_lo:[0,1,0]
    ds_read_b128 v[244:247], v112 offset:448
    ds_write_addtid_b32 v158 offset:0
    ds_write_addtid_b32 v159 offset:256
    s_waitcnt lgkmcnt(2)
    v_mfma_f32_16x16x32_f16 v[252:255], v[216:219], v[184:187], 0
    v_mfma_f32_16x16x32_f16 v[252:255], v[220:223], v[188:191], v[252:255]
    v_pk_mul_f16 v86, v166, v82 op_sel_hi:[0,1]
    v_pk_mul_f16 v87, v167, v83 op_sel_hi:[0,1]
    v_pk_fma_f16 v168, v166, v82, v86 op_sel:[1,1,0] op_sel_hi:[1,0,1] neg_lo:[0,1,0]
    v_pk_fma_f16 v169, v167, v83, v87 op_sel:[1,1,0] op_sel_hi:[1,0,1] neg_lo:[0,1,0]
    ds_write_addtid_b32 v160 offset:544
    ds_write_addtid_b32 v161 offset:800
    ds_write_addtid_b32 v162 offset:1088
    ds_write_addtid_b32 v163 offset:1344
    v_mfma_f32_16x16x32_f16 v[252:255], v[224:227], v[192:195], v[252:255]
    v_mfma_f32_16x16x32_f16 v[252:255], v[228:231], v[196:199], v[252:255]
    v_pk_mul_f16 v86, v168, v82 op_sel_hi:[0,1]
    v_pk_mul_f16 v87, v169, v83 op_sel_hi:[0,1]
    v_pk_fma_f16 v170, v168, v82, v86 op_sel:[1,1,0] op_sel_hi:[1,0,1] neg_lo:[0,1,0]
    v_pk_fma_f16 v171, v169, v83, v87 op_sel:[1,1,0] op_sel_hi:[1,0,1] neg_lo:[0,1,0]
    ds_write_addtid_b32 v164 offset:1632
    ds_write_addtid_b32 v165 offset:1888
    ds_write_addtid_b32 v166 offset:2720
    ds_write_addtid_b32 v167 offset:2976
    v_mfma_f32_16x16x32_f16 v[252:255], v[232:235], v[200:203], v[252:255]
    v_mfma_f32_16x16x32_f16 v[252:255], v[236:239], v[204:207], v[252:255]
    v_pk_mul_f16 v86, v170, v82 op_sel_hi:[0,1]
    v_pk_mul_f16 v87, v171, v83 op_sel_hi:[0,1]
    v_pk_fma_f16 v172, v170, v82, v86 op_sel:[1,1,0] op_sel_hi:[1,0,1] neg_lo:[0,1,0]
    v_pk_fma_f16 v173, v171, v83, v87 op_sel:[1,1,0] op_sel_hi:[1,0,1] neg_lo:[0,1,0]
    ds_write_addtid_b32 v168 offset:3264
    ds_write_addtid_b32 v169 offset:3520
    ds_write_addtid_b32 v170 offset:3808
    ds_write_addtid_b32 v171 offset:4064
    v_mfma_f32_16x16x32_f16 v[252:255], v[240:243], v[208:211], v[252:255]
    v_mfma_f32_16x16x32_f16 v[252:255], v[244:247], v[212:215], v[252:255]
    v_pk_mul_f16 v86, v172, v82 op_sel_hi:[0,1]
    v_pk_mul_f16 v87, v173, v83 op_sel_hi:[0,1]
    v_pk_fma_f16 v174, v172, v82, v86 op_sel:[1,1,0] op_sel_hi:[1,0,1] neg_lo:[0,1,0]
    v_pk_fma_f16 v175, v173, v83, v87 op_sel:[1,1,0] op_sel_hi:[1,0,1] neg_lo:[0,1,0]
    ds_write_addtid_b32 v172 offset:4896
    ds_write_addtid_b32 v173 offset:5152
    ds_write_addtid_b32 v174 offset:5440
    ds_write_addtid_b32 v175 offset:5696
    ds_read_b128 v[216:219], v114 offset:0
    ds_read_b128 v[220:223], v114 offset:64
    ds_read_b128 v[224:227], v114 offset:128
    ds_read_b128 v[228:231], v114 offset:192
    ds_read_b128 v[232:235], v114 offset:256
    ds_read_b128 v[236:239], v114 offset:320
    ds_read_b128 v[240:243], v114 offset:384
    ds_read_b128 v[244:247], v114 offset:448
    v_lshrrev_b32 v116, 4, v0
    v_and_b32 v1, 15, v0
    v_lshl_add_u32 v104, v1, 4, s91
    s_mov_b32 s68, 0xaaaaaaaa
    s_mov_b32 s69, 0xaaaaaaaa
    s_mov_b32 s70, 0
    s_mov_b32 s71, -1
    v_lshl_add_u32 v105, v116, 9, v104
    v_min_u32 v1, 28, v0
    v_lshl_add_u32 v1, v1, 4, s91
    v_add_u32 v2, 704, v105
    v_cndmask_b32 v108, v1, v2, s[70:71]
    v_lshrrev_b32 v2, 5, v0
    v_lshl_add_u32 v107, v2, 8, v104
    v_and_b32 v1, 1, v116
    v_lshl_add_u32 v107, v1, 3, v107
    v_lshl_add_u32 v106, v116, 8, v104
    v_add_u32 v106, 512, v106
    v_max_u32 v106, v106, v105
    s_cmp_lg_u64 s[14:15], 0
    s_cbranch_scc1 L_direct1
L_back2:
    v_mul_f32 v254, v118, v254
    v_mul_f32 v252, v118, v252
    v_mul_f32 v253, v118, v253
    v_mul_f32 v255, v118, v255
    v_mov_b32_dpp v69, v254 row_ror:15 row_mask:0xf bank_mask:0xf
    v_fma_f32 v248, v248, v118, v113
    v_mul_f32 v249, v118, v249
    v_mul_f32 v250, v118, v250
    v_mul_f32 v251, v118, v251
    v_mov_b32_dpp v69, v252 row_shl:1 row_mask:0xf bank_mask:0xf
    v_mov_b32 v70, 0
    s_waitcnt lgkmcnt(0)
    v_mfma_f32_16x16x32_f16 v[100:103], v[216:219], v[184:187], 0
    v_cvt_pk_bf16_f32 v132, v248, v249
    v_cvt_pk_bf16_f32 v133, v250, v251
    v_mfma_f32_16x16x32_f16 v[100:103], v[220:223], v[188:191], v[100:103]
    v_cvt_pk_bf16_f32 v134, v249, v250
    v_cndmask_b32 v73, v253, v252, s[70:71]
    v_mfma_f32_16x16x32_f16 v[100:103], v[224:227], v[192:195], v[100:103]
    v_cndmask_b32 v74, v254, v253, s[70:71]
    v_cndmask_b32 v75, v255, v69, s[70:71]
    v_mfma_f32_16x16x32_f16 v[100:103], v[228:231], v[196:199], v[100:103]
    v_cndmask_b32 v76, 0, v254, s[70:71]
    v_cndmask_b32 v77, 0, v255, s[70:71]
    v_mfma_f32_16x16x32_f16 v[100:103], v[232:235], v[200:203], v[100:103]
    v_cvt_pk_bf16_f32 v136, v252, v252
    v_cvt_pk_bf16_f32 v137, v252, v73
    v_mfma_f32_16x16x32_f16 v[100:103], v[236:239], v[204:207], v[100:103]
    v_cvt_pk_bf16_f32 v138, v74, v74
    v_cvt_pk_bf16_f32 v139, v74, v75
    v_mfma_f32_16x16x32_f16 v[100:103], v[240:243], v[208:211], v[100:103]
    v_cvt_pk_bf16_f32 v140, v76, v76
    v_cvt_pk_bf16_f32 v141, v76, v77
    v_mfma_f32_16x16x32_f16 v[100:103], v[244:247], v[212:215], v[100:103]
    v_cvt_pk_bf16_f32 v142, v77, v77
    ds_write_b128 v106, v[136:139] offset:5024
    s_nop 0
    v_cvt_pk_bf16_f32 v137, v73, v74
    s_nop 3
    s_cbranch_scc1 L_fix3
L_back4:
    v_mul_f32 v103, v118, v103
    v_mul_f32 v101, v118, v101
    v_mul_f32 v102, v118, v102
    v_mul_f32 v100, v118, v100
    v_mov_b32_dpp v68, v103 row_ror:15 row_mask:0xf bank_mask:0xf
    v_mov_b32_dpp v70, v103 row_ror:15 row_mask:0xc bank_mask:0xf
    v_mov_b32_dpp v71, v101 row_ror:15 row_mask:0xf bank_mask:0xf
    v_mov_b32_dpp v72, v102 row_ror:15 row_mask:0xf bank_mask:0xf
    v_mov_b32_dpp v68, v252 row_shl:1 row_mask:0xf bank_mask:0xf
    v_mov_b32_dpp v70, v254 row_shl:1 row_mask:0xc bank_mask:0xf
    v_mov_b32_dpp v71, v100 row_shl:1 row_mask:0xf bank_mask:0xf
    v_mov_b32_dpp v72, v101 row_shl:1 row_mask:0xf bank_mask:0xf
    v_cndmask_b32 v68, v68, v69, s[70:71]
    v_cvt_pk_bf16_f32 v143, v70, v70
    v_cvt_pk_bf16_f32 v139, v75, v68
    ds_write_b128 v108, v[140:143] offset:0
    ds_write_b128 v106, v[136:139] offset:448
    v_cvt_pk_bf16_f32 v141, v76, v76
    v_cvt_pk_bf16_f32 v143, v77, v70
    v_cndmask_b32 v73, v100, v71, s[68:69]
    v_cndmask_b32 v74, v101, v72, s[68:69]
    v_cvt_pk_bf16_f32 v144, v100, v100
    v_cvt_pk_bf16_f32 v145, v100, v100
    v_cvt_pk_bf16_f32 v146, v73, v71
    v_cvt_pk_bf16_f32 v147, v71, v71
    v_cvt_pk_bf16_f32 v148, v101, v101
    v_cvt_pk_bf16_f32 v149, v101, v101
    v_cvt_pk_bf16_f32 v150, v74, v72
    v_cvt_pk_bf16_f32 v151, v72, v72
    ds_write_b128 v108, v[140:143] offset:4576
    ds_write_b64 v107, v[132:133] offset:448
    ds_write_b16 v107, v132 offset:5026
    ds_write_b32 v107, v134 offset:5028
    ds_write_b16_d16_hi v107, v133 offset:5032
    ds_write_b128 v105, v[144:147] offset:2496
    ds_write_b128 v105, v[148:151] offset:2752
    v_cvt_pk_bf16_f32 v146, v100, v73
    v_cvt_pk_bf16_f32 v150, v101, v74
    ds_write_b128 v105, v[144:147] offset:7072
    ds_write_b128 v105, v[148:151] offset:7328
    v_mov_b32 v3, 3
    ds_write_b32 v6, v3
    buffer_load_dwordx4 v[36:39], v16, s[48:51], s75 offen
    buffer_load_dwordx4 v[40:43], v16, s[48:51], s75 offen offset:2048
    s_waitcnt vmcnt(0)
    s_add_u32 m0, s82, 2048
    v_perm_b32 v60, v36, v40, s88
    ds_write_addtid_b32 v60 offset:0
    v_perm_b32 v61, v36, v40, s89
    ds_write_addtid_b32 v60 offset:4220
    ds_write_addtid_b32 v61 offset:8400
    v_perm_b32 v62, v37, v41, s88
    ds_write_addtid_b32 v61 offset:12620
    ds_write_addtid_b32 v62 offset:16800
    v_perm_b32 v63, v37, v41, s89
    ds_write_addtid_b32 v62 offset:21028
    ds_write_addtid_b32 v63 offset:25200
    v_perm_b32 v64, v38, v42, s88
    ds_write_addtid_b32 v63 offset:29428
    ds_write_addtid_b32 v64 offset:33600
    v_perm_b32 v65, v38, v42, s89
    ds_write_addtid_b32 v64 offset:37820
    ds_write_addtid_b32 v65 offset:42000
    v_perm_b32 v66, v39, v43, s88
    ds_write_addtid_b32 v65 offset:46220
    ds_write_addtid_b32 v66 offset:50400
    v_perm_b32 v67, v39, v43, s89
    ds_write_addtid_b32 v66 offset:54628
    ds_write_addtid_b32 v67 offset:58800
    ds_write_addtid_b32 v67 offset:63028
    s_mov_b32 m0, s91
    v_mov_b32 v3, 4
    ds_write_b32 v6, v3
    buffer_load_dword v4, v20, s[56:59], s77 offen
    buffer_load_dword v4, v20, s[48:51], s77 offen
    buffer_load_dword v4, v20, s[56:59], s76 offen
    buffer_load_dword v4, v20, s[56:59], s75 offen
    buffer_load_dword v4, v20, s[48:51], s76 offen
    v_and_b32 v2, 3, v0
    v_lshl_add_u32 v15, s3, 6, v0
    s_mul_i32 s86, s3, 0x90
    s_and_b32 s86, s86, 0xa0
    v_and_b32 v1, 32, v0
    v_add3_u32 v1, v1, v0, s86
    s_lshl_b32 s87, s84, 4
    v_lshl_add_u32 v26, v1, 12, s87
    v_add_u32 v27, s75, v26
    v_and_b32 v3, 0xf0, v15
    v_lshlrev_b32 v3, 1, v3
    v_lshl_add_u32 v3, v2, 3, v3
    v_bfe_u32 v1, v0, 2, 2
    s_movk_i32 s86, 1088
    v_mad_u32_u24 v10, v1, s86, v3
    v_add_u32 v10, 140160, v10
    s_movk_i32 s86, 8400
    v_mad_u32_u24 v11, v1, s86, v3
    v_add_u32 v11, 76032, v11
    ds_read_b128 v[12:15], v5
    s_waitcnt lgkmcnt(0)
    v_min3_u32 v12, v12, v13, v14
    v_min_u32 v12, v12, v15
    s_nop 0
    v_readfirstlane_b32 s86, v12
    s_cmp_ge_u32 s86, 2
    s_cbranch_scc1 L_ok6
L_spin7:
    s_sleep 2
    ds_read_b128 v[12:15], v5
    s_waitcnt lgkmcnt(0)
    v_min3_u32 v12, v12, v13, v14
    v_min_u32 v12, v12, v15
    s_nop 0
    v_readfirstlane_b32 s86, v12
    s_cmp_ge_u32 s86, 2
    s_cbranch_scc0 L_spin7
L_ok6:
    ds_read_b64_tr_b16 v[84:85], v10 offset:0
    ds_read_b64_tr_b16 v[86:87], v10 offset:4352
    ds_read_b64_tr_b16 v[88:89], v10 offset:512
    ds_read_b64_tr_b16 v[90:91], v10 offset:4864
    s_waitcnt lgkmcnt(2)
    buffer_store_dwordx4 v[84:87], v26, s[60:63], 0 offen
    s_waitcnt lgkmcnt(0)
    buffer_store_dwordx4 v[88:91], v27, s[60:63], 0 offen
    buffer_load_dwordx4 v[44:47], v16, s[48:51], s76 offen
    buffer_load_dwordx4 v[48:51], v16, s[48:51], s76 offen offset:2048
    s_waitcnt vmcnt(0)
    s_add_u32 m0, s82, 1024
    v_perm_b32 v60, v44, v48, s88
    ds_write_addtid_b32 v60 offset:0
    v_perm_b32 v61, v44, v48, s89
    ds_write_addtid_b32 v60 offset:4220
    ds_write_addtid_b32 v61 offset:8400
    v_perm_b32 v62, v45, v49, s88
    ds_write_addtid_b32 v61 offset:12620
    ds_write_addtid_b32 v62 offset:16800
    v_perm_b32 v63, v45, v49, s89
    ds_write_addtid_b32 v62 offset:21028
    ds_write_addtid_b32 v63 offset:25200
    v_perm_b32 v64, v46, v50, s88
    ds_write_addtid_b32 v63 offset:29428
    ds_write_addtid_b32 v64 offset:33600
    v_perm_b32 v65, v46, v50, s89
    ds_write_addtid_b32 v64 offset:37820
    ds_write_addtid_b32 v65 offset:42000
    v_perm_b32 v66, v47, v51, s88
    ds_write_addtid_b32 v65 offset:46220
    ds_write_addtid_b32 v66 offset:50400
    v_perm_b32 v67, v47, v51, s89
    ds_write_addtid_b32 v66 offset:54628
    ds_write_addtid_b32 v67 offset:58800
    ds_write_addtid_b32 v67 offset:63028
    s_mov_b32 m0, s91
    v_mov_b32 v3, 5
    ds_write_b32 v6, v3
    buffer_load_dwordx4 v[52:55], v16, s[48:51], s77 offen
    buffer_load_dwordx4 v[56:59], v16, s[48:51], s77 offen offset:2048
    s_waitcnt vmcnt(0)
    s_add_u32 m0, s82, 0
    v_perm_b32 v60, v52, v56, s88
    ds_write_addtid_b32 v60 offset:0
    v_perm_b32 v61, v52, v56, s89
    ds_write_addtid_b32 v60 offset:4220
    ds_write_addtid_b32 v61 offset:8400
    v_perm_b32 v62, v53, v57, s88
    ds_write_addtid_b32 v61 offset:12620
    ds_write_addtid_b32 v62 offset:16800
    v_perm_b32 v63, v53, v57, s89
    ds_write_addtid_b32 v62 offset:21028
    ds_write_addtid_b32 v63 offset:25200
    v_perm_b32 v64, v54, v58, s88
    ds_write_addtid_b32 v63 offset:29428
    ds_write_addtid_b32 v64 offset:33600
    v_perm_b32 v65, v54, v58, s89
    ds_write_addtid_b32 v64 offset:37820
    ds_write_addtid_b32 v65 offset:42000
    v_perm_b32 v66, v55, v59, s88
    ds_write_addtid_b32 v65 offset:46220
    ds_write_addtid_b32 v66 offset:50400
    v_perm_b32 v67, v55, v59, s89
    ds_write_addtid_b32 v66 offset:54628
    ds_write_addtid_b32 v67 offset:58800
    ds_write_addtid_b32 v67 offset:63028
    s_mov_b32 m0, s91
    v_mov_b32 v3, 6
    ds_write_b32 v6, v3
    ds_read_b128 v[12:15], v5
    s_waitcnt lgkmcnt(0)
    v_min3_u32 v12, v12, v13, v14
    v_min_u32 v12, v12, v15
    s_nop 0
    v_readfirstlane_b32 s86, v12
    s_cmp_ge_u32 s86, 4
    s_cbranch_scc1 L_ok8
L_spin9:
    s_sleep 2
    ds_read_b128 v[12:15], v5
    s_waitcnt lgkmcnt(0)
    v_min3_u32 v12, v12, v13, v14
    v_min_u32 v12, v12, v15
    s_nop 0
    v_readfirstlane_b32 s86, v12
    s_cmp_ge_u32 s86, 4
    s_cbranch_scc0 L_spin9
L_ok8:
    ds_read_b64_tr_b16 v[92:93], v10 offset:8704
    ds_read_b64_tr_b16 v[94:95], v10 offset:13056
    ds_read_b64_tr_b16 v[96:97], v10 offset:9216
    ds_read_b64_tr_b16 v[98:99], v10 offset:13568
    s_waitcnt lgkmcnt(2)
    buffer_store_dwordx4 v[92:95], v26, s[60:63], s76 offen
    s_waitcnt lgkmcnt(0)
    buffer_store_dwordx4 v[96:99], v27, s[60:63], s76 offen
    ds_read_b128 v[12:15], v5
    s_waitcnt lgkmcnt(0)
    v_min3_u32 v12, v12, v13, v14
    v_min_u32 v12, v12, v15
    s_nop 0
    v_readfirstlane_b32 s86, v12
    s_cmp_ge_u32 s86, 6
    s_cbranch_scc1 L_ok10
L_spin11:
    s_sleep 2
    ds_read_b128 v[12:15], v5
    s_waitcnt lgkmcnt(0)
    v_min3_u32 v12, v12, v13, v14
    v_min_u32 v12, v12, v15
    s_nop 0
    v_readfirstlane_b32 s86, v12
    s_cmp_ge_u32 s86, 6
    s_cbranch_scc0 L_spin11
L_ok10:
    ds_read_b64_tr_b16 v[100:101], v11 offset:0
    ds_read_b64_tr_b16 v[102:103], v11 offset:33600
    ds_read_b64_tr_b16 v[104:105], v11 offset:512
    ds_read_b64_tr_b16 v[106:107], v11 offset:34112
    s_waitcnt lgkmcnt(2)
    buffer_store_dwordx4 v[100:103], v26, s[60:63], s78 offen
    s_waitcnt lgkmcnt(0)
    buffer_store_dwordx4 v[104:107], v27, s[60:63], s78 offen
    ds_read_b128 v[12:15], v5
    s_waitcnt lgkmcnt(0)
    v_min3_u32 v12, v12, v13, v14
    v_min_u32 v12, v12, v15
    s_nop 0
    v_readfirstlane_b32 s86, v12
    s_cmp_ge_u32 s86, 7
    s_cbranch_scc1 L_ok12
L_spin13:
    s_sleep 2
    ds_read_b128 v[12:15], v5
    s_waitcnt lgkmcnt(0)
    v_min3_u32 v12, v12, v13, v14
    v_min_u32 v12, v12, v15
    s_nop 0
    v_readfirstlane_b32 s86, v12
    s_cmp_ge_u32 s86, 7
    s_cbranch_scc0 L_spin13
L_ok12:
    ds_read_b64_tr_b16 v[108:109], v11 offset:4224
    ds_read_b64_tr_b16 v[110:111], v11 offset:37824
    s_waitcnt lgkmcnt(0)
    buffer_store_dwordx4 v[108:111], v26, s[60:63], s79 offen
    ds_read_b128 v[12:15], v5
    s_waitcnt lgkmcnt(0)
    v_min3_u32 v12, v12, v13, v14
    v_min_u32 v12, v12, v15
    s_nop 0
    v_readfirstlane_b32 s86, v12
    s_cmp_ge_u32 s86, 8
    s_cbranch_scc1 L_ok14
L_spin15:
    ds_read_b128 v[12:15], v5
    s_waitcnt lgkmcnt(0)
    v_min3_u32 v12, v12, v13, v14
    v_min_u32 v12, v12, v15
    s_nop 0
    v_readfirstlane_b32 s86, v12
    s_cmp_ge_u32 s86, 8
    s_cbranch_scc0 L_spin15
L_ok14:
    ds_read_b64_tr_b16 v[112:113], v11 offset:4736
    ds_read_b64_tr_b16 v[114:115], v11 offset:38336
    s_waitcnt lgkmcnt(0)
    buffer_store_dwordx4 v[112:115], v27, s[60:63], s79 offen
    s_endpgm
L_AM_body:
    s_barrier
    s_mov_b32 s90, 0xffff0000
    s_mul_i32 s91, s83, 9120
    s_lshl_b32 s86, s83, 2
    s_and_b32 s86, s86, 16
    s_sub_u32 s86, 157584, s86
    v_mov_b32 v5, s86
    s_mov_b32 m0, s91
    s_mov_b32 s8, 0x41000000
    s_mov_b32 s9, 0x43000000
    s_mov_b32 s7, 0x3a000000
    s_mov_b32 s86, 0x85324210
    s_mov_b32 s87, 0xa97c765
    s_movk_i32 s10, 544
    v_and_b32 v2, 48, v0
    v_add_u32 v2, s91, v2
    v_and_b32 v1, 15, v0
    v_mad_u32_u24 v112, v1, s10, v2
    v_lshlrev_b32 v1, 2, v1
    v_lshrrev_b64 v[114:115], v1, s[86:87]
    v_and_b32 v1, 15, v114
    v_mad_u32_u24 v114, v1, s10, v2
    v_lshrrev_b32 v116, 4, v0
    v_and_b32 v1, 15, v0
    v_lshl_add_u32 v104, v1, 4, s91
    s_mov_b32 s68, 0xaaaaaaaa
    s_mov_b32 s69, 0xaaaaaaaa
    s_mov_b32 s70, 0
    s_mov_b32 s71, -1
    v_lshl_add_u32 v105, v116, 9, v104
    v_min_u32 v1, 28, v0
    v_lshl_add_u32 v1, v1, 4, s91
    v_add_u32 v2, 704, v105
    v_cndmask_b32 v108, v1, v2, s[70:71]
    v_lshrrev_b32 v2, 5, v0
    v_lshl_add_u32 v107, v2, 8, v104
    v_and_b32 v1, 1, v116
    v_lshl_add_u32 v107, v1, 3, v107
    v_lshl_add_u32 v106, v116, 8, v104
    v_add_u32 v106, 512, v106
    v_max_u32 v106, v106, v105
    v_and_b32 v3, 1, v0
    v_xor_b32 v3, 1, v3
    v_and_b32 v2, 48, v0
    v_mul_u32_u24 v7, 4576, v3
    v_bfe_u32 v1, v0, 1, 3
    v_lshl_add_u32 v7, v1, 6, v7
    v_add3_u32 v7, v7, v2, s91
    s_lshl_b32 s86, s83, 2
    s_and_b32 s86, s86, 8
    s_add_u32 s86, s86, 4224
    v_mul_u32_u24 v8, s86, v3
    v_lshlrev_b32 v1, 3, v1
    v_sub_u32 v8, v8, v1
    s_mul_i32 s87, s83, 8400
    s_add_u32 s87, s87, 72960
    v_add3_u32 v8, v8, v2, s87
    v_and_b32 v1, 31, v0
    v_min_u32 v1, 14, v1
    v_lshlrev_b32 v1, 2, v1
    v_lshrrev_b32 v2, 5, v0
    s_add_u32 s86, s86, -4
    v_mul_u32_u24 v2, s86, v2
    v_add3_u32 v1, v1, v2, s87
    v_mov_b32 v2, 0
    ds_write_b32 v1, v2 offset:4096
    ds_write_b32 v1, v2 offset:37696
    s_add_u32 s73, s87, 3072
    s_mul_i32 s86, s83, 1088
    s_add_u32 s72, s86, 140160
    v_mov_b32 v86, 0x3c00
    ds_write_addtid_b32 v86 offset:0
    ds_write_addtid_b32 v86 offset:256
    s_waitcnt lgkmcnt(0)
    s_lshl_b32 s86, s12, 16
    s_and_b32 s12, s12, s90
    s_bitcmp1_b32 s85, 0
    s_cselect_b32 s12, s12, s86
    s_lshl_b32 s86, s13, 16
    s_and_b32 s13, s13, s90
    s_bitcmp1_b32 s85, 0
    s_cselect_b32 s13, s13, s86
    v_mov_b32 v66, 0x3fb8aa3b
    v_mul_f32 v66, s12, v66
    v_exp_f32 v66, v66
    v_mov_b32 v113, 0
    v_cvt_pk_bf16_f32 v66, v66, v66
    v_writelane_b32 v113, s13, 0
    v_and_b32 v118, s90, v66
    v_mul_f32 v66, 0x3fb8aa3b, v118
    v_mul_f32 v67, 0.15915494, v118
    s_waitcnt vmcnt(4)
    v_lshlrev_b32 v68, 16, v60
    v_and_b32 v69, s90, v60
    v_lshlrev_b32 v70, 16, v61
    v_and_b32 v71, s90, v61
    v_pk_mul_f32 v[68:69], v[68:69], v[66:67] op_sel_hi:[1,0]
    v_pk_mul_f32 v[70:71], v[70:71], v[66:67] op_sel:[0,1] op_sel_hi:[1,1]
    v_pk_mul_f32 v[94:95], v[70:71], s[8:9] op_sel_hi:[1,0]
    v_pk_mul_f32 v[92:93], v[68:69], s[8:9] op_sel_hi:[1,0]
    v_fract_f32 v94, v94
    v_fract_f32 v95, v95
    v_exp_f32 v92, v92
    v_exp_f32 v93, v93
    v_cos_f32 v96, v94
    v_cos_f32 v97, v95
    v_sin_f32 v98, v94
    v_sin_f32 v99, v95
    v_pk_mul_f32 v[96:97], v[96:97], v[92:93]
    v_pk_mul_f32 v[98:99], v[98:99], v[92:93]
    v_cvt_pk_f16_f32 v84, v96, -v98
    v_cvt_pk_f16_f32 v85, v97, -v99
    v_pk_mul_f16 v86, v84, v84 op_sel_hi:[0,1]
    v_pk_mul_f16 v87, v85, v85 op_sel_hi:[0,1]
    v_pk_fma_f16 v122, v84, v84, v86 op_sel:[1,1,0] op_sel_hi:[1,0,1] neg_lo:[0,1,0]
    v_pk_fma_f16 v123, v85, v85, v87 op_sel:[1,1,0] op_sel_hi:[1,0,1] neg_lo:[0,1,0]
    v_pk_mul_f32 v[94:95], v[70:71], s[8:9] op_sel:[0,1] op_sel_hi:[1,1]
    v_pk_mul_f32 v[92:93], v[68:69], s[8:9] op_sel:[0,1] op_sel_hi:[1,1]
    v_fract_f32 v94, v94
    v_fract_f32 v95, v95
    v_exp_f32 v92, v92
    ds_write_addtid_b32 v84 offset:544
    ds_write_addtid_b32 v85 offset:800
    v_pk_mul_f16 v86, v122, v84 op_sel_hi:[0,1]
    v_pk_mul_f16 v87, v123, v85 op_sel_hi:[0,1]
    v_pk_fma_f16 v124, v122, v84, v86 op_sel:[1,1,0] op_sel_hi:[1,0,1] neg_lo:[0,1,0]
    v_pk_fma_f16 v125, v123, v85, v87 op_sel:[1,1,0] op_sel_hi:[1,0,1] neg_lo:[0,1,0]
    v_exp_f32 v93, v93
    v_cos_f32 v96, v94
    v_cos_f32 v97, v95
    v_sin_f32 v98, v94
    v_sin_f32 v99, v95
    ds_write_addtid_b32 v122 offset:1088
    ds_write_addtid_b32 v123 offset:1344
    v_pk_mul_f16 v86, v124, v84 op_sel_hi:[0,1]
    v_pk_mul_f16 v87, v125, v85 op_sel_hi:[0,1]
    v_pk_fma_f16 v126, v124, v84, v86 op_sel:[1,1,0] op_sel_hi:[1,0,1] neg_lo:[0,1,0]
    v_pk_fma_f16 v127, v125, v85, v87 op_sel:[1,1,0] op_sel_hi:[1,0,1] neg_lo:[0,1,0]
    v_pk_mul_f32 v[96:97], v[96:97], v[92:93]
    v_pk_mul_f32 v[98:99], v[98:99], v[92:93]
    v_cvt_pk_f16_f32 v82, v96, v98
    v_cvt_pk_f16_f32 v83, v97, v99
    s_waitcnt vmcnt(0)
    ds_write_addtid_b32 v124 offset:1632
    ds_write_addtid_b32 v125 offset:1888
    v_pk_mul_f16 v86, v126, v84 op_sel_hi:[0,1]
    v_pk_mul_f16 v87, v127, v85 op_sel_hi:[0,1]
    v_pk_fma_f16 v128, v126, v84, v86 op_sel:[1,1,0] op_sel_hi:[1,0,1] neg_lo:[0,1,0]
    v_pk_fma_f16 v129, v127, v85, v87 op_sel:[1,1,0] op_sel_hi:[1,0,1] neg_lo:[0,1,0]
    v_lshlrev_b32 v72, 16, v62
    v_and_b32 v73, s90, v62
    v_lshlrev_b32 v74, 16, v63
    v_and_b32 v75, s90, v63
    v_lshlrev_b32 v76, 16, v64
    ds_write_addtid_b32 v126 offset:2176
    ds_write_addtid_b32 v127 offset:2432
    v_pk_mul_f16 v86, v128, v84 op_sel_hi:[0,1]
    v_pk_mul_f16 v87, v129, v85 op_sel_hi:[0,1]
    v_pk_fma_f16 v130, v128, v84, v86 op_sel:[1,1,0] op_sel_hi:[1,0,1] neg_lo:[0,1,0]
    v_pk_fma_f16 v131, v129, v85, v87 op_sel:[1,1,0] op_sel_hi:[1,0,1] neg_lo:[0,1,0]
    v_and_b32 v77, s90, v64
    v_lshlrev_b32 v78, 16, v65
    v_and_b32 v79, s90, v65
    v_max_f32 v109, v68, v69
    v_cmp_nge_f32 s[14:15], s7, v109
    ds_write_addtid_b32 v128 offset:2720
    ds_write_addtid_b32 v129 offset:2976
    v_pk_mul_f16 v86, v130, v84 op_sel_hi:[0,1]
    v_pk_mul_f16 v87, v131, v85 op_sel_hi:[0,1]
    v_pk_fma_f16 v132, v130, v84, v86 op_sel:[1,1,0] op_sel_hi:[1,0,1] neg_lo:[0,1,0]
    v_pk_fma_f16 v133, v131, v85, v87 op_sel:[1,1,0] op_sel_hi:[1,0,1] neg_lo:[0,1,0]
    v_pk_mul_f32 v[88:89], v[76:77], v[72:73]
    v_pk_mul_f32 v[90:91], v[76:77], v[74:75]
    v_pk_fma_f32 v[88:89], v[78:79], v[74:75], v[88:89] neg_lo:[1,0,0] neg_hi:[1,0,0]
    v_pk_fma_f32 v[90:91], v[78:79], v[72:73], v[90:91]
    v_max_f32_e64 v117, abs(v88), abs(v90)
    ds_write_addtid_b32 v130 offset:3264
    ds_write_addtid_b32 v131 offset:3520
    v_pk_mul_f16 v86, v132, v84 op_sel_hi:[0,1]
    v_pk_mul_f16 v87, v133, v85 op_sel_hi:[0,1]
    v_pk_fma_f16 v134, v132, v84, v86 op_sel:[1,1,0] op_sel_hi:[1,0,1] neg_lo:[0,1,0]
    v_pk_fma_f16 v135, v133, v85, v87 op_sel:[1,1,0] op_sel_hi:[1,0,1] neg_lo:[0,1,0]
    v_max3_f32 v117, v117, abs(v89), abs(v91)
    v_fract_f32 v94, v70
    v_fract_f32 v95, v71
    v_max_f32_dpp v117, v117, v117 row_shr:1 row_mask:0xf bank_mask:0xf
    v_exp_f32 v92, v68
    ds_write_addtid_b32 v132 offset:3808
    ds_write_addtid_b32 v133 offset:4064
    v_pk_mul_f16 v86, v134, v84 op_sel_hi:[0,1]
    v_pk_mul_f16 v87, v135, v85 op_sel_hi:[0,1]
    v_pk_fma_f16 v136, v134, v84, v86 op_sel:[1,1,0] op_sel_hi:[1,0,1] neg_lo:[0,1,0]
    v_pk_fma_f16 v137, v135, v85, v87 op_sel:[1,1,0] op_sel_hi:[1,0,1] neg_lo:[0,1,0]
    v_exp_f32 v93, v69
    v_max_f32_dpp v117, v117, v117 row_shr:2 row_mask:0xf bank_mask:0xf
    v_cos_f32 v96, v94
    v_cos_f32 v97, v95
    v_max_f32_dpp v117, v117, v117 row_shr:4 row_mask:0xf bank_mask:0xf
    ds_write_addtid_b32 v134 offset:4352
    ds_write_addtid_b32 v135 offset:4608
    v_pk_mul_f16 v86, v136, v84 op_sel_hi:[0,1]
    v_pk_mul_f16 v87, v137, v85 op_sel_hi:[0,1]
    v_pk_fma_f16 v138, v136, v84, v86 op_sel:[1,1,0] op_sel_hi:[1,0,1] neg_lo:[0,1,0]
    v_pk_fma_f16 v139, v137, v85, v87 op_sel:[1,1,0] op_sel_hi:[1,0,1] neg_lo:[0,1,0]
    v_sin_f32 v98, v94
    v_sin_f32 v99, v95
    v_max_f32_dpp v117, v117, v117 row_shr:8 row_mask:0xf bank_mask:0xf
    v_pk_mul_f32 v[96:97], v[96:97], v[92:93]
    v_pk_mul_f32 v[98:99], v[98:99], v[92:93]
    ds_write_addtid_b32 v136 offset:4896
    ds_write_addtid_b32 v137 offset:5152
    v_pk_mul_f16 v86, v138, v84 op_sel_hi:[0,1]
    v_pk_mul_f16 v87, v139, v85 op_sel_hi:[0,1]
    v_pk_fma_f16 v140, v138, v84, v86 op_sel:[1,1,0] op_sel_hi:[1,0,1] neg_lo:[0,1,0]
    v_pk_fma_f16 v141, v139, v85, v87 op_sel:[1,1,0] op_sel_hi:[1,0,1] neg_lo:[0,1,0]
    v_max_f32_dpp v117, v117, v117 row_bcast:15 row_mask:0xa bank_mask:0xf
    v_cvt_pk_f16_f32 v80, v96, v98
    v_cvt_pk_f16_f32 v81, v97, v99
    v_max_f32_dpp v117, v117, v117 row_bcast:31 row_mask:0xc bank_mask:0xf
    s_nop 0
    ds_write_addtid_b32 v138 offset:5440
    ds_write_addtid_b32 v139 offset:5696
    v_pk_mul_f16 v86, v140, v84 op_sel_hi:[0,1]
    v_pk_mul_f16 v87, v141, v85 op_sel_hi:[0,1]
    v_pk_fma_f16 v142, v140, v84, v86 op_sel:[1,1,0] op_sel_hi:[1,0,1] neg_lo:[0,1,0]
    v_pk_fma_f16 v143, v141, v85, v87 op_sel:[1,1,0] op_sel_hi:[1,0,1] neg_lo:[0,1,0]
    v_readlane_b32 s10, v117, 63
    s_nop 0
    s_nop 0
    s_lshr_b32 s10, s10, 23
    s_max_u32 s10, s10, 30
    ds_write_addtid_b32 v140 offset:5984
    ds_write_addtid_b32 v141 offset:6240
    v_pk_mul_f16 v86, v142, v84 op_sel_hi:[0,1]
    v_pk_mul_f16 v87, v143, v85 op_sel_hi:[0,1]
    v_pk_fma_f16 v144, v142, v84, v86 op_sel:[1,1,0] op_sel_hi:[1,0,1] neg_lo:[0,1,0]
    v_pk_fma_f16 v145, v143, v85, v87 op_sel:[1,1,0] op_sel_hi:[1,0,1] neg_lo:[0,1,0]
    s_min_u32 s10, s10, 250
    s_sub_u32 s11, s10, 13
    s_lshl_b32 s11, s11, 23
    s_sub_u32 s10, 267, s10
    s_lshl_b32 s10, s10, 23
    ds_write_addtid_b32 v142 offset:6528
    ds_write_addtid_b32 v143 offset:6784
    v_pk_mul_f16 v86, v144, v84 op_sel_hi:[0,1]
    v_pk_mul_f16 v87, v145, v85 op_sel_hi:[0,1]
    v_pk_fma_f16 v146, v144, v84, v86 op_sel:[1,1,0] op_sel_hi:[1,0,1] neg_lo:[0,1,0]
    v_pk_fma_f16 v147, v145, v85, v87 op_sel:[1,1,0] op_sel_hi:[1,0,1] neg_lo:[0,1,0]
    v_mul_f32 v118, s11, v118
    v_pk_mul_f32 v[88:89], v[88:89], s[10:11] op_sel_hi:[1,0]
    v_pk_mul_f32 v[90:91], v[90:91], s[10:11] op_sel_hi:[1,0]
    v_cvt_pk_f16_f32 v120, v88, v90
    v_cvt_pk_f16_f32 v121, v89, v91
    ds_write_addtid_b32 v144 offset:7072
    ds_write_addtid_b32 v145 offset:7328
    v_pk_mul_f16 v86, v146, v84 op_sel_hi:[0,1]
    v_pk_mul_f16 v87, v147, v85 op_sel_hi:[0,1]
    v_pk_fma_f16 v148, v146, v84, v86 op_sel:[1,1,0] op_sel_hi:[1,0,1] neg_lo:[0,1,0]
    v_pk_fma_f16 v149, v147, v85, v87 op_sel:[1,1,0] op_sel_hi:[1,0,1] neg_lo:[0,1,0]
    ds_write_addtid_b32 v146 offset:7616
    ds_write_addtid_b32 v147 offset:7872
    v_pk_mul_f16 v86, v120, v80 op_sel_hi:[0,1]
    v_pk_mul_f16 v87, v121, v81 op_sel_hi:[0,1]
    v_pk_fma_f16 v150, v120, v80, v86 op_sel:[1,1,0] op_sel_hi:[1,0,1] neg_lo:[0,1,0]
    v_pk_fma_f16 v151, v121, v81, v87 op_sel:[1,1,0] op_sel_hi:[1,0,1] neg_lo:[0,1,0]
    ds_write_addtid_b32 v148 offset:8160
    ds_write_addtid_b32 v149 offset:8416
    ds_read_b128 v[184:187], v112 offset:0
    v_pk_mul_f16 v86, v150, v80 op_sel_hi:[0,1]
    v_pk_mul_f16 v87, v151, v81 op_sel_hi:[0,1]
    v_pk_fma_f16 v152, v150, v80, v86 op_sel:[1,1,0] op_sel_hi:[1,0,1] neg_lo:[0,1,0]
    v_pk_fma_f16 v153, v151, v81, v87 op_sel:[1,1,0] op_sel_hi:[1,0,1] neg_lo:[0,1,0]
    ds_read_b128 v[188:191], v112 offset:64
    ds_read_b128 v[192:195], v112 offset:128
    v_pk_mul_f16 v86, v152, v80 op_sel_hi:[0,1]
    v_pk_mul_f16 v87, v153, v81 op_sel_hi:[0,1]
    v_pk_fma_f16 v154, v152, v80, v86 op_sel:[1,1,0] op_sel_hi:[1,0,1] neg_lo:[0,1,0]
    v_pk_fma_f16 v155, v153, v81, v87 op_sel:[1,1,0] op_sel_hi:[1,0,1] neg_lo:[0,1,0]
    ds_read_b128 v[196:199], v112 offset:192
    ds_read_b128 v[200:203], v112 offset:256
    v_pk_mul_f16 v86, v154, v80 op_sel_hi:[0,1]
    v_pk_mul_f16 v87, v155, v81 op_sel_hi:[0,1]
    v_pk_fma_f16 v156, v154, v80, v86 op_sel:[1,1,0] op_sel_hi:[1,0,1] neg_lo:[0,1,0]
    v_pk_fma_f16 v157, v155, v81, v87 op_sel:[1,1,0] op_sel_hi:[1,0,1] neg_lo:[0,1,0]
    ds_read_b128 v[204:207], v112 offset:320
    ds_read_b128 v[208:211], v112 offset:384
    v_pk_mul_f16 v86, v156, v80 op_sel_hi:[0,1]
    v_pk_mul_f16 v87, v157, v81 op_sel_hi:[0,1]
    v_pk_fma_f16 v158, v156, v80, v86 op_sel:[1,1,0] op_sel_hi:[1,0,1] neg_lo:[0,1,0]
    v_pk_fma_f16 v159, v157, v81, v87 op_sel:[1,1,0] op_sel_hi:[1,0,1] neg_lo:[0,1,0]
    ds_read_b128 v[212:215], v112 offset:448
    ds_write_addtid_b32 v120 offset:0
    ds_write_addtid_b32 v121 offset:256
    v_pk_mul_f16 v86, v158, v80 op_sel_hi:[0,1]
    v_pk_mul_f16 v87, v159, v81 op_sel_hi:[0,1]
    v_pk_fma_f16 v160, v158, v80, v86 op_sel:[1,1,0] op_sel_hi:[1,0,1] neg_lo:[0,1,0]
    v_pk_fma_f16 v161, v159, v81, v87 op_sel:[1,1,0] op_sel_hi:[1,0,1] neg_lo:[0,1,0]
    ds_write_addtid_b32 v150 offset:544
    ds_write_addtid_b32 v151 offset:800
    ds_write_addtid_b32 v152 offset:1088
    ds_write_addtid_b32 v153 offset:1344
    v_pk_mul_f16 v86, v160, v80 op_sel_hi:[0,1]
    v_pk_mul_f16 v87, v161, v81 op_sel_hi:[0,1]
    v_pk_fma_f16 v162, v160, v80, v86 op_sel:[1,1,0] op_sel_hi:[1,0,1] neg_lo:[0,1,0]
    v_pk_fma_f16 v163, v161, v81, v87 op_sel:[1,1,0] op_sel_hi:[1,0,1] neg_lo:[0,1,0]
    ds_write_addtid_b32 v154 offset:1632
    ds_write_addtid_b32 v155 offset:1888
    ds_write_addtid_b32 v156 offset:2176
    ds_write_addtid_b32 v157 offset:2432
    v_pk_mul_f16 v86, v120, v82 op_sel_hi:[0,1]
    v_pk_mul_f16 v87, v121, v83 op_sel_hi:[0,1]
    v_pk_fma_f16 v164, v120, v82, v86 op_sel:[1,1,0] op_sel_hi:[1,0,1] neg_lo:[0,1,0]
    v_pk_fma_f16 v165, v121, v83, v87 op_sel:[1,1,0] op_sel_hi:[1,0,1] neg_lo:[0,1,0]
    ds_write_addtid_b32 v158 offset:2720
    ds_write_addtid_b32 v159 offset:2976
    ds_write_addtid_b32 v160 offset:3264
    ds_write_addtid_b32 v161 offset:3520
    v_pk_mul_f16 v86, v150, v82 op_sel_hi:[0,1]
    v_pk_mul_f16 v87, v151, v83 op_sel_hi:[0,1]
    v_pk_fma_f16 v166, v150, v82, v86 op_sel:[1,1,0] op_sel_hi:[1,0,1] neg_lo:[0,1,0]
    v_pk_fma_f16 v167, v151, v83, v87 op_sel:[1,1,0] op_sel_hi:[1,0,1] neg_lo:[0,1,0]
    ds_write_addtid_b32 v162 offset:3808
    ds_write_addtid_b32 v163 offset:4064
    ds_write_addtid_b32 v164 offset:4352
    ds_write_addtid_b32 v165 offset:4608
    v_pk_mul_f16 v86, v152, v82 op_sel_hi:[0,1]
    v_pk_mul_f16 v87, v153, v83 op_sel_hi:[0,1]
    v_pk_fma_f16 v168, v152, v82, v86 op_sel:[1,1,0] op_sel_hi:[1,0,1] neg_lo:[0,1,0]
    v_pk_fma_f16 v169, v153, v83, v87 op_sel:[1,1,0] op_sel_hi:[1,0,1] neg_lo:[0,1,0]
    ds_write_addtid_b32 v166 offset:4896
    ds_write_addtid_b32 v167 offset:5152
    v_pk_mul_f16 v86, v154, v82 op_sel_hi:[0,1]
    v_pk_mul_f16 v87, v155, v83 op_sel_hi:[0,1]
    v_pk_fma_f16 v170, v154, v82, v86 op_sel:[1,1,0] op_sel_hi:[1,0,1] neg_lo:[0,1,0]
    v_pk_fma_f16 v171, v155, v83, v87 op_sel:[1,1,0] op_sel_hi:[1,0,1] neg_lo:[0,1,0]
    ds_write_addtid_b32 v168 offset:5440
    ds_write_addtid_b32 v169 offset:5696
    v_pk_mul_f16 v86, v156, v82 op_sel_hi:[0,1]
    v_pk_mul_f16 v87, v157, v83 op_sel_hi:[0,1]
    v_pk_fma_f16 v172, v156, v82, v86 op_sel:[1,1,0] op_sel_hi:[1,0,1] neg_lo:[0,1,0]
    v_pk_fma_f16 v173, v157, v83, v87 op_sel:[1,1,0] op_sel_hi:[1,0,1] neg_lo:[0,1,0]
    ds_write_addtid_b32 v170 offset:5984
    ds_write_addtid_b32 v171 offset:6240
    v_pk_mul_f16 v86, v158, v82 op_sel_hi:[0,1]
    v_pk_mul_f16 v87, v159, v83 op_sel_hi:[0,1]
    v_pk_fma_f16 v174, v158, v82, v86 op_sel:[1,1,0] op_sel_hi:[1,0,1] neg_lo:[0,1,0]
    v_pk_fma_f16 v175, v159, v83, v87 op_sel:[1,1,0] op_sel_hi:[1,0,1] neg_lo:[0,1,0]
    ds_write_addtid_b32 v172 offset:6528
    ds_write_addtid_b32 v173 offset:6784
    v_pk_mul_f16 v86, v160, v82 op_sel_hi:[0,1]
    v_pk_mul_f16 v87, v161, v83 op_sel_hi:[0,1]
    v_pk_fma_f16 v122, v160, v82, v86 op_sel:[1,1,0] op_sel_hi:[1,0,1] neg_lo:[0,1,0]
    v_pk_fma_f16 v123, v161, v83, v87 op_sel:[1,1,0] op_sel_hi:[1,0,1] neg_lo:[0,1,0]
    ds_write_addtid_b32 v174 offset:7072
    ds_write_addtid_b32 v175 offset:7328
    s_setprio 2
    v_pk_mul_f16 v86, v162, v82 op_sel_hi:[0,1]
    v_pk_mul_f16 v87, v163, v83 op_sel_hi:[0,1]
    v_pk_fma_f16 v124, v162, v82, v86 op_sel:[1,1,0] op_sel_hi:[1,0,1] neg_lo:[0,1,0]
    v_pk_fma_f16 v125, v163, v83, v87 op_sel:[1,1,0] op_sel_hi:[1,0,1] neg_lo:[0,1,0]
    ds_write_addtid_b32 v122 offset:7616
    ds_write_addtid_b32 v123 offset:7872
    v_pk_mul_f16 v86, v164, v82 op_sel_hi:[0,1]
    v_pk_mul_f16 v87, v165, v83 op_sel_hi:[0,1]
    v_pk_fma_f16 v126, v164, v82, v86 op_sel:[1,1,0] op_sel_hi:[1,0,1] neg_lo:[0,1,0]
    v_pk_fma_f16 v127, v165, v83, v87 op_sel:[1,1,0] op_sel_hi:[1,0,1] neg_lo:[0,1,0]
    ds_write_addtid_b32 v124 offset:8160
    ds_write_addtid_b32 v125 offset:8416
    ds_read_b128 v[216:219], v112 offset:0
    v_pk_mul_f16 v86, v168, v82 op_sel_hi:[0,1]
    v_pk_mul_f16 v87, v169, v83 op_sel_hi:[0,1]
    v_pk_fma_f16 v128, v168, v82, v86 op_sel:[1,1,0] op_sel_hi:[1,0,1] neg_lo:[0,1,0]
    v_pk_fma_f16 v129, v169, v83, v87 op_sel:[1,1,0] op_sel_hi:[1,0,1] neg_lo:[0,1,0]
    ds_read_b128 v[220:223], v112 offset:64
    ds_read_b128 v[224:227], v112 offset:128
    v_pk_mul_f16 v86, v172, v82 op_sel_hi:[0,1]
    v_pk_mul_f16 v87, v173, v83 op_sel_hi:[0,1]
    v_pk_fma_f16 v130, v172, v82, v86 op_sel:[1,1,0] op_sel_hi:[1,0,1] neg_lo:[0,1,0]
    v_pk_fma_f16 v131, v173, v83, v87 op_sel:[1,1,0] op_sel_hi:[1,0,1] neg_lo:[0,1,0]
    ds_read_b128 v[228:231], v112 offset:192
    ds_read_b128 v[232:235], v112 offset:256
    v_pk_mul_f16 v86, v122, v82 op_sel_hi:[0,1]
    v_pk_mul_f16 v87, v123, v83 op_sel_hi:[0,1]
    v_pk_fma_f16 v132, v122, v82, v86 op_sel:[1,1,0] op_sel_hi:[1,0,1] neg_lo:[0,1,0]
    v_pk_fma_f16 v133, v123, v83, v87 op_sel:[1,1,0] op_sel_hi:[1,0,1] neg_lo:[0,1,0]
    ds_read_b128 v[236:239], v112 offset:320
    ds_read_b128 v[240:243], v112 offset:384
    v_pk_mul_f16 v86, v126, v82 op_sel_hi:[0,1]
    v_pk_mul_f16 v87, v127, v83 op_sel_hi:[0,1]
    v_pk_fma_f16 v134, v126, v82, v86 op_sel:[1,1,0] op_sel_hi:[1,0,1] neg_lo:[0,1,0]
    v_pk_fma_f16 v135, v127, v83, v87 op_sel:[1,1,0] op_sel_hi:[1,0,1] neg_lo:[0,1,0]
    ds_read_b128 v[244:247], v112 offset:448
    ds_write_addtid_b32 v126 offset:0
    ds_write_addtid_b32 v127 offset:256
    s_waitcnt lgkmcnt(2)
    v_mfma_f32_16x16x32_f16 v[248:251], v[216:219], v[184:187], 0
    v_mfma_f32_16x16x32_f16 v[248:251], v[220:223], v[188:191], v[248:251]
    v_pk_mul_f16 v86, v128, v82 op_sel_hi:[0,1]
    v_pk_mul_f16 v87, v129, v83 op_sel_hi:[0,1]
    v_pk_fma_f16 v136, v128, v82, v86 op_sel:[1,1,0] op_sel_hi:[1,0,1] neg_lo:[0,1,0]
    v_pk_fma_f16 v137, v129, v83, v87 op_sel:[1,1,0] op_sel_hi:[1,0,1] neg_lo:[0,1,0]
    ds_write_addtid_b32 v128 offset:544
    ds_write_addtid_b32 v129 offset:800
    ds_write_addtid_b32 v130 offset:1088
    ds_write_addtid_b32 v131 offset:1344
    v_mfma_f32_16x16x32_f16 v[248:251], v[224:227], v[192:195], v[248:251]
    v_mfma_f32_16x16x32_f16 v[248:251], v[228:231], v[196:199], v[248:251]
    v_pk_mul_f16 v86, v130, v82 op_sel_hi:[0,1]
    v_pk_mul_f16 v87, v131, v83 op_sel_hi:[0,1]
    v_pk_fma_f16 v138, v130, v82, v86 op_sel:[1,1,0] op_sel_hi:[1,0,1] neg_lo:[0,1,0]
    v_pk_fma_f16 v139, v131, v83, v87 op_sel:[1,1,0] op_sel_hi:[1,0,1] neg_lo:[0,1,0]
    ds_write_addtid_b32 v132 offset:1632
    ds_write_addtid_b32 v133 offset:1888
    ds_write_addtid_b32 v134 offset:2176
    ds_write_addtid_b32 v135 offset:2432
    v_mfma_f32_16x16x32_f16 v[248:251], v[232:235], v[200:203], v[248:251]
    v_mfma_f32_16x16x32_f16 v[248:251], v[236:239], v[204:207], v[248:251]
    v_pk_mul_f16 v86, v132, v82 op_sel_hi:[0,1]
    v_pk_mul_f16 v87, v133, v83 op_sel_hi:[0,1]
    v_pk_fma_f16 v140, v132, v82, v86 op_sel:[1,1,0] op_sel_hi:[1,0,1] neg_lo:[0,1,0]
    v_pk_fma_f16 v141, v133, v83, v87 op_sel:[1,1,0] op_sel_hi:[1,0,1] neg_lo:[0,1,0]
    ds_write_addtid_b32 v136 offset:2720
    ds_write_addtid_b32 v137 offset:2976
    ds_write_addtid_b32 v138 offset:3264
    ds_write_addtid_b32 v139 offset:3520
    v_mfma_f32_16x16x32_f16 v[248:251], v[240:243], v[208:211], v[248:251]
    v_mfma_f32_16x16x32_f16 v[248:251], v[244:247], v[212:215], v[248:251]
    v_pk_mul_f16 v86, v134, v82 op_sel_hi:[0,1]
    v_pk_mul_f16 v87, v135, v83 op_sel_hi:[0,1]
    v_pk_fma_f16 v142, v134, v82, v86 op_sel:[1,1,0] op_sel_hi:[1,0,1] neg_lo:[0,1,0]
    v_pk_fma_f16 v143, v135, v83, v87 op_sel:[1,1,0] op_sel_hi:[1,0,1] neg_lo:[0,1,0]
    ds_write_addtid_b32 v140 offset:3808
    ds_write_addtid_b32 v141 offset:4064
    v_pk_mul_f16 v86, v138, v82 op_sel_hi:[0,1]
    v_pk_mul_f16 v87, v139, v83 op_sel_hi:[0,1]
    v_pk_fma_f16 v144, v138, v82, v86 op_sel:[1,1,0] op_sel_hi:[1,0,1] neg_lo:[0,1,0]
    v_pk_fma_f16 v145, v139, v83, v87 op_sel:[1,1,0] op_sel_hi:[1,0,1] neg_lo:[0,1,0]
    ds_write_addtid_b32 v142 offset:4352
    ds_write_addtid_b32 v143 offset:4608
    v_pk_mul_f16 v86, v142, v82 op_sel_hi:[0,1]
    v_pk_mul_f16 v87, v143, v83 op_sel_hi:[0,1]
    v_pk_fma_f16 v146, v142, v82, v86 op_sel:[1,1,0] op_sel_hi:[1,0,1] neg_lo:[0,1,0]
    v_pk_fma_f16 v147, v143, v83, v87 op_sel:[1,1,0] op_sel_hi:[1,0,1] neg_lo:[0,1,0]
    ds_write_addtid_b32 v144 offset:4896
    ds_write_addtid_b32 v145 offset:5152
    v_pk_mul_f16 v86, v144, v82 op_sel_hi:[0,1]
    v_pk_mul_f16 v87, v145, v83 op_sel_hi:[0,1]
    v_pk_fma_f16 v148, v144, v82, v86 op_sel:[1,1,0] op_sel_hi:[1,0,1] neg_lo:[0,1,0]
    v_pk_fma_f16 v149, v145, v83, v87 op_sel:[1,1,0] op_sel_hi:[1,0,1] neg_lo:[0,1,0]
    ds_write_addtid_b32 v146 offset:5440
    ds_write_addtid_b32 v147 offset:5696
    v_pk_mul_f16 v86, v146, v82 op_sel_hi:[0,1]
    v_pk_mul_f16 v87, v147, v83 op_sel_hi:[0,1]
    v_pk_fma_f16 v150, v146, v82, v86 op_sel:[1,1,0] op_sel_hi:[1,0,1] neg_lo:[0,1,0]
    v_pk_fma_f16 v151, v147, v83, v87 op_sel:[1,1,0] op_sel_hi:[1,0,1] neg_lo:[0,1,0]
    ds_write_addtid_b32 v148 offset:5984
    ds_write_addtid_b32 v149 offset:6240
    v_pk_mul_f16 v86, v148, v82 op_sel_hi:[0,1]
    v_pk_mul_f16 v87, v149, v83 op_sel_hi:[0,1]
    v_pk_fma_f16 v152, v148, v82, v86 op_sel:[1,1,0] op_sel_hi:[1,0,1] neg_lo:[0,1,0]
    v_pk_fma_f16 v153, v149, v83, v87 op_sel:[1,1,0] op_sel_hi:[1,0,1] neg_lo:[0,1,0]
    ds_write_addtid_b32 v150 offset:6528
    ds_write_addtid_b32 v151 offset:6784
    v_pk_mul_f16 v86, v150, v82 op_sel_hi:[0,1]
    v_pk_mul_f16 v87, v151, v83 op_sel_hi:[0,1]
    v_pk_fma_f16 v154, v150, v82, v86 op_sel:[1,1,0] op_sel_hi:[1,0,1] neg_lo:[0,1,0]
    v_pk_fma_f16 v155, v151, v83, v87 op_sel:[1,1,0] op_sel_hi:[1,0,1] neg_lo:[0,1,0]
    ds_write_addtid_b32 v152 offset:7072
    ds_write_addtid_b32 v153 offset:7328
    v_pk_mul_f16 v86, v152, v82 op_sel_hi:[0,1]
    v_pk_mul_f16 v87, v153, v83 op_sel_hi:[0,1]
    v_pk_fma_f16 v156, v152, v82, v86 op_sel:[1,1,0] op_sel_hi:[1,0,1] neg_lo:[0,1,0]
    v_pk_fma_f16 v157, v153, v83, v87 op_sel:[1,1,0] op_sel_hi:[1,0,1] neg_lo:[0,1,0]
    ds_write_addtid_b32 v154 offset:7616
    ds_write_addtid_b32 v155 offset:7872
    v_pk_mul_f16 v86, v154, v82 op_sel_hi:[0,1]
    v_pk_mul_f16 v87, v155, v83 op_sel_hi:[0,1]
    v_pk_fma_f16 v158, v154, v82, v86 op_sel:[1,1,0] op_sel_hi:[1,0,1] neg_lo:[0,1,0]
    v_pk_fma_f16 v159, v155, v83, v87 op_sel:[1,1,0] op_sel_hi:[1,0,1] neg_lo:[0,1,0]
    ds_write_addtid_b32 v156 offset:8160
    ds_write_addtid_b32 v157 offset:8416
    ds_read_b128 v[216:219], v112 offset:0
    v_pk_mul_f16 v86, v158, v82 op_sel_hi:[0,1]
    v_pk_mul_f16 v87, v159, v83 op_sel_hi:[0,1]
    v_pk_fma_f16 v160, v158, v82, v86 op_sel:[1,1,0] op_sel_hi:[1,0,1] neg_lo:[0,1,0]
    v_pk_fma_f16 v161, v159, v83, v87 op_sel:[1,1,0] op_sel_hi:[1,0,1] neg_lo:[0,1,0]
    ds_read_b128 v[220:223], v112 offset:64
    ds_read_b128 v[224:227], v112 offset:128
    v_pk_mul_f16 v86, v160, v82 op_sel_hi:[0,1]
    v_pk_mul_f16 v87, v161, v83 op_sel_hi:[0,1]
    v_pk_fma_f16 v162, v160, v82, v86 op_sel:[1,1,0] op_sel_hi:[1,0,1] neg_lo:[0,1,0]
    v_pk_fma_f16 v163, v161, v83, v87 op_sel:[1,1,0] op_sel_hi:[1,0,1] neg_lo:[0,1,0]
    ds_read_b128 v[228:231], v112 offset:192
    ds_read_b128 v[232:235], v112 offset:256
    v_pk_mul_f16 v86, v162, v82 op_sel_hi:[0,1]
    v_pk_mul_f16 v87, v163, v83 op_sel_hi:[0,1]
    v_pk_fma_f16 v164, v162, v82, v86 op_sel:[1,1,0] op_sel_hi:[1,0,1] neg_lo:[0,1,0]
    v_pk_fma_f16 v165, v163, v83, v87 op_sel:[1,1,0] op_sel_hi:[1,0,1] neg_lo:[0,1,0]
    ds_read_b128 v[236:239], v112 offset:320
    ds_read_b128 v[240:243], v112 offset:384
    v_pk_mul_f16 v86, v164, v82 op_sel_hi:[0,1]
    v_pk_mul_f16 v87, v165, v83 op_sel_hi:[0,1]
    v_pk_fma_f16 v166, v164, v82, v86 op_sel:[1,1,0] op_sel_hi:[1,0,1] neg_lo:[0,1,0]
    v_pk_fma_f16 v167, v165, v83, v87 op_sel:[1,1,0] op_sel_hi:[1,0,1] neg_lo:[0,1,0]
    ds_read_b128 v[244:247], v112 offset:448
    ds_write_addtid_b32 v158 offset:0
    ds_write_addtid_b32 v159 offset:256
    s_waitcnt lgkmcnt(2)
    v_mfma_f32_16x16x32_f16 v[252:255], v[216:219], v[184:187], 0
    v_mfma_f32_16x16x32_f16 v[252:255], v[220:223], v[188:191], v[252:255]
    v_pk_mul_f16 v86, v166, v82 op_sel_hi:[0,1]
    v_pk_mul_f16 v87, v167, v83 op_sel_hi:[0,1]
    v_pk_fma_f16 v168, v166, v82, v86 op_sel:[1,1,0] op_sel_hi:[1,0,1] neg_lo:[0,1,0]
    v_pk_fma_f16 v169, v167, v83, v87 op_sel:[1,1,0] op_sel_hi:[1,0,1] neg_lo:[0,1,0]
    ds_write_addtid_b32 v160 offset:544
    ds_write_addtid_b32 v161 offset:800
    ds_write_addtid_b32 v162 offset:1088
    ds_write_addtid_b32 v163 offset:1344
    v_mfma_f32_16x16x32_f16 v[252:255], v[224:227], v[192:195], v[252:255]
    v_mfma_f32_16x16x32_f16 v[252:255], v[228:231], v[196:199], v[252:255]
    v_pk_mul_f16 v86, v168, v82 op_sel_hi:[0,1]
    v_pk_mul_f16 v87, v169, v83 op_sel_hi:[0,1]
    v_pk_fma_f16 v170, v168, v82, v86 op_sel:[1,1,0] op_sel_hi:[1,0,1] neg_lo:[0,1,0]
    v_pk_fma_f16 v171, v169, v83, v87 op_sel:[1,1,0] op_sel_hi:[1,0,1] neg_lo:[0,1,0]
    ds_write_addtid_b32 v164 offset:1632
    ds_write_addtid_b32 v165 offset:1888
    ds_write_addtid_b32 v166 offset:2720
    ds_write_addtid_b32 v167 offset:2976
    v_mfma_f32_16x16x32_f16 v[252:255], v[232:235], v[200:203], v[252:255]
    v_mfma_f32_16x16x32_f16 v[252:255], v[236:239], v[204:207], v[252:255]
    v_pk_mul_f16 v86, v170, v82 op_sel_hi:[0,1]
    v_pk_mul_f16 v87, v171, v83 op_sel_hi:[0,1]
    v_pk_fma_f16 v172, v170, v82, v86 op_sel:[1,1,0] op_sel_hi:[1,0,1] neg_lo:[0,1,0]
    v_pk_fma_f16 v173, v171, v83, v87 op_sel:[1,1,0] op_sel_hi:[1,0,1] neg_lo:[0,1,0]
    ds_write_addtid_b32 v168 offset:3264
    ds_write_addtid_b32 v169 offset:3520
    ds_write_addtid_b32 v170 offset:3808
    ds_write_addtid_b32 v171 offset:4064
    v_mfma_f32_16x16x32_f16 v[252:255], v[240:243], v[208:211], v[252:255]
    v_mfma_f32_16x16x32_f16 v[252:255], v[244:247], v[212:215], v[252:255]
    v_pk_mul_f16 v86, v172, v82 op_sel_hi:[0,1]
    v_pk_mul_f16 v87, v173, v83 op_sel_hi:[0,1]
    v_pk_fma_f16 v174, v172, v82, v86 op_sel:[1,1,0] op_sel_hi:[1,0,1] neg_lo:[0,1,0]
    v_pk_fma_f16 v175, v173, v83, v87 op_sel:[1,1,0] op_sel_hi:[1,0,1] neg_lo:[0,1,0]
    ds_write_addtid_b32 v172 offset:4896
    ds_write_addtid_b32 v173 offset:5152
    ds_write_addtid_b32 v174 offset:5440
    ds_write_addtid_b32 v175 offset:5696
    ds_read_b128 v[216:219], v114 offset:0
    ds_read_b128 v[220:223], v114 offset:64
    ds_read_b128 v[224:227], v114 offset:128
    ds_read_b128 v[228:231], v114 offset:192
    ds_read_b128 v[232:235], v114 offset:256
    ds_read_b128 v[236:239], v114 offset:320
    ds_read_b128 v[240:243], v114 offset:384
    ds_read_b128 v[244:247], v114 offset:448
    s_cmp_lg_u64 s[14:15], 0
    s_cbranch_scc1 L_direct16
L_back17:
    v_mul_f32 v254, v118, v254
    v_mul_f32 v252, v118, v252
    v_mul_f32 v253, v118, v253
    v_mul_f32 v255, v118, v255
    v_mov_b32_dpp v69, v254 row_ror:15 row_mask:0xf bank_mask:0xf
    v_fma_f32 v248, v248, v118, v113
    v_mul_f32 v249, v118, v249
    v_mul_f32 v250, v118, v250
    v_mul_f32 v251, v118, v251
    v_mov_b32_dpp v69, v252 row_shl:1 row_mask:0xf bank_mask:0xf
    v_mov_b32 v70, 0
    s_waitcnt lgkmcnt(0)
    v_mfma_f32_16x16x32_f16 v[100:103], v[216:219], v[184:187], 0
    v_cvt_pk_bf16_f32 v132, v248, v249
    v_cvt_pk_bf16_f32 v133, v250, v251
    v_mfma_f32_16x16x32_f16 v[100:103], v[220:223], v[188:191], v[100:103]
    v_cvt_pk_bf16_f32 v134, v249, v250
    v_cndmask_b32 v73, v253, v252, s[70:71]
    v_mfma_f32_16x16x32_f16 v[100:103], v[224:227], v[192:195], v[100:103]
    v_cndmask_b32 v74, v254, v253, s[70:71]
    v_cndmask_b32 v75, v255, v69, s[70:71]
    v_mfma_f32_16x16x32_f16 v[100:103], v[228:231], v[196:199], v[100:103]
    v_cndmask_b32 v76, 0, v254, s[70:71]
    v_cndmask_b32 v77, 0, v255, s[70:71]
    v_mfma_f32_16x16x32_f16 v[100:103], v[232:235], v[200:203], v[100:103]
    v_cvt_pk_bf16_f32 v136, v252, v252
    v_cvt_pk_bf16_f32 v137, v252, v73
    v_mfma_f32_16x16x32_f16 v[100:103], v[236:239], v[204:207], v[100:103]
    v_cvt_pk_bf16_f32 v138, v74, v74
    v_cvt_pk_bf16_f32 v139, v74, v75
    v_mfma_f32_16x16x32_f16 v[100:103], v[240:243], v[208:211], v[100:103]
    v_cvt_pk_bf16_f32 v140, v76, v76
    v_cvt_pk_bf16_f32 v141, v76, v77
    v_mfma_f32_16x16x32_f16 v[100:103], v[244:247], v[212:215], v[100:103]
    v_cvt_pk_bf16_f32 v142, v77, v77
    ds_write_b128 v106, v[136:139] offset:5024
    ds_read_b128 v[12:15], v5
    v_cvt_pk_bf16_f32 v137, v73, v74
    s_nop 3
    s_cbranch_scc1 L_fix18
L_back19:
    v_mul_f32 v103, v118, v103
    v_mul_f32 v101, v118, v101
    v_mul_f32 v102, v118, v102
    v_mul_f32 v100, v118, v100
    v_mov_b32_dpp v68, v103 row_ror:15 row_mask:0xf bank_mask:0xf
    v_mov_b32_dpp v70, v103 row_ror:15 row_mask:0xc bank_mask:0xf
    v_mov_b32_dpp v71, v101 row_ror:15 row_mask:0xf bank_mask:0xf
    v_mov_b32_dpp v72, v102 row_ror:15 row_mask:0xf bank_mask:0xf
    v_mov_b32_dpp v68, v252 row_shl:1 row_mask:0xf bank_mask:0xf
    v_mov_b32_dpp v70, v254 row_shl:1 row_mask:0xc bank_mask:0xf
    v_mov_b32_dpp v71, v100 row_shl:1 row_mask:0xf bank_mask:0xf
    v_mov_b32_dpp v72, v101 row_shl:1 row_mask:0xf bank_mask:0xf
    v_cndmask_b32 v68, v68, v69, s[70:71]
    v_cvt_pk_bf16_f32 v143, v70, v70
    v_cvt_pk_bf16_f32 v139, v75, v68
    ds_write_b128 v108, v[140:143] offset:0
    ds_write_b128 v106, v[136:139] offset:448
    v_cvt_pk_bf16_f32 v141, v76, v76
    v_cvt_pk_bf16_f32 v143, v77, v70
    v_cndmask_b32 v73, v100, v71, s[68:69]
    v_cndmask_b32 v74, v101, v72, s[68:69]
    v_cvt_pk_bf16_f32 v144, v100, v100
    v_cvt_pk_bf16_f32 v145, v100, v100
    v_cvt_pk_bf16_f32 v146, v73, v71
    v_cvt_pk_bf16_f32 v147, v71, v71
    v_cvt_pk_bf16_f32 v148, v101, v101
    v_cvt_pk_bf16_f32 v149, v101, v101
    v_cvt_pk_bf16_f32 v150, v74, v72
    v_cvt_pk_bf16_f32 v151, v72, v72
    ds_write_b128 v108, v[140:143] offset:4576
    ds_write_b64 v107, v[132:133] offset:448
    ds_write_b16 v107, v132 offset:5026
    ds_write_b32 v107, v134 offset:5028
    ds_write_b16_d16_hi v107, v133 offset:5032
    ds_write_b128 v105, v[144:147] offset:2496
    ds_write_b128 v105, v[148:151] offset:2752
    v_cvt_pk_bf16_f32 v146, v100, v73
    v_cvt_pk_bf16_f32 v150, v101, v74
    ds_write_b128 v105, v[144:147] offset:7072
    ds_write_b128 v105, v[148:151] offset:7328
    s_waitcnt lgkmcnt(11)
    v_min3_u32 v12, v12, v13, v14
    v_min_u32 v12, v12, v15
    s_nop 0
    v_readfirstlane_b32 s86, v12
    s_cmp_ge_u32 s86, 1
    s_cbranch_scc1 L_ok21
L_spin22:
    s_sleep 1
    ds_read_b128 v[12:15], v5
    s_waitcnt lgkmcnt(0)
    v_min3_u32 v12, v12, v13, v14
    v_min_u32 v12, v12, v15
    s_nop 0
    v_readfirstlane_b32 s86, v12
    s_cmp_ge_u32 s86, 1
    s_cbranch_scc0 L_spin22
L_ok21:
    ds_read_b64 v[140:141], v8 offset:3640
    ds_read_b64 v[142:143], v8 offset:3648
    ds_read_b128 v[128:131], v7 offset:0
    ds_read_b64 v[172:173], v8 offset:3128
    ds_read_b64 v[174:175], v8 offset:3136
    ds_read_b128 v[160:163], v7 offset:512
    ds_read_b128 v[88:91], v7 offset:1024
    ds_read_b128 v[92:95], v7 offset:1536
    ds_read_b128 v[144:147], v7 offset:2048
    ds_read_b128 v[176:179], v7 offset:2560
    ds_read_b128 v[148:151], v7 offset:3072
    ds_read_b128 v[180:183], v7 offset:3584
    s_setprio 0
    s_waitcnt lgkmcnt(9)
    v_mfma_f32_16x16x32_bf16 v[64:67], v[128:131], v[140:143], 0
    ds_read_b64 v[152:153], v8 offset:3704
    s_waitcnt lgkmcnt(8)
    v_mfma_f32_16x16x32_bf16 v[68:71], v[128:131], v[172:175], 0
    ds_read_b64 v[154:155], v8 offset:3712
    s_waitcnt lgkmcnt(8)
    v_mfma_f32_16x16x32_bf16 v[68:71], v[160:163], v[140:143], v[68:71]
    ds_read_b128 v[132:135], v7 offset:64
    v_mfma_f32_16x16x32_bf16 v[72:75], v[160:163], v[172:175], 0
    ds_read_b64 v[184:185], v8 offset:3192
    s_waitcnt lgkmcnt(9)
    v_mfma_f32_16x16x32_bf16 v[72:75], v[88:91], v[140:143], v[72:75]
    ds_read_b64 v[186:187], v8 offset:3200
    v_mfma_f32_16x16x32_bf16 v[76:79], v[88:91], v[172:175], 0
    ds_read_b128 v[164:167], v7 offset:576
    s_waitcnt lgkmcnt(6)
    v_mfma_f32_16x16x32_bf16 v[76:79], v[92:95], v[140:143], v[76:79]
    ds_read_b128 v[156:159], v7 offset:1088
    v_mfma_f32_16x16x32_bf16 v[80:83], v[92:95], v[172:175], 0
    ds_read_b128 v[188:191], v7 offset:1600
    v_mfma_f32_16x16x32_bf16 v[80:83], v[144:147], v[140:143], v[80:83]
    ds_read_b128 v[192:195], v7 offset:2112
    v_mfma_f32_16x16x32_bf16 v[84:87], v[144:147], v[172:175], 0
    ds_read_b128 v[144:147], v7 offset:2624
    v_mfma_f32_16x16x32_bf16 v[84:87], v[176:179], v[140:143], v[84:87]
    ds_read_b128 v[224:227], v7 offset:3136
    v_mfma_f32_16x16x32_bf16 v[88:91], v[176:179], v[172:175], 0
    ds_read_b128 v[176:179], v7 offset:3648
    v_mfma_f32_16x16x32_bf16 v[88:91], v[148:151], v[140:143], v[88:91]
    ds_read_b64 v[196:197], v8 offset:3768
    v_mfma_f32_16x16x32_bf16 v[92:95], v[148:151], v[172:175], 0
    ds_read_b64 v[198:199], v8 offset:3776
    v_mfma_f32_16x16x32_bf16 v[92:95], v[180:183], v[140:143], v[92:95]
    ds_read_b128 v[136:139], v7 offset:128
    s_waitcnt lgkmcnt(6)
    v_mfma_f32_16x16x32_bf16 v[64:67], v[132:135], v[152:155], v[64:67]
    ds_read_b64 v[148:149], v8 offset:3256
    v_mfma_f32_16x16x32_bf16 v[68:71], v[132:135], v[184:187], v[68:71]
    ds_read_b64 v[150:151], v8 offset:3264
    v_mfma_f32_16x16x32_bf16 v[68:71], v[164:167], v[152:155], v[68:71]
    ds_read_b128 v[168:171], v7 offset:640
    v_mfma_f32_16x16x32_bf16 v[72:75], v[164:167], v[184:187], v[72:75]
    ds_read_b128 v[180:183], v7 offset:1152
    v_mfma_f32_16x16x32_bf16 v[72:75], v[156:159], v[152:155], v[72:75]
    ds_read_b128 v[228:231], v7 offset:1664
    v_mfma_f32_16x16x32_bf16 v[76:79], v[156:159], v[184:187], v[76:79]
    ds_read_b128 v[156:159], v7 offset:2176
    v_mfma_f32_16x16x32_bf16 v[76:79], v[188:191], v[152:155], v[76:79]
    ds_read_b128 v[96:99], v7 offset:2688
    v_mfma_f32_16x16x32_bf16 v[80:83], v[188:191], v[184:187], v[80:83]
    ds_read_b128 v[188:191], v7 offset:3200
    v_mfma_f32_16x16x32_bf16 v[80:83], v[192:195], v[152:155], v[80:83]
    ds_read_b128 v[100:103], v7 offset:3712
    v_mfma_f32_16x16x32_bf16 v[84:87], v[192:195], v[184:187], v[84:87]
    ds_read_b64 v[192:193], v8 offset:3832
    s_waitcnt lgkmcnt(6)
    v_mfma_f32_16x16x32_bf16 v[84:87], v[144:147], v[152:155], v[84:87]
    ds_read_b64 v[194:195], v8 offset:3840
    v_mfma_f32_16x16x32_bf16 v[88:91], v[144:147], v[184:187], v[88:91]
    ds_read_b128 v[140:143], v7 offset:192
    v_mfma_f32_16x16x32_bf16 v[88:91], v[224:227], v[152:155], v[88:91]
    ds_read_b64 v[104:105], v8 offset:3320
    v_mfma_f32_16x16x32_bf16 v[92:95], v[224:227], v[184:187], v[92:95]
    ds_read_b64 v[106:107], v8 offset:3328
    v_mfma_f32_16x16x32_bf16 v[92:95], v[176:179], v[152:155], v[92:95]
    ds_read_b128 v[172:175], v7 offset:704
    v_mfma_f32_16x16x32_bf16 v[64:67], v[136:139], v[196:199], v[64:67]
    ds_read_b128 v[152:155], v7 offset:1216
    v_mfma_f32_16x16x32_bf16 v[68:71], v[136:139], v[148:151], v[68:71]
    ds_read_b128 v[184:187], v7 offset:1728
    v_mfma_f32_16x16x32_bf16 v[68:71], v[168:171], v[196:199], v[68:71]
    ds_read_b128 v[224:227], v7 offset:2240
    v_mfma_f32_16x16x32_bf16 v[72:75], v[168:171], v[148:151], v[72:75]
    ds_read_b128 v[108:111], v7 offset:2752
    v_mfma_f32_16x16x32_bf16 v[72:75], v[180:183], v[196:199], v[72:75]
    ds_read_b128 v[112:115], v7 offset:3264
    v_mfma_f32_16x16x32_bf16 v[76:79], v[180:183], v[148:151], v[76:79]
    ds_read_b128 v[116:119], v7 offset:3776
    s_waitcnt lgkmcnt(6)
    v_mfma_f32_16x16x32_bf16 v[76:79], v[228:231], v[196:199], v[76:79]
    ds_read_b64 v[200:201], v8 offset:3896
    v_mfma_f32_16x16x32_bf16 v[80:83], v[228:231], v[148:151], v[80:83]
    ds_read_b64 v[202:203], v8 offset:3904
    v_mfma_f32_16x16x32_bf16 v[80:83], v[156:159], v[196:199], v[80:83]
    ds_read_b128 v[144:147], v7 offset:256
    v_mfma_f32_16x16x32_bf16 v[84:87], v[156:159], v[148:151], v[84:87]
    ds_read_b64 v[156:157], v8 offset:3384
    v_mfma_f32_16x16x32_bf16 v[84:87], v[96:99], v[196:199], v[84:87]
    ds_read_b64 v[158:159], v8 offset:3392
    v_mfma_f32_16x16x32_bf16 v[88:91], v[96:99], v[148:151], v[88:91]
    ds_read_b128 v[176:179], v7 offset:768
    v_mfma_f32_16x16x32_bf16 v[88:91], v[188:191], v[196:199], v[88:91]
    ds_read_b128 v[228:231], v7 offset:1280
    v_mfma_f32_16x16x32_bf16 v[92:95], v[188:191], v[148:151], v[92:95]
    ds_read_b128 v[188:191], v7 offset:1792
    v_mfma_f32_16x16x32_bf16 v[92:95], v[100:103], v[196:199], v[92:95]
    ds_read_b128 v[196:199], v7 offset:2304
    v_mfma_f32_16x16x32_bf16 v[64:67], v[140:143], v[192:195], v[64:67]
    ds_read_b128 v[96:99], v7 offset:2816
    v_mfma_f32_16x16x32_bf16 v[68:71], v[140:143], v[104:107], v[68:71]
    ds_read_b128 v[100:103], v7 offset:3328
    v_mfma_f32_16x16x32_bf16 v[68:71], v[172:175], v[192:195], v[68:71]
    ds_read_b128 v[120:123], v7 offset:3840
    v_mfma_f32_16x16x32_bf16 v[72:75], v[172:175], v[104:107], v[72:75]
    ds_read_b64 v[232:233], v8 offset:3960
    s_waitcnt lgkmcnt(6)
    v_mfma_f32_16x16x32_bf16 v[72:75], v[152:155], v[192:195], v[72:75]
    ds_read_b64 v[234:235], v8 offset:3968
    v_mfma_f32_16x16x32_bf16 v[76:79], v[152:155], v[104:107], v[76:79]
    ds_read_b128 v[148:151], v7 offset:320
    v_mfma_f32_16x16x32_bf16 v[76:79], v[184:187], v[192:195], v[76:79]
    ds_read_b64 v[124:125], v8 offset:3448
    v_mfma_f32_16x16x32_bf16 v[80:83], v[184:187], v[104:107], v[80:83]
    ds_read_b64 v[126:127], v8 offset:3456
    v_mfma_f32_16x16x32_bf16 v[80:83], v[224:227], v[192:195], v[80:83]
    ds_read_b128 v[180:183], v7 offset:832
    v_mfma_f32_16x16x32_bf16 v[84:87], v[224:227], v[104:107], v[84:87]
    ds_read_b128 v[224:227], v7 offset:1344
    v_mfma_f32_16x16x32_bf16 v[84:87], v[108:111], v[192:195], v[84:87]
    ds_read_b128 v[204:207], v7 offset:1856
    v_mfma_f32_16x16x32_bf16 v[88:91], v[108:111], v[104:107], v[88:91]
    ds_read_b128 v[108:111], v7 offset:2368
    v_mfma_f32_16x16x32_bf16 v[88:91], v[112:115], v[192:195], v[88:91]
    ds_read_b128 v[236:239], v7 offset:2880
    v_mfma_f32_16x16x32_bf16 v[92:95], v[112:115], v[104:107], v[92:95]
    ds_read_b128 v[104:107], v7 offset:3392
    v_mfma_f32_16x16x32_bf16 v[92:95], v[116:119], v[192:195], v[92:95]
    ds_read_b128 v[192:195], v7 offset:3904
    v_mfma_f32_16x16x32_bf16 v[64:67], v[144:147], v[200:203], v[64:67]
    ds_read_b64 v[112:113], v8 offset:4024
    v_mfma_f32_16x16x32_bf16 v[68:71], v[144:147], v[156:159], v[68:71]
    ds_read_b64 v[114:115], v8 offset:4032
    v_mfma_f32_16x16x32_bf16 v[68:71], v[176:179], v[200:203], v[68:71]
    ds_read_b128 v[152:155], v7 offset:384
    v_mfma_f32_16x16x32_bf16 v[72:75], v[176:179], v[156:159], v[72:75]
    ds_read_b64 v[116:117], v8 offset:3512
    v_mfma_f32_16x16x32_bf16 v[72:75], v[228:231], v[200:203], v[72:75]
    ds_read_b64 v[118:119], v8 offset:3520
    v_mfma_f32_16x16x32_bf16 v[76:79], v[228:231], v[156:159], v[76:79]
    ds_read_b128 v[184:187], v7 offset:896
    s_waitcnt lgkmcnt(6)
    v_mfma_f32_16x16x32_bf16 v[76:79], v[188:191], v[200:203], v[76:79]
    ds_read_b128 v[228:231], v7 offset:1408
    v_mfma_f32_16x16x32_bf16 v[80:83], v[188:191], v[156:159], v[80:83]
    ds_read_b128 v[208:211], v7 offset:1920
    v_mfma_f32_16x16x32_bf16 v[80:83], v[196:199], v[200:203], v[80:83]
    ds_read_b128 v[240:243], v7 offset:2432
    v_mfma_f32_16x16x32_bf16 v[84:87], v[196:199], v[156:159], v[84:87]
    ds_read_b128 v[196:199], v7 offset:2944
    v_mfma_f32_16x16x32_bf16 v[84:87], v[96:99], v[200:203], v[84:87]
    ds_read_b128 v[212:215], v7 offset:3456
    v_mfma_f32_16x16x32_bf16 v[88:91], v[96:99], v[156:159], v[88:91]
    ds_read_b128 v[96:99], v7 offset:3968
    v_mfma_f32_16x16x32_bf16 v[88:91], v[100:103], v[200:203], v[88:91]
    ds_read_b64 v[244:245], v8 offset:4088
    v_mfma_f32_16x16x32_bf16 v[92:95], v[100:103], v[156:159], v[92:95]
    ds_read_b64 v[246:247], v8 offset:4096
    v_mfma_f32_16x16x32_bf16 v[92:95], v[120:123], v[200:203], v[92:95]
    ds_read_b128 v[156:159], v7 offset:448
    v_mfma_f32_16x16x32_bf16 v[64:67], v[148:151], v[232:235], v[64:67]
    ds_read_b64 v[200:201], v8 offset:3576
    v_mfma_f32_16x16x32_bf16 v[68:71], v[148:151], v[124:127], v[68:71]
    ds_read_b64 v[202:203], v8 offset:3584
    v_mfma_f32_16x16x32_bf16 v[68:71], v[180:183], v[232:235], v[68:71]
    ds_read_b128 v[188:191], v7 offset:960
    v_mfma_f32_16x16x32_bf16 v[72:75], v[180:183], v[124:127], v[72:75]
    ds_read_b128 v[100:103], v7 offset:1472
    v_mfma_f32_16x16x32_bf16 v[72:75], v[224:227], v[232:235], v[72:75]
    ds_read_b128 v[120:123], v7 offset:1984
    v_mfma_f32_16x16x32_bf16 v[76:79], v[224:227], v[124:127], v[76:79]
    ds_read_b128 v[216:219], v7 offset:2496
    v_mfma_f32_16x16x32_bf16 v[76:79], v[204:207], v[232:235], v[76:79]
    ds_read_b128 v[248:251], v7 offset:3008
    v_mfma_f32_16x16x32_bf16 v[80:83], v[204:207], v[124:127], v[80:83]
    ds_read_b128 v[204:207], v7 offset:3520
    v_mfma_f32_16x16x32_bf16 v[80:83], v[108:111], v[232:235], v[80:83]
    ds_read_b128 v[220:223], v7 offset:4032
    v_mfma_f32_16x16x32_bf16 v[84:87], v[108:111], v[124:127], v[84:87]
    v_mfma_f32_16x16x32_bf16 v[84:87], v[236:239], v[232:235], v[84:87]
    v_mfma_f32_16x16x32_bf16 v[88:91], v[236:239], v[124:127], v[88:91]
    v_mfma_f32_16x16x32_bf16 v[88:91], v[104:107], v[232:235], v[88:91]
    v_mfma_f32_16x16x32_bf16 v[92:95], v[104:107], v[124:127], v[92:95]
    v_mfma_f32_16x16x32_bf16 v[92:95], v[192:195], v[232:235], v[92:95]
    s_waitcnt lgkmcnt(0)
    v_mfma_f32_16x16x32_bf16 v[64:67], v[152:155], v[112:115], v[64:67]
    v_mfma_f32_16x16x32_bf16 v[68:71], v[152:155], v[116:119], v[68:71]
    v_mfma_f32_16x16x32_bf16 v[68:71], v[184:187], v[112:115], v[68:71]
    v_mfma_f32_16x16x32_bf16 v[72:75], v[184:187], v[116:119], v[72:75]
    v_mfma_f32_16x16x32_bf16 v[72:75], v[228:231], v[112:115], v[72:75]
    v_mfma_f32_16x16x32_bf16 v[76:79], v[228:231], v[116:119], v[76:79]
    v_mfma_f32_16x16x32_bf16 v[76:79], v[208:211], v[112:115], v[76:79]
    v_mfma_f32_16x16x32_bf16 v[80:83], v[208:211], v[116:119], v[80:83]
    v_mfma_f32_16x16x32_bf16 v[80:83], v[240:243], v[112:115], v[80:83]
    v_mfma_f32_16x16x32_bf16 v[84:87], v[240:243], v[116:119], v[84:87]
    v_mfma_f32_16x16x32_bf16 v[84:87], v[196:199], v[112:115], v[84:87]
    v_mfma_f32_16x16x32_bf16 v[88:91], v[196:199], v[116:119], v[88:91]
    v_mfma_f32_16x16x32_bf16 v[88:91], v[212:215], v[112:115], v[88:91]
    v_mfma_f32_16x16x32_bf16 v[92:95], v[212:215], v[116:119], v[92:95]
    ds_read_b128 v[12:15], v5
    v_mfma_f32_16x16x32_bf16 v[92:95], v[96:99], v[112:115], v[92:95]
    v_mfma_f32_16x16x32_bf16 v[64:67], v[156:159], v[244:247], v[64:67]
    v_mfma_f32_16x16x32_bf16 v[68:71], v[156:159], v[200:203], v[68:71]
    v_mfma_f32_16x16x32_bf16 v[68:71], v[188:191], v[244:247], v[68:71]
    v_mfma_f32_16x16x32_bf16 v[72:75], v[188:191], v[200:203], v[72:75]
    v_mfma_f32_16x16x32_bf16 v[72:75], v[100:103], v[244:247], v[72:75]
    s_waitcnt lgkmcnt(0)
    v_min3_u32 v12, v12, v13, v14
    v_min_u32 v12, v12, v15
    s_nop 0
    v_readfirstlane_b32 s86, v12
    s_cmp_ge_u32 s86, 3
    s_cbranch_scc1 L_ok23
L_spin24:
    s_sleep 1
    ds_read_b128 v[12:15], v5
    s_waitcnt lgkmcnt(0)
    v_min3_u32 v12, v12, v13, v14
    v_min_u32 v12, v12, v15
    s_nop 0
    v_readfirstlane_b32 s86, v12
    s_cmp_ge_u32 s86, 3
    s_cbranch_scc0 L_spin24
L_ok23:
    v_mfma_f32_16x16x32_bf16 v[76:79], v[100:103], v[200:203], v[76:79]
    ds_read_b64 v[236:237], v8 offset:37240
    v_cvt_pk_bf16_f32 v16, v64, v65
    v_cvt_pk_bf16_f32 v17, v66, v67
    v_cvt_pk_bf16_f32 v18, v68, v69
    v_cvt_pk_bf16_f32 v19, v70, v71
    s_mov_b32 m0, s72
    s_nop 0
    ds_write_addtid_b32 v16 offset:0
    v_mfma_f32_16x16x32_bf16 v[76:79], v[120:123], v[244:247], v[76:79]
    ds_write_addtid_b32 v17 offset:256
    ds_write_addtid_b32 v18 offset:512
    ds_write_addtid_b32 v19 offset:768
    v_mfma_f32_16x16x32_bf16 v[80:83], v[120:123], v[200:203], v[80:83]
    ds_read_b64 v[238:239], v8 offset:37248
    v_mfma_f32_16x16x32_bf16 v[80:83], v[216:219], v[244:247], v[80:83]
    ds_read_b128 v[192:195], v7 offset:36480
    v_mfma_f32_16x16x32_bf16 v[84:87], v[216:219], v[200:203], v[84:87]
    ds_read_b64 v[208:209], v8 offset:36728
    ds_read_b64 v[210:211], v8 offset:36736
    v_mfma_f32_16x16x32_bf16 v[84:87], v[248:251], v[244:247], v[84:87]
    ds_read_b128 v[224:227], v7 offset:36992
    v_mfma_f32_16x16x32_bf16 v[88:91], v[248:251], v[200:203], v[88:91]
    ds_read_b128 v[120:123], v7 offset:37504
    v_mfma_f32_16x16x32_bf16 v[88:91], v[204:207], v[244:247], v[88:91]
    ds_read_b128 v[232:235], v7 offset:38016
    v_mfma_f32_16x16x32_bf16 v[92:95], v[204:207], v[200:203], v[92:95]
    ds_read_b128 v[204:207], v7 offset:38528
    v_mfma_f32_16x16x32_bf16 v[92:95], v[220:223], v[244:247], v[92:95]
    ds_read_b128 v[240:243], v7 offset:39040
    s_waitcnt lgkmcnt(7)
    v_mfma_f32_16x16x32_bf16 v[96:99], v[192:195], v[236:239], 0
    ds_read_b128 v[212:215], v7 offset:39552
    s_waitcnt lgkmcnt(6)
    v_mfma_f32_16x16x32_bf16 v[100:103], v[192:195], v[208:211], 0
    ds_read_b128 v[244:247], v7 offset:40064
    s_waitcnt lgkmcnt(6)
    v_mfma_f32_16x16x32_bf16 v[100:103], v[224:227], v[236:239], v[100:103]
    ds_read_b64 v[216:217], v8 offset:37304
    v_mfma_f32_16x16x32_bf16 v[104:107], v[224:227], v[208:211], 0
    ds_read_b64 v[218:219], v8 offset:37312
    s_waitcnt lgkmcnt(6)
    v_mfma_f32_16x16x32_bf16 v[104:107], v[120:123], v[236:239], v[104:107]
    ds_read_b128 v[196:199], v7 offset:36544
    v_mfma_f32_16x16x32_bf16 v[108:111], v[120:123], v[208:211], 0
    ds_read_b64 v[248:249], v8 offset:36792
    v_mfma_f32_16x16x32_bf16 v[108:111], v[232:235], v[236:239], v[108:111]
    ds_read_b64 v[250:251], v8 offset:36800
    v_mfma_f32_16x16x32_bf16 v[112:115], v[232:235], v[208:211], 0
    ds_read_b128 v[228:231], v7 offset:37056
    s_waitcnt lgkmcnt(6)
    v_mfma_f32_16x16x32_bf16 v[112:115], v[204:207], v[236:239], v[112:115]
    ds_read_b128 v[220:223], v7 offset:37568
    v_mfma_f32_16x16x32_bf16 v[116:119], v[204:207], v[208:211], 0
    ds_read_b128 v[252:255], v7 offset:38080
    v_mfma_f32_16x16x32_bf16 v[116:119], v[240:243], v[236:239], v[116:119]
    ds_read_b128 v[20:23], v7 offset:38592
    v_mfma_f32_16x16x32_bf16 v[120:123], v[240:243], v[208:211], 0
    ds_read_b128 v[240:243], v7 offset:39104
    v_mfma_f32_16x16x32_bf16 v[120:123], v[212:215], v[236:239], v[120:123]
    ds_read_b128 v[24:27], v7 offset:39616
    v_mfma_f32_16x16x32_bf16 v[124:127], v[212:215], v[208:211], 0
    ds_read_b128 v[208:211], v7 offset:40128
    v_mfma_f32_16x16x32_bf16 v[124:127], v[244:247], v[236:239], v[124:127]
    ds_read_b64 v[212:213], v8 offset:37368
    s_waitcnt lgkmcnt(6)
    v_mfma_f32_16x16x32_bf16 v[96:99], v[196:199], v[216:219], v[96:99]
    ds_read_b64 v[214:215], v8 offset:37376
    v_mfma_f32_16x16x32_bf16 v[100:103], v[196:199], v[248:251], v[100:103]
    ds_read_b128 v[200:203], v7 offset:36608
    v_mfma_f32_16x16x32_bf16 v[100:103], v[228:231], v[216:219], v[100:103]
    ds_read_b64 v[244:245], v8 offset:36856
    v_mfma_f32_16x16x32_bf16 v[104:107], v[228:231], v[248:251], v[104:107]
    ds_read_b64 v[246:247], v8 offset:36864
    v_mfma_f32_16x16x32_bf16 v[104:107], v[220:223], v[216:219], v[104:107]
    ds_read_b128 v[232:235], v7 offset:37120
    v_mfma_f32_16x16x32_bf16 v[108:111], v[220:223], v[248:251], v[108:111]
    ds_read_b128 v[220:223], v7 offset:37632
    s_waitcnt lgkmcnt(6)
    v_mfma_f32_16x16x32_bf16 v[108:111], v[252:255], v[216:219], v[108:111]
    ds_read_b128 v[28:31], v7 offset:38144
    v_mfma_f32_16x16x32_bf16 v[112:115], v[252:255], v[248:251], v[112:115]
    ds_read_b128 v[252:255], v7 offset:38656
    v_mfma_f32_16x16x32_bf16 v[112:115], v[20:23], v[216:219], v[112:115]
    ds_read_b128 v[32:35], v7 offset:39168
    v_mfma_f32_16x16x32_bf16 v[116:119], v[20:23], v[248:251], v[116:119]
    ds_read_b128 v[36:39], v7 offset:39680
    v_mfma_f32_16x16x32_bf16 v[116:119], v[240:243], v[216:219], v[116:119]
    ds_read_b128 v[40:43], v7 offset:40192
    v_mfma_f32_16x16x32_bf16 v[120:123], v[240:243], v[248:251], v[120:123]
    ds_read_b64 v[44:45], v8 offset:37432
    v_mfma_f32_16x16x32_bf16 v[120:123], v[24:27], v[216:219], v[120:123]
    ds_read_b64 v[46:47], v8 offset:37440
    v_mfma_f32_16x16x32_bf16 v[124:127], v[24:27], v[248:251], v[124:127]
    ds_read_b128 v[204:207], v7 offset:36672
    v_mfma_f32_16x16x32_bf16 v[124:127], v[208:211], v[216:219], v[124:127]
    ds_read_b64 v[48:49], v8 offset:36920
    s_waitcnt lgkmcnt(6)
    v_mfma_f32_16x16x32_bf16 v[96:99], v[200:203], v[212:215], v[96:99]
    ds_read_b64 v[50:51], v8 offset:36928
    v_mfma_f32_16x16x32_bf16 v[100:103], v[200:203], v[244:247], v[100:103]
    ds_read_b128 v[236:239], v7 offset:37184
    v_mfma_f32_16x16x32_bf16 v[100:103], v[232:235], v[212:215], v[100:103]
    ds_read_b128 v[216:219], v7 offset:37696
    v_mfma_f32_16x16x32_bf16 v[104:107], v[232:235], v[244:247], v[104:107]
    ds_read_b128 v[248:251], v7 offset:38208
    v_mfma_f32_16x16x32_bf16 v[104:107], v[220:223], v[212:215], v[104:107]
    ds_read_b128 v[52:55], v7 offset:38720
    v_mfma_f32_16x16x32_bf16 v[108:111], v[220:223], v[244:247], v[108:111]
    ds_read_b128 v[220:223], v7 offset:39232
    v_mfma_f32_16x16x32_bf16 v[108:111], v[28:31], v[212:215], v[108:111]
    ds_read_b128 v[56:59], v7 offset:39744
    v_mfma_f32_16x16x32_bf16 v[112:115], v[28:31], v[244:247], v[112:115]
    ds_read_b128 v[60:63], v7 offset:40256
    v_mfma_f32_16x16x32_bf16 v[112:115], v[252:255], v[212:215], v[112:115]
    ds_read_b64 v[64:65], v8 offset:37496
    v_mfma_f32_16x16x32_bf16 v[116:119], v[252:255], v[244:247], v[116:119]
    ds_read_b64 v[66:67], v8 offset:37504
    v_mfma_f32_16x16x32_bf16 v[116:119], v[32:35], v[212:215], v[116:119]
    ds_read_b128 v[208:211], v7 offset:36736
    v_mfma_f32_16x16x32_bf16 v[120:123], v[32:35], v[244:247], v[120:123]
    ds_read_b64 v[68:69], v8 offset:36984
    s_waitcnt lgkmcnt(6)
    v_mfma_f32_16x16x32_bf16 v[120:123], v[36:39], v[212:215], v[120:123]
    ds_read_b64 v[70:71], v8 offset:36992
    v_mfma_f32_16x16x32_bf16 v[124:127], v[36:39], v[244:247], v[124:127]
    ds_read_b128 v[240:243], v7 offset:37248
    v_mfma_f32_16x16x32_bf16 v[124:127], v[40:43], v[212:215], v[124:127]
    ds_read_b128 v[20:23], v7 offset:37760
    v_mfma_f32_16x16x32_bf16 v[96:99], v[204:207], v[44:47], v[96:99]
    ds_read_b128 v[24:27], v7 offset:38272
    v_mfma_f32_16x16x32_bf16 v[100:103], v[204:207], v[48:51], v[100:103]
    ds_read_b128 v[28:31], v7 offset:38784
    v_mfma_f32_16x16x32_bf16 v[100:103], v[236:239], v[44:47], v[100:103]
    ds_read_b128 v[32:35], v7 offset:39296
    v_mfma_f32_16x16x32_bf16 v[104:107], v[236:239], v[48:51], v[104:107]
    ds_read_b128 v[36:39], v7 offset:39808
    v_mfma_f32_16x16x32_bf16 v[104:107], v[216:219], v[44:47], v[104:107]
    ds_read_b128 v[40:43], v7 offset:40320
    v_mfma_f32_16x16x32_bf16 v[108:111], v[216:219], v[48:51], v[108:111]
    v_mfma_f32_16x16x32_bf16 v[108:111], v[248:251], v[44:47], v[108:111]
    v_mfma_f32_16x16x32_bf16 v[112:115], v[248:251], v[48:51], v[112:115]
    v_mfma_f32_16x16x32_bf16 v[112:115], v[52:55], v[44:47], v[112:115]
    v_mfma_f32_16x16x32_bf16 v[116:119], v[52:55], v[48:51], v[116:119]
    ds_read_b64 v[52:53], v8 offset:37560
    v_mfma_f32_16x16x32_bf16 v[116:119], v[220:223], v[44:47], v[116:119]
    ds_read_b64 v[54:55], v8 offset:37568
    v_mfma_f32_16x16x32_bf16 v[120:123], v[220:223], v[48:51], v[120:123]
    ds_read_b128 v[212:215], v7 offset:36800
    s_waitcnt lgkmcnt(3)
    v_mfma_f32_16x16x32_bf16 v[120:123], v[56:59], v[44:47], v[120:123]
    v_mfma_f32_16x16x32_bf16 v[124:127], v[56:59], v[48:51], v[124:127]
    ds_read_b64 v[48:49], v8 offset:37048
    v_mfma_f32_16x16x32_bf16 v[124:127], v[60:63], v[44:47], v[124:127]
    ds_read_b64 v[50:51], v8 offset:37056
    v_mfma_f32_16x16x32_bf16 v[96:99], v[208:211], v[64:67], v[96:99]
    ds_read_b128 v[244:247], v7 offset:37312
    v_mfma_f32_16x16x32_bf16 v[100:103], v[208:211], v[68:71], v[100:103]
    ds_read_b64 v[56:57], v8 offset:37624
    v_mfma_f32_16x16x32_bf16 v[100:103], v[240:243], v[64:67], v[100:103]
    ds_read_b64 v[58:59], v8 offset:37632
    v_mfma_f32_16x16x32_bf16 v[104:107], v[240:243], v[68:71], v[104:107]
    ds_read_b128 v[216:219], v7 offset:36864
    v_mfma_f32_16x16x32_bf16 v[104:107], v[20:23], v[64:67], v[104:107]
    ds_read_b64 v[44:45], v8 offset:37112
    v_mfma_f32_16x16x32_bf16 v[108:111], v[20:23], v[68:71], v[108:111]
    ds_read_b64 v[46:47], v8 offset:37120
    v_mfma_f32_16x16x32_bf16 v[108:111], v[24:27], v[64:67], v[108:111]
    ds_read_b128 v[248:251], v7 offset:37376
    v_mfma_f32_16x16x32_bf16 v[112:115], v[24:27], v[68:71], v[112:115]
    ds_read_b64 v[60:61], v8 offset:37688
    v_mfma_f32_16x16x32_bf16 v[112:115], v[28:31], v[64:67], v[112:115]
    ds_read_b64 v[62:63], v8 offset:37696
    v_mfma_f32_16x16x32_bf16 v[116:119], v[28:31], v[68:71], v[116:119]
    ds_read_b128 v[220:223], v7 offset:36928
    v_mfma_f32_16x16x32_bf16 v[116:119], v[32:35], v[64:67], v[116:119]
    ds_read_b64 v[20:21], v8 offset:37176
    v_mfma_f32_16x16x32_bf16 v[120:123], v[32:35], v[68:71], v[120:123]
    ds_read_b64 v[22:23], v8 offset:37184
    v_mfma_f32_16x16x32_bf16 v[120:123], v[36:39], v[64:67], v[120:123]
    ds_read_b128 v[252:255], v7 offset:37440
    v_mfma_f32_16x16x32_bf16 v[124:127], v[36:39], v[68:71], v[124:127]
    ds_read_b128 v[24:27], v7 offset:37824
    v_mfma_f32_16x16x32_bf16 v[124:127], v[40:43], v[64:67], v[124:127]
    ds_read_b128 v[28:31], v7 offset:38336
    s_waitcnt lgkmcnt(6)
    v_mfma_f32_16x16x32_bf16 v[96:99], v[212:215], v[52:55], v[96:99]
    ds_read_b128 v[32:35], v7 offset:38848
    v_mfma_f32_16x16x32_bf16 v[100:103], v[212:215], v[48:51], v[100:103]
    ds_read_b128 v[36:39], v7 offset:39360
    v_mfma_f32_16x16x32_bf16 v[100:103], v[244:247], v[52:55], v[100:103]
    ds_read_b128 v[68:71], v7 offset:39872
    v_mfma_f32_16x16x32_bf16 v[96:99], v[216:219], v[56:59], v[96:99]
    ds_read_b128 v[40:43], v7 offset:40384
    v_mfma_f32_16x16x32_bf16 v[100:103], v[216:219], v[44:47], v[100:103]
    ds_read_b128 v[64:67], v7 offset:37888
    v_mfma_f32_16x16x32_bf16 v[100:103], v[248:251], v[56:59], v[100:103]
    s_waitcnt lgkmcnt(5)
    v_mfma_f32_16x16x32_bf16 v[96:99], v[220:223], v[60:63], v[96:99]
    v_mfma_f32_16x16x32_bf16 v[100:103], v[220:223], v[20:23], v[100:103]
    v_mfma_f32_16x16x32_bf16 v[100:103], v[252:255], v[60:63], v[100:103]
    v_mfma_f32_16x16x32_bf16 v[104:107], v[244:247], v[48:51], v[104:107]
    v_mfma_f32_16x16x32_bf16 v[104:107], v[24:27], v[52:55], v[104:107]
    v_mfma_f32_16x16x32_bf16 v[108:111], v[24:27], v[48:51], v[108:111]
    ds_read_b128 v[24:27], v7 offset:38400
    v_mfma_f32_16x16x32_bf16 v[108:111], v[28:31], v[52:55], v[108:111]
    v_mfma_f32_16x16x32_bf16 v[112:115], v[28:31], v[48:51], v[112:115]
    ds_read_b128 v[28:31], v7 offset:38912
    s_waitcnt lgkmcnt(2)
    v_mfma_f32_16x16x32_bf16 v[112:115], v[32:35], v[52:55], v[112:115]
    v_cvt_pk_bf16_f32 v16, v96, v97
    v_cvt_pk_bf16_f32 v17, v98, v99
    v_cvt_pk_bf16_f32 v18, v100, v101
    v_cvt_pk_bf16_f32 v19, v102, v103
    ds_write_addtid_b32 v16 offset:4352
    ds_write_addtid_b32 v17 offset:4608
    v_mfma_f32_16x16x32_bf16 v[116:119], v[32:35], v[48:51], v[116:119]
    ds_write_addtid_b32 v18 offset:4864
    ds_write_addtid_b32 v19 offset:5120
    v_mov_b32 v3, 2
    ds_write_b32 v6, v3
    v_mfma_f32_16x16x32_bf16 v[116:119], v[36:39], v[52:55], v[116:119]
    ds_read_b128 v[32:35], v7 offset:39424
    v_mfma_f32_16x16x32_bf16 v[120:123], v[36:39], v[48:51], v[120:123]
    ds_read_b128 v[96:99], v7 offset:39936
    v_mfma_f32_16x16x32_bf16 v[120:123], v[68:71], v[52:55], v[120:123]
    ds_read_b128 v[100:103], v7 offset:40448
    v_mfma_f32_16x16x32_bf16 v[124:127], v[68:71], v[48:51], v[124:127]
    ds_read_b128 v[36:39], v7 offset:37952
    v_mfma_f32_16x16x32_bf16 v[124:127], v[40:43], v[52:55], v[124:127]
    ds_read_b128 v[48:51], v7 offset:38464
    v_mfma_f32_16x16x32_bf16 v[104:107], v[248:251], v[44:47], v[104:107]
    ds_read_b128 v[68:71], v7 offset:38976
    v_mfma_f32_16x16x32_bf16 v[104:107], v[64:67], v[56:59], v[104:107]
    ds_read_b128 v[40:43], v7 offset:39488
    v_mfma_f32_16x16x32_bf16 v[108:111], v[64:67], v[44:47], v[108:111]
    ds_read_b128 v[52:55], v7 offset:40000
    s_waitcnt lgkmcnt(6)
    v_mfma_f32_16x16x32_bf16 v[108:111], v[24:27], v[56:59], v[108:111]
    ds_read_b128 v[64:67], v7 offset:40512
    v_mfma_f32_16x16x32_bf16 v[112:115], v[24:27], v[44:47], v[112:115]
    v_mfma_f32_16x16x32_bf16 v[112:115], v[28:31], v[56:59], v[112:115]
    v_mfma_f32_16x16x32_bf16 v[116:119], v[28:31], v[44:47], v[116:119]
    v_mfma_f32_16x16x32_bf16 v[116:119], v[32:35], v[56:59], v[116:119]
    ds_read_b128 v[12:15], v5
    v_mfma_f32_16x16x32_bf16 v[120:123], v[32:35], v[44:47], v[120:123]
    v_mfma_f32_16x16x32_bf16 v[120:123], v[96:99], v[56:59], v[120:123]
    v_mfma_f32_16x16x32_bf16 v[124:127], v[96:99], v[44:47], v[124:127]
    s_waitcnt lgkmcnt(1)
    v_mfma_f32_16x16x32_bf16 v[124:127], v[100:103], v[56:59], v[124:127]
    v_mfma_f32_16x16x32_bf16 v[104:107], v[252:255], v[20:23], v[104:107]
    v_mfma_f32_16x16x32_bf16 v[104:107], v[36:39], v[60:63], v[104:107]
    s_waitcnt lgkmcnt(0)
    v_min3_u32 v12, v12, v13, v14
    v_min_u32 v12, v12, v15
    s_nop 0
    v_readfirstlane_b32 s86, v12
    s_cmp_ge_u32 s86, 4
    s_cbranch_scc1 L_ok25
L_spin26:
    s_sleep 1
    ds_read_b128 v[12:15], v5
    s_waitcnt lgkmcnt(0)
    v_min3_u32 v12, v12, v13, v14
    v_min_u32 v12, v12, v15
    s_nop 0
    v_readfirstlane_b32 s86, v12
    s_cmp_ge_u32 s86, 4
    s_cbranch_scc0 L_spin26
L_ok25:
    v_mfma_f32_16x16x32_bf16 v[108:111], v[36:39], v[20:23], v[108:111]
    ds_read_b64 v[24:25], v8 offset:2616
    v_mfma_f32_16x16x32_bf16 v[108:111], v[48:51], v[60:63], v[108:111]
    ds_read_b64 v[26:27], v8 offset:2624
    v_mfma_f32_16x16x32_bf16 v[112:115], v[48:51], v[20:23], v[112:115]
    ds_read_b64 v[28:29], v8 offset:2104
    v_mfma_f32_16x16x32_bf16 v[112:115], v[68:71], v[60:63], v[112:115]
    ds_read_b64 v[30:31], v8 offset:2112
    v_mfma_f32_16x16x32_bf16 v[116:119], v[68:71], v[20:23], v[116:119]
    ds_read_b128 v[32:35], v7 offset:1024
    v_mfma_f32_16x16x32_bf16 v[116:119], v[40:43], v[60:63], v[116:119]
    ds_read_b128 v[44:47], v7 offset:1536
    v_mfma_f32_16x16x32_bf16 v[120:123], v[40:43], v[20:23], v[120:123]
    ds_read_b128 v[96:99], v7 offset:2048
    v_mfma_f32_16x16x32_bf16 v[120:123], v[52:55], v[60:63], v[120:123]
    ds_read_b128 v[56:59], v7 offset:2560
    v_mfma_f32_16x16x32_bf16 v[124:127], v[52:55], v[20:23], v[124:127]
    ds_read_b64 v[100:101], v8 offset:2680
    v_mfma_f32_16x16x32_bf16 v[124:127], v[64:67], v[60:63], v[124:127]
    ds_read_b64 v[102:103], v8 offset:2688
    s_waitcnt lgkmcnt(6)
    v_mfma_f32_16x16x32_bf16 v[72:75], v[128:131], v[24:27], v[72:75]
    ds_read_b64 v[36:37], v8 offset:2168
    v_mfma_f32_16x16x32_bf16 v[76:79], v[128:131], v[28:31], v[76:79]
    ds_read_b64 v[38:39], v8 offset:2176
    v_mfma_f32_16x16x32_bf16 v[76:79], v[160:163], v[24:27], v[76:79]
    ds_read_b128 v[48:51], v7 offset:1088
    v_mfma_f32_16x16x32_bf16 v[80:83], v[160:163], v[28:31], v[80:83]
    ds_read_b128 v[68:71], v7 offset:1600
    s_waitcnt lgkmcnt(6)
    v_mfma_f32_16x16x32_bf16 v[80:83], v[32:35], v[24:27], v[80:83]
    ds_read_b128 v[40:43], v7 offset:2112
    v_mfma_f32_16x16x32_bf16 v[84:87], v[32:35], v[28:31], v[84:87]
    ds_read_b128 v[20:23], v7 offset:2624
    v_mfma_f32_16x16x32_bf16 v[84:87], v[44:47], v[24:27], v[84:87]
    ds_read_b64 v[52:53], v8 offset:2744
    v_mfma_f32_16x16x32_bf16 v[88:91], v[44:47], v[28:31], v[88:91]
    ds_read_b64 v[54:55], v8 offset:2752
    v_mfma_f32_16x16x32_bf16 v[88:91], v[96:99], v[24:27], v[88:91]
    ds_read_b64 v[60:61], v8 offset:2232
    v_mfma_f32_16x16x32_bf16 v[92:95], v[96:99], v[28:31], v[92:95]
    ds_read_b64 v[62:63], v8 offset:2240
    v_mfma_f32_16x16x32_bf16 v[92:95], v[56:59], v[24:27], v[92:95]
    ds_read_b128 v[64:67], v7 offset:1152
    s_waitcnt lgkmcnt(6)
    v_mfma_f32_16x16x32_bf16 v[72:75], v[132:135], v[100:103], v[72:75]
    ds_read_b128 v[32:35], v7 offset:1664
    v_mfma_f32_16x16x32_bf16 v[76:79], v[132:135], v[36:39], v[76:79]
    ds_read_b128 v[44:47], v7 offset:2176
    v_mfma_f32_16x16x32_bf16 v[76:79], v[164:167], v[100:103], v[76:79]
    ds_read_b128 v[28:31], v7 offset:2688
    v_mfma_f32_16x16x32_bf16 v[80:83], v[164:167], v[36:39], v[80:83]
    ds_read_b64 v[96:97], v8 offset:2808
    v_mfma_f32_16x16x32_bf16 v[80:83], v[48:51], v[100:103], v[80:83]
    ds_read_b64 v[98:99], v8 offset:2816
    v_mfma_f32_16x16x32_bf16 v[84:87], v[48:51], v[36:39], v[84:87]
    ds_read_b64 v[24:25], v8 offset:2296
    v_mfma_f32_16x16x32_bf16 v[84:87], v[68:71], v[100:103], v[84:87]
    ds_read_b64 v[26:27], v8 offset:2304
    v_mfma_f32_16x16x32_bf16 v[88:91], v[68:71], v[36:39], v[88:91]
    ds_read_b128 v[56:59], v7 offset:1216
    v_mfma_f32_16x16x32_bf16 v[88:91], v[40:43], v[100:103], v[88:91]
    ds_read_b128 v[48:51], v7 offset:1728
    v_mfma_f32_16x16x32_bf16 v[92:95], v[40:43], v[36:39], v[92:95]
    ds_read_b128 v[68:71], v7 offset:2240
    s_waitcnt lgkmcnt(6)
    v_mfma_f32_16x16x32_bf16 v[92:95], v[20:23], v[100:103], v[92:95]
    ds_read_b128 v[36:39], v7 offset:2752
    v_mfma_f32_16x16x32_bf16 v[72:75], v[136:139], v[52:55], v[72:75]
    ds_read_b64 v[40:41], v8 offset:2872
    v_mfma_f32_16x16x32_bf16 v[76:79], v[136:139], v[60:63], v[76:79]
    ds_read_b64 v[42:43], v8 offset:2880
    v_mfma_f32_16x16x32_bf16 v[76:79], v[168:171], v[52:55], v[76:79]
    ds_read_b64 v[20:21], v8 offset:2360
    v_mfma_f32_16x16x32_bf16 v[80:83], v[168:171], v[60:63], v[80:83]
    ds_read_b64 v[22:23], v8 offset:2368
    v_mfma_f32_16x16x32_bf16 v[80:83], v[64:67], v[52:55], v[80:83]
    ds_read_b128 v[100:103], v7 offset:1280
    v_mfma_f32_16x16x32_bf16 v[84:87], v[64:67], v[60:63], v[84:87]
    ds_read_b128 v[64:67], v7 offset:1792
    v_mfma_f32_16x16x32_bf16 v[84:87], v[32:35], v[52:55], v[84:87]
    v_mfma_f32_16x16x32_bf16 v[88:91], v[32:35], v[60:63], v[88:91]
    ds_read_b128 v[32:35], v7 offset:2304
    v_mfma_f32_16x16x32_bf16 v[88:91], v[44:47], v[52:55], v[88:91]
    v_mfma_f32_16x16x32_bf16 v[92:95], v[44:47], v[60:63], v[92:95]
    ds_read_b128 v[44:47], v7 offset:2816
    v_mfma_f32_16x16x32_bf16 v[92:95], v[28:31], v[52:55], v[92:95]
    ds_read_b64 v[60:61], v8 offset:2936
    s_waitcnt lgkmcnt(4)
    v_mfma_f32_16x16x32_bf16 v[72:75], v[140:143], v[96:99], v[72:75]
    ds_read_b64 v[62:63], v8 offset:2944
    v_mfma_f32_16x16x32_bf16 v[76:79], v[140:143], v[24:27], v[76:79]
    ds_read_b64 v[28:29], v8 offset:2424
    v_mfma_f32_16x16x32_bf16 v[76:79], v[172:175], v[96:99], v[76:79]
    ds_read_b64 v[30:31], v8 offset:2432
    v_mfma_f32_16x16x32_bf16 v[80:83], v[172:175], v[24:27], v[80:83]
    ds_read_b128 v[52:55], v7 offset:1344
    v_mfma_f32_16x16x32_bf16 v[80:83], v[56:59], v[96:99], v[80:83]
    v_mfma_f32_16x16x32_bf16 v[84:87], v[56:59], v[24:27], v[84:87]
    ds_read_b128 v[56:59], v7 offset:1856
    v_mfma_f32_16x16x32_bf16 v[84:87], v[48:51], v[96:99], v[84:87]
    v_mfma_f32_16x16x32_bf16 v[88:91], v[48:51], v[24:27], v[88:91]
    ds_read_b128 v[48:51], v7 offset:2368
    v_mfma_f32_16x16x32_bf16 v[88:91], v[68:71], v[96:99], v[88:91]
    v_mfma_f32_16x16x32_bf16 v[92:95], v[68:71], v[24:27], v[92:95]
    ds_read_b128 v[24:27], v7 offset:2880
    v_mfma_f32_16x16x32_bf16 v[92:95], v[36:39], v[96:99], v[92:95]
    ds_read_b64 v[68:69], v8 offset:3000
    v_mfma_f32_16x16x32_bf16 v[72:75], v[144:147], v[40:43], v[72:75]
    ds_read_b64 v[70:71], v8 offset:3008
    v_mfma_f32_16x16x32_bf16 v[76:79], v[144:147], v[20:23], v[76:79]
    ds_read_b64 v[36:37], v8 offset:2488
    v_mfma_f32_16x16x32_bf16 v[76:79], v[176:179], v[40:43], v[76:79]
    ds_read_b64 v[38:39], v8 offset:2496
    v_mfma_f32_16x16x32_bf16 v[80:83], v[176:179], v[20:23], v[80:83]
    ds_read_b128 v[96:99], v7 offset:1408
    v_mfma_f32_16x16x32_bf16 v[80:83], v[100:103], v[40:43], v[80:83]
    v_mfma_f32_16x16x32_bf16 v[84:87], v[100:103], v[20:23], v[84:87]
    ds_read_b128 v[100:103], v7 offset:1920
    s_waitcnt lgkmcnt(5)
    v_mfma_f32_16x16x32_bf16 v[84:87], v[64:67], v[40:43], v[84:87]
    v_mfma_f32_16x16x32_bf16 v[88:91], v[64:67], v[20:23], v[88:91]
    ds_read_b128 v[64:67], v7 offset:2432
    v_mfma_f32_16x16x32_bf16 v[88:91], v[32:35], v[40:43], v[88:91]
    v_mfma_f32_16x16x32_bf16 v[92:95], v[32:35], v[20:23], v[92:95]
    ds_read_b128 v[20:23], v7 offset:2944
    v_mfma_f32_16x16x32_bf16 v[92:95], v[44:47], v[40:43], v[92:95]
    ds_read_b64 v[32:33], v8 offset:3064
    v_mfma_f32_16x16x32_bf16 v[72:75], v[148:151], v[60:63], v[72:75]
    ds_read_b64 v[34:35], v8 offset:3072
    v_mfma_f32_16x16x32_bf16 v[76:79], v[148:151], v[28:31], v[76:79]
    ds_read_b64 v[40:41], v8 offset:2552
    v_mfma_f32_16x16x32_bf16 v[76:79], v[180:183], v[60:63], v[76:79]
    ds_read_b64 v[42:43], v8 offset:2560
    v_mfma_f32_16x16x32_bf16 v[80:83], v[180:183], v[28:31], v[80:83]
    ds_read_b128 v[44:47], v7 offset:1472
    v_mfma_f32_16x16x32_bf16 v[80:83], v[52:55], v[60:63], v[80:83]
    v_mfma_f32_16x16x32_bf16 v[84:87], v[52:55], v[28:31], v[84:87]
    ds_read_b128 v[52:55], v7 offset:1984
    v_mfma_f32_16x16x32_bf16 v[84:87], v[56:59], v[60:63], v[84:87]
    v_mfma_f32_16x16x32_bf16 v[88:91], v[56:59], v[28:31], v[88:91]
    ds_read_b128 v[56:59], v7 offset:2496
    v_mfma_f32_16x16x32_bf16 v[88:91], v[48:51], v[60:63], v[88:91]
    v_mfma_f32_16x16x32_bf16 v[92:95], v[48:51], v[28:31], v[92:95]
    ds_read_b128 v[28:31], v7 offset:3008
    v_mfma_f32_16x16x32_bf16 v[92:95], v[24:27], v[60:63], v[92:95]
    ds_read_b64 v[48:49], v8 offset:36216
    s_waitcnt lgkmcnt(4)
    v_mfma_f32_16x16x32_bf16 v[72:75], v[152:155], v[68:71], v[72:75]
    ds_read_b64 v[50:51], v8 offset:36224
    v_mfma_f32_16x16x32_bf16 v[76:79], v[152:155], v[36:39], v[76:79]
    ds_read_b64 v[24:25], v8 offset:35704
    v_mfma_f32_16x16x32_bf16 v[76:79], v[184:187], v[68:71], v[76:79]
    ds_read_b64 v[26:27], v8 offset:35712
    v_mfma_f32_16x16x32_bf16 v[80:83], v[184:187], v[36:39], v[80:83]
    ds_read_b128 v[60:63], v7 offset:37504
    v_mfma_f32_16x16x32_bf16 v[80:83], v[96:99], v[68:71], v[80:83]
    v_mfma_f32_16x16x32_bf16 v[84:87], v[96:99], v[36:39], v[84:87]
    ds_read_b128 v[96:99], v7 offset:38016
    v_mfma_f32_16x16x32_bf16 v[84:87], v[100:103], v[68:71], v[84:87]
    v_mfma_f32_16x16x32_bf16 v[88:91], v[100:103], v[36:39], v[88:91]
    ds_read_b128 v[100:103], v7 offset:38528
    v_mfma_f32_16x16x32_bf16 v[88:91], v[64:67], v[68:71], v[88:91]
    v_mfma_f32_16x16x32_bf16 v[92:95], v[64:67], v[36:39], v[92:95]
    ds_read_b128 v[36:39], v7 offset:39040
    v_mfma_f32_16x16x32_bf16 v[92:95], v[20:23], v[68:71], v[92:95]
    ds_read_b64 v[64:65], v8 offset:36280
    v_mfma_f32_16x16x32_bf16 v[72:75], v[156:159], v[32:35], v[72:75]
    ds_read_b64 v[66:67], v8 offset:36288
    v_mfma_f32_16x16x32_bf16 v[76:79], v[156:159], v[40:43], v[76:79]
    ds_read_b64 v[20:21], v8 offset:35768
    v_mfma_f32_16x16x32_bf16 v[76:79], v[188:191], v[32:35], v[76:79]
    ds_read_b64 v[22:23], v8 offset:35776
    v_mfma_f32_16x16x32_bf16 v[80:83], v[188:191], v[40:43], v[80:83]
    ds_read_b128 v[68:71], v7 offset:37568
    v_mfma_f32_16x16x32_bf16 v[80:83], v[44:47], v[32:35], v[80:83]
    v_mfma_f32_16x16x32_bf16 v[84:87], v[44:47], v[40:43], v[84:87]
    ds_read_b128 v[44:47], v7 offset:38080
    s_waitcnt lgkmcnt(5)
    v_mfma_f32_16x16x32_bf16 v[84:87], v[52:55], v[32:35], v[84:87]
    v_cvt_pk_bf16_f32 v16, v72, v73
    v_cvt_pk_bf16_f32 v17, v74, v75
    v_cvt_pk_bf16_f32 v18, v76, v77
    v_cvt_pk_bf16_f32 v19, v78, v79
    ds_write_addtid_b32 v16 offset:8704
    ds_write_addtid_b32 v17 offset:8960
    v_mfma_f32_16x16x32_bf16 v[88:91], v[52:55], v[40:43], v[88:91]
    ds_write_addtid_b32 v18 offset:9216
    ds_write_addtid_b32 v19 offset:9472
    v_mfma_f32_16x16x32_bf16 v[88:91], v[56:59], v[32:35], v[88:91]
    ds_read_b128 v[52:55], v7 offset:38592
    v_mfma_f32_16x16x32_bf16 v[92:95], v[56:59], v[40:43], v[92:95]
    ds_read_b128 v[72:75], v7 offset:39104
    v_mfma_f32_16x16x32_bf16 v[92:95], v[28:31], v[32:35], v[92:95]
    ds_read_b64 v[76:77], v8 offset:36344
    v_mfma_f32_16x16x32_bf16 v[104:107], v[192:195], v[48:51], v[104:107]
    ds_read_b64 v[78:79], v8 offset:36352
    v_mfma_f32_16x16x32_bf16 v[108:111], v[192:195], v[24:27], v[108:111]
    ds_read_b64 v[40:41], v8 offset:35832
    v_mfma_f32_16x16x32_bf16 v[108:111], v[224:227], v[48:51], v[108:111]
    ds_read_b64 v[42:43], v8 offset:35840
    v_mfma_f32_16x16x32_bf16 v[112:115], v[224:227], v[24:27], v[112:115]
    ds_read_b64 v[56:57], v8 offset:36408
    v_mfma_f32_16x16x32_bf16 v[112:115], v[60:63], v[48:51], v[112:115]
    ds_read_b64 v[58:59], v8 offset:36416
    v_mfma_f32_16x16x32_bf16 v[116:119], v[60:63], v[24:27], v[116:119]
    ds_read_b64 v[28:29], v8 offset:35896
    v_mfma_f32_16x16x32_bf16 v[116:119], v[96:99], v[48:51], v[116:119]
    ds_read_b64 v[30:31], v8 offset:35904
    v_mfma_f32_16x16x32_bf16 v[120:123], v[96:99], v[24:27], v[120:123]
    ds_read_b64 v[32:33], v8 offset:36472
    v_mfma_f32_16x16x32_bf16 v[120:123], v[100:103], v[48:51], v[120:123]
    ds_read_b64 v[34:35], v8 offset:36480
    v_mfma_f32_16x16x32_bf16 v[124:127], v[100:103], v[24:27], v[124:127]
    ds_read_b64 v[60:61], v8 offset:35960
    v_mfma_f32_16x16x32_bf16 v[124:127], v[36:39], v[48:51], v[124:127]
    ds_read_b64 v[62:63], v8 offset:35968
    s_waitcnt lgkmcnt(6)
    v_mfma_f32_16x16x32_bf16 v[104:107], v[196:199], v[64:67], v[104:107]
    ds_read_b64 v[96:97], v8 offset:36536
    v_mfma_f32_16x16x32_bf16 v[108:111], v[196:199], v[20:23], v[108:111]
    ds_read_b64 v[98:99], v8 offset:36544
    v_mfma_f32_16x16x32_bf16 v[108:111], v[228:231], v[64:67], v[108:111]
    ds_read_b64 v[24:25], v8 offset:36024
    v_mfma_f32_16x16x32_bf16 v[112:115], v[228:231], v[20:23], v[112:115]
    ds_read_b64 v[26:27], v8 offset:36032
    v_mfma_f32_16x16x32_bf16 v[112:115], v[68:71], v[64:67], v[112:115]
    ds_read_b64 v[100:101], v8 offset:36600
    v_mfma_f32_16x16x32_bf16 v[116:119], v[68:71], v[20:23], v[116:119]
    ds_read_b64 v[102:103], v8 offset:36608
    v_mfma_f32_16x16x32_bf16 v[116:119], v[44:47], v[64:67], v[116:119]
    ds_read_b64 v[36:37], v8 offset:36088
    v_mfma_f32_16x16x32_bf16 v[120:123], v[44:47], v[20:23], v[120:123]
    ds_read_b64 v[38:39], v8 offset:36096
    v_mfma_f32_16x16x32_bf16 v[120:123], v[52:55], v[64:67], v[120:123]
    ds_read_b64 v[48:49], v8 offset:36664
    v_mfma_f32_16x16x32_bf16 v[124:127], v[52:55], v[20:23], v[124:127]
    ds_read_b64 v[50:51], v8 offset:36672
    v_mfma_f32_16x16x32_bf16 v[124:127], v[72:75], v[64:67], v[124:127]
    ds_read_b64 v[68:69], v8 offset:36152
    v_mfma_f32_16x16x32_bf16 v[104:107], v[200:203], v[76:79], v[104:107]
    ds_read_b64 v[70:71], v8 offset:36160
    v_mfma_f32_16x16x32_bf16 v[108:111], v[200:203], v[40:43], v[108:111]
    ds_read_b128 v[44:47], v7 offset:37632
    v_mfma_f32_16x16x32_bf16 v[108:111], v[232:235], v[76:79], v[108:111]
    ds_read_b128 v[20:23], v7 offset:38144
    v_mfma_f32_16x16x32_bf16 v[104:107], v[204:207], v[56:59], v[104:107]
    ds_read_b128 v[52:55], v7 offset:38656
    s_waitcnt lgkmcnt(6)
    v_mfma_f32_16x16x32_bf16 v[108:111], v[204:207], v[28:31], v[108:111]
    ds_read_b128 v[64:67], v7 offset:39168
    v_mfma_f32_16x16x32_bf16 v[108:111], v[236:239], v[56:59], v[108:111]
    ds_read_b128 v[72:75], v7 offset:37696
    v_mfma_f32_16x16x32_bf16 v[104:107], v[208:211], v[32:35], v[104:107]
    v_mfma_f32_16x16x32_bf16 v[108:111], v[208:211], v[60:63], v[108:111]
    v_mfma_f32_16x16x32_bf16 v[108:111], v[240:243], v[32:35], v[108:111]
    v_mfma_f32_16x16x32_bf16 v[104:107], v[212:215], v[96:99], v[104:107]
    v_mfma_f32_16x16x32_bf16 v[108:111], v[212:215], v[24:27], v[108:111]
    v_mfma_f32_16x16x32_bf16 v[108:111], v[244:247], v[96:99], v[108:111]
    v_mfma_f32_16x16x32_bf16 v[104:107], v[216:219], v[100:103], v[104:107]
    v_mfma_f32_16x16x32_bf16 v[108:111], v[216:219], v[36:39], v[108:111]
    v_mfma_f32_16x16x32_bf16 v[108:111], v[248:251], v[100:103], v[108:111]
    s_waitcnt lgkmcnt(0)
    v_mfma_f32_16x16x32_bf16 v[104:107], v[220:223], v[48:51], v[104:107]
    v_mfma_f32_16x16x32_bf16 v[108:111], v[220:223], v[68:71], v[108:111]
    v_mfma_f32_16x16x32_bf16 v[108:111], v[252:255], v[48:51], v[108:111]
    v_mfma_f32_16x16x32_bf16 v[112:115], v[232:235], v[40:43], v[112:115]
    v_mfma_f32_16x16x32_bf16 v[112:115], v[44:47], v[76:79], v[112:115]
    v_mfma_f32_16x16x32_bf16 v[116:119], v[44:47], v[40:43], v[116:119]
    ds_read_b128 v[44:47], v7 offset:38208
    v_mfma_f32_16x16x32_bf16 v[116:119], v[20:23], v[76:79], v[116:119]
    v_mfma_f32_16x16x32_bf16 v[120:123], v[20:23], v[40:43], v[120:123]
    ds_read_b128 v[20:23], v7 offset:38720
    v_mfma_f32_16x16x32_bf16 v[120:123], v[52:55], v[76:79], v[120:123]
    v_cvt_pk_bf16_f32 v16, v104, v105
    v_cvt_pk_bf16_f32 v17, v106, v107
    v_cvt_pk_bf16_f32 v18, v108, v109
    v_cvt_pk_bf16_f32 v19, v110, v111
    ds_write_addtid_b32 v16 offset:13056
    ds_write_addtid_b32 v17 offset:13312
    v_mfma_f32_16x16x32_bf16 v[124:127], v[52:55], v[40:43], v[124:127]
    ds_write_addtid_b32 v18 offset:13568
    ds_write_addtid_b32 v19 offset:13824
    v_mov_b32 v3, 4
    ds_write_b32 v6, v3
    v_mfma_f32_16x16x32_bf16 v[124:127], v[64:67], v[76:79], v[124:127]
    ds_read_b128 v[40:43], v7 offset:39232
    v_mfma_f32_16x16x32_bf16 v[112:115], v[236:239], v[28:31], v[112:115]
    ds_read_b128 v[52:55], v7 offset:37760
    v_mfma_f32_16x16x32_bf16 v[112:115], v[72:75], v[56:59], v[112:115]
    ds_read_b128 v[104:107], v7 offset:38272
    v_mfma_f32_16x16x32_bf16 v[116:119], v[72:75], v[28:31], v[116:119]
    ds_read_b128 v[108:111], v7 offset:38784
    s_waitcnt lgkmcnt(9)
    v_mfma_f32_16x16x32_bf16 v[116:119], v[44:47], v[56:59], v[116:119]
    ds_read_b128 v[64:67], v7 offset:39296
    v_mfma_f32_16x16x32_bf16 v[120:123], v[44:47], v[28:31], v[120:123]
    ds_read_b128 v[76:79], v7 offset:37824
    v_mfma_f32_16x16x32_bf16 v[120:123], v[20:23], v[56:59], v[120:123]
    ds_read_b128 v[72:75], v7 offset:38336
    v_mfma_f32_16x16x32_bf16 v[124:127], v[20:23], v[28:31], v[124:127]
    ds_read_b128 v[44:47], v7 offset:38848
    s_waitcnt lgkmcnt(6)
    v_mfma_f32_16x16x32_bf16 v[124:127], v[40:43], v[56:59], v[124:127]
    ds_read_b128 v[20:23], v7 offset:39360
    v_mfma_f32_16x16x32_bf16 v[112:115], v[240:243], v[60:63], v[112:115]
    ds_read_b128 v[28:31], v7 offset:37888
    v_mfma_f32_16x16x32_bf16 v[112:115], v[52:55], v[32:35], v[112:115]
    ds_read_b128 v[40:43], v7 offset:38400
    v_mfma_f32_16x16x32_bf16 v[116:119], v[52:55], v[60:63], v[116:119]
    ds_read_b128 v[56:59], v7 offset:38912
    s_waitcnt lgkmcnt(6)
    v_mfma_f32_16x16x32_bf16 v[116:119], v[104:107], v[32:35], v[116:119]
    ds_read_b128 v[52:55], v7 offset:39424
    v_mfma_f32_16x16x32_bf16 v[120:123], v[104:107], v[60:63], v[120:123]
    ds_read_b128 v[104:107], v7 offset:37952
    v_mfma_f32_16x16x32_bf16 v[120:123], v[108:111], v[32:35], v[120:123]
    v_mfma_f32_16x16x32_bf16 v[124:127], v[108:111], v[60:63], v[124:127]
    ds_read_b128 v[60:63], v7 offset:38464
    v_mfma_f32_16x16x32_bf16 v[124:127], v[64:67], v[32:35], v[124:127]
    ds_read_b128 v[108:111], v7 offset:38976
    v_mfma_f32_16x16x32_bf16 v[112:115], v[244:247], v[24:27], v[112:115]
    ds_read_b128 v[32:35], v7 offset:39488
    v_mfma_f32_16x16x32_bf16 v[112:115], v[76:79], v[96:99], v[112:115]
    v_mfma_f32_16x16x32_bf16 v[116:119], v[76:79], v[24:27], v[116:119]
    s_waitcnt lgkmcnt(3)
    v_mfma_f32_16x16x32_bf16 v[116:119], v[72:75], v[96:99], v[116:119]
    v_mfma_f32_16x16x32_bf16 v[120:123], v[72:75], v[24:27], v[120:123]
    v_mfma_f32_16x16x32_bf16 v[120:123], v[44:47], v[96:99], v[120:123]
    v_mfma_f32_16x16x32_bf16 v[124:127], v[44:47], v[24:27], v[124:127]
    v_mfma_f32_16x16x32_bf16 v[124:127], v[20:23], v[96:99], v[124:127]
    ds_read_b128 v[12:15], v5
    v_mfma_f32_16x16x32_bf16 v[112:115], v[248:251], v[36:39], v[112:115]
    v_mfma_f32_16x16x32_bf16 v[112:115], v[28:31], v[100:103], v[112:115]
    v_mfma_f32_16x16x32_bf16 v[116:119], v[28:31], v[36:39], v[116:119]
    v_mfma_f32_16x16x32_bf16 v[116:119], v[40:43], v[100:103], v[116:119]
    v_mfma_f32_16x16x32_bf16 v[120:123], v[40:43], v[36:39], v[120:123]
    v_mfma_f32_16x16x32_bf16 v[120:123], v[56:59], v[100:103], v[120:123]
    s_waitcnt lgkmcnt(0)
    v_min3_u32 v12, v12, v13, v14
    v_min_u32 v12, v12, v15
    s_nop 0
    v_readfirstlane_b32 s86, v12
    s_cmp_ge_u32 s86, 5
    s_cbranch_scc1 L_ok27
L_spin28:
    s_sleep 1
    ds_read_b128 v[12:15], v5
    s_waitcnt lgkmcnt(0)
    v_min3_u32 v12, v12, v13, v14
    v_min_u32 v12, v12, v15
    s_nop 0
    v_readfirstlane_b32 s86, v12
    s_cmp_ge_u32 s86, 5
    s_cbranch_scc0 L_spin28
L_ok27:
    v_mfma_f32_16x16x32_bf16 v[124:127], v[56:59], v[36:39], v[124:127]
    ds_read_b64 v[64:65], v8 offset:1592
    v_mfma_f32_16x16x32_bf16 v[124:127], v[52:55], v[100:103], v[124:127]
    ds_read_b64 v[66:67], v8 offset:1600
    v_mfma_f32_16x16x32_bf16 v[112:115], v[252:255], v[68:71], v[112:115]
    ds_read_b64 v[76:77], v8 offset:1080
    v_mfma_f32_16x16x32_bf16 v[112:115], v[104:107], v[48:51], v[112:115]
    ds_read_b64 v[78:79], v8 offset:1088
    v_mfma_f32_16x16x32_bf16 v[116:119], v[104:107], v[68:71], v[116:119]
    ds_read_b128 v[72:75], v7 offset:1024
    v_mfma_f32_16x16x32_bf16 v[116:119], v[60:63], v[48:51], v[116:119]
    ds_read_b128 v[24:27], v7 offset:1536
    v_mfma_f32_16x16x32_bf16 v[120:123], v[60:63], v[68:71], v[120:123]
    ds_read_b64 v[44:45], v8 offset:1656
    v_mfma_f32_16x16x32_bf16 v[120:123], v[108:111], v[48:51], v[120:123]
    ds_read_b64 v[46:47], v8 offset:1664
    v_mfma_f32_16x16x32_bf16 v[124:127], v[108:111], v[68:71], v[124:127]
    ds_read_b64 v[20:21], v8 offset:1144
    v_mfma_f32_16x16x32_bf16 v[124:127], v[32:35], v[48:51], v[124:127]
    ds_read_b64 v[22:23], v8 offset:1152
    s_waitcnt lgkmcnt(6)
    v_mfma_f32_16x16x32_bf16 v[80:83], v[128:131], v[64:67], v[80:83]
    ds_read_b128 v[96:99], v7 offset:1088
    v_mfma_f32_16x16x32_bf16 v[84:87], v[128:131], v[76:79], v[84:87]
    ds_read_b128 v[28:31], v7 offset:1600
    v_mfma_f32_16x16x32_bf16 v[84:87], v[160:163], v[64:67], v[84:87]
    ds_read_b64 v[40:41], v8 offset:1720
    v_mfma_f32_16x16x32_bf16 v[88:91], v[160:163], v[76:79], v[88:91]
    ds_read_b64 v[42:43], v8 offset:1728
    s_waitcnt lgkmcnt(6)
    v_mfma_f32_16x16x32_bf16 v[88:91], v[72:75], v[64:67], v[88:91]
    ds_read_b64 v[36:37], v8 offset:1208
    v_mfma_f32_16x16x32_bf16 v[92:95], v[72:75], v[76:79], v[92:95]
    ds_read_b64 v[38:39], v8 offset:1216
    v_mfma_f32_16x16x32_bf16 v[92:95], v[24:27], v[64:67], v[92:95]
    ds_read_b128 v[56:59], v7 offset:1152
    v_mfma_f32_16x16x32_bf16 v[80:83], v[132:135], v[44:47], v[80:83]
    ds_read_b128 v[52:55], v7 offset:1664
    s_waitcnt lgkmcnt(6)
    v_mfma_f32_16x16x32_bf16 v[84:87], v[132:135], v[20:23], v[84:87]
    ds_read_b64 v[100:101], v8 offset:1784
    v_mfma_f32_16x16x32_bf16 v[84:87], v[164:167], v[44:47], v[84:87]
    ds_read_b64 v[102:103], v8 offset:1792
    v_mfma_f32_16x16x32_bf16 v[88:91], v[164:167], v[20:23], v[88:91]
    ds_read_b64 v[104:105], v8 offset:1272
    v_mfma_f32_16x16x32_bf16 v[88:91], v[96:99], v[44:47], v[88:91]
    ds_read_b64 v[106:107], v8 offset:1280
    v_mfma_f32_16x16x32_bf16 v[92:95], v[96:99], v[20:23], v[92:95]
    ds_read_b128 v[60:63], v7 offset:1216
    v_mfma_f32_16x16x32_bf16 v[92:95], v[28:31], v[44:47], v[92:95]
    ds_read_b128 v[68:71], v7 offset:1728
    s_waitcnt lgkmcnt(6)
    v_mfma_f32_16x16x32_bf16 v[80:83], v[136:139], v[40:43], v[80:83]
    ds_read_b64 v[108:109], v8 offset:1848
    v_mfma_f32_16x16x32_bf16 v[84:87], v[136:139], v[36:39], v[84:87]
    ds_read_b64 v[110:111], v8 offset:1856
    v_mfma_f32_16x16x32_bf16 v[84:87], v[168:171], v[40:43], v[84:87]
    ds_read_b64 v[32:33], v8 offset:1336
    v_mfma_f32_16x16x32_bf16 v[88:91], v[168:171], v[36:39], v[88:91]
    ds_read_b64 v[34:35], v8 offset:1344
    v_mfma_f32_16x16x32_bf16 v[88:91], v[56:59], v[40:43], v[88:91]
    ds_read_b128 v[48:51], v7 offset:1280
    v_mfma_f32_16x16x32_bf16 v[92:95], v[56:59], v[36:39], v[92:95]
    ds_read_b128 v[72:75], v7 offset:1792
    v_mfma_f32_16x16x32_bf16 v[92:95], v[52:55], v[40:43], v[92:95]
    ds_read_b64 v[76:77], v8 offset:1912
    s_waitcnt lgkmcnt(6)
    v_mfma_f32_16x16x32_bf16 v[80:83], v[140:143], v[100:103], v[80:83]
    ds_read_b64 v[78:79], v8 offset:1920
    v_mfma_f32_16x16x32_bf16 v[84:87], v[140:143], v[104:107], v[84:87]
    ds_read_b64 v[24:25], v8 offset:1400
    v_mfma_f32_16x16x32_bf16 v[84:87], v[172:175], v[100:103], v[84:87]
    ds_read_b64 v[26:27], v8 offset:1408
    v_mfma_f32_16x16x32_bf16 v[88:91], v[172:175], v[104:107], v[88:91]
    ds_read_b128 v[64:67], v7 offset:1344
    v_mfma_f32_16x16x32_bf16 v[88:91], v[60:63], v[100:103], v[88:91]
    ds_read_b128 v[20:23], v7 offset:1856
    v_mfma_f32_16x16x32_bf16 v[92:95], v[60:63], v[104:107], v[92:95]
    ds_read_b64 v[96:97], v8 offset:1976
    v_mfma_f32_16x16x32_bf16 v[92:95], v[68:71], v[100:103], v[92:95]
    ds_read_b64 v[98:99], v8 offset:1984
    s_waitcnt lgkmcnt(6)
    v_mfma_f32_16x16x32_bf16 v[80:83], v[144:147], v[108:111], v[80:83]
    ds_read_b64 v[28:29], v8 offset:1464
    v_mfma_f32_16x16x32_bf16 v[84:87], v[144:147], v[32:35], v[84:87]
    ds_read_b64 v[30:31], v8 offset:1472
    v_mfma_f32_16x16x32_bf16 v[84:87], v[176:179], v[108:111], v[84:87]
    ds_read_b128 v[44:47], v7 offset:1408
    v_mfma_f32_16x16x32_bf16 v[88:91], v[176:179], v[32:35], v[88:91]
    ds_read_b128 v[36:39], v7 offset:1920
    v_mfma_f32_16x16x32_bf16 v[88:91], v[48:51], v[108:111], v[88:91]
    ds_read_b64 v[56:57], v8 offset:2040
    v_mfma_f32_16x16x32_bf16 v[92:95], v[48:51], v[32:35], v[92:95]
    ds_read_b64 v[58:59], v8 offset:2048
    v_mfma_f32_16x16x32_bf16 v[92:95], v[72:75], v[108:111], v[92:95]
    ds_read_b64 v[40:41], v8 offset:1528
    v_mfma_f32_16x16x32_bf16 v[80:83], v[148:151], v[76:79], v[80:83]
    ds_read_b64 v[42:43], v8 offset:1536
    s_waitcnt lgkmcnt(6)
    v_mfma_f32_16x16x32_bf16 v[84:87], v[148:151], v[24:27], v[84:87]
    ds_read_b128 v[52:55], v7 offset:1472
    v_mfma_f32_16x16x32_bf16 v[84:87], v[180:183], v[76:79], v[84:87]
    ds_read_b128 v[60:63], v7 offset:1984
    v_mfma_f32_16x16x32_bf16 v[88:91], v[180:183], v[24:27], v[88:91]
    ds_read_b64 v[104:105], v8 offset:35192
    v_mfma_f32_16x16x32_bf16 v[88:91], v[64:67], v[76:79], v[88:91]
    ds_read_b64 v[106:107], v8 offset:35200
    v_mfma_f32_16x16x32_bf16 v[92:95], v[64:67], v[24:27], v[92:95]
    ds_read_b64 v[68:69], v8 offset:34680
    v_mfma_f32_16x16x32_bf16 v[92:95], v[20:23], v[76:79], v[92:95]
    ds_read_b64 v[70:71], v8 offset:34688
    v_mfma_f32_16x16x32_bf16 v[80:83], v[152:155], v[96:99], v[80:83]
    ds_read_b64 v[100:101], v8 offset:35256
    v_mfma_f32_16x16x32_bf16 v[84:87], v[152:155], v[28:31], v[84:87]
    ds_read_b64 v[102:103], v8 offset:35264
    v_mfma_f32_16x16x32_bf16 v[84:87], v[184:187], v[96:99], v[84:87]
    ds_read_b64 v[32:33], v8 offset:34744
    v_mfma_f32_16x16x32_bf16 v[88:91], v[184:187], v[28:31], v[88:91]
    ds_read_b64 v[34:35], v8 offset:34752
    s_waitcnt lgkmcnt(6)
    v_mfma_f32_16x16x32_bf16 v[88:91], v[44:47], v[96:99], v[88:91]
    ds_read_b64 v[48:49], v8 offset:35320
    v_mfma_f32_16x16x32_bf16 v[92:95], v[44:47], v[28:31], v[92:95]
    ds_read_b64 v[50:51], v8 offset:35328
    v_mfma_f32_16x16x32_bf16 v[92:95], v[36:39], v[96:99], v[92:95]
    ds_read_b64 v[72:73], v8 offset:34808
    v_mfma_f32_16x16x32_bf16 v[80:83], v[156:159], v[56:59], v[80:83]
    ds_read_b64 v[74:75], v8 offset:34816
    v_mfma_f32_16x16x32_bf16 v[84:87], v[156:159], v[40:43], v[84:87]
    ds_read_b64 v[108:109], v8 offset:35384
    v_mfma_f32_16x16x32_bf16 v[84:87], v[188:191], v[56:59], v[84:87]
    ds_read_b64 v[110:111], v8 offset:35392
    v_mfma_f32_16x16x32_bf16 v[88:91], v[188:191], v[40:43], v[88:91]
    ds_read_b64 v[24:25], v8 offset:34872
    v_mfma_f32_16x16x32_bf16 v[88:91], v[52:55], v[56:59], v[88:91]
    ds_read_b64 v[26:27], v8 offset:34880
    v_mfma_f32_16x16x32_bf16 v[92:95], v[52:55], v[40:43], v[92:95]
    ds_read_b64 v[64:65], v8 offset:35448
    v_mfma_f32_16x16x32_bf16 v[92:95], v[60:63], v[56:59], v[92:95]
    ds_read_b64 v[66:67], v8 offset:35456
    v_cvt_pk_bf16_f32 v16, v80, v81
    v_cvt_pk_bf16_f32 v17, v82, v83
    v_cvt_pk_bf16_f32 v18, v84, v85
    v_cvt_pk_bf16_f32 v19, v86, v87
    s_mov_b32 m0, s73
    s_nop 0
    ds_write_addtid_b32 v16 offset:0
    v_mfma_f32_16x16x32_bf16 v[112:115], v[192:195], v[104:107], v[112:115]
    ds_write_addtid_b32 v17 offset:256
    ds_write_addtid_b32 v18 offset:512
    ds_write_addtid_b32 v19 offset:768
    s_waitcnt lgkmcnt(9)
    v_mfma_f32_16x16x32_bf16 v[116:119], v[192:195], v[68:71], v[116:119]
    ds_read_b64 v[20:21], v8 offset:34936
    v_mfma_f32_16x16x32_bf16 v[116:119], v[224:227], v[104:107], v[116:119]
    ds_read_b64 v[22:23], v8 offset:34944
    v_mfma_f32_16x16x32_bf16 v[112:115], v[196:199], v[100:103], v[112:115]
    ds_read_b64 v[76:77], v8 offset:35512
    v_mfma_f32_16x16x32_bf16 v[116:119], v[196:199], v[32:35], v[116:119]
    ds_read_b64 v[78:79], v8 offset:35520
    v_mfma_f32_16x16x32_bf16 v[116:119], v[228:231], v[100:103], v[116:119]
    ds_read_b64 v[28:29], v8 offset:35000
    v_mfma_f32_16x16x32_bf16 v[112:115], v[200:203], v[48:51], v[112:115]
    ds_read_b64 v[30:31], v8 offset:35008
    v_mfma_f32_16x16x32_bf16 v[116:119], v[200:203], v[72:75], v[116:119]
    ds_read_b64 v[44:45], v8 offset:35576
    ds_read_b128 v[12:15], v5
    v_mfma_f32_16x16x32_bf16 v[116:119], v[232:235], v[48:51], v[116:119]
    ds_read_b64 v[46:47], v8 offset:35584
    s_waitcnt lgkmcnt(7)
    v_mfma_f32_16x16x32_bf16 v[112:115], v[204:207], v[108:111], v[112:115]
    ds_read_b64 v[36:37], v8 offset:35064
    v_mfma_f32_16x16x32_bf16 v[116:119], v[204:207], v[24:27], v[116:119]
    ds_read_b64 v[38:39], v8 offset:35072
    v_mfma_f32_16x16x32_bf16 v[116:119], v[236:239], v[108:111], v[116:119]
    ds_read_b64 v[96:97], v8 offset:35640
    v_mfma_f32_16x16x32_bf16 v[112:115], v[208:211], v[64:67], v[112:115]
    ds_read_b64 v[98:99], v8 offset:35648
    v_mfma_f32_16x16x32_bf16 v[116:119], v[208:211], v[20:23], v[116:119]
    ds_read_b64 v[40:41], v8 offset:35128
    s_waitcnt lgkmcnt(6)
    v_min3_u32 v12, v12, v13, v14
    v_min_u32 v12, v12, v15
    s_nop 0
    v_readfirstlane_b32 s86, v12
    s_cmp_ge_u32 s86, 6
    s_cbranch_scc1 L_ok29
L_spin30:
    s_sleep 1
    ds_read_b128 v[12:15], v5
    s_waitcnt lgkmcnt(0)
    v_min3_u32 v12, v12, v13, v14
    v_min_u32 v12, v12, v15
    s_nop 0
    v_readfirstlane_b32 s86, v12
    s_cmp_ge_u32 s86, 6
    s_cbranch_scc0 L_spin30
L_ok29:
    v_mfma_f32_16x16x32_bf16 v[116:119], v[240:243], v[64:67], v[116:119]
    ds_read_b64 v[42:43], v8 offset:35136
    v_mfma_f32_16x16x32_bf16 v[112:115], v[212:215], v[76:79], v[112:115]
    ds_read_b64 v[52:53], v8 offset:568
    v_mfma_f32_16x16x32_bf16 v[116:119], v[212:215], v[28:31], v[116:119]
    ds_read_b64 v[54:55], v8 offset:576
    v_mfma_f32_16x16x32_bf16 v[116:119], v[244:247], v[76:79], v[116:119]
    ds_read_b64 v[56:57], v8 offset:56
    s_waitcnt lgkmcnt(6)
    v_mfma_f32_16x16x32_bf16 v[112:115], v[216:219], v[44:47], v[112:115]
    ds_read_b64 v[58:59], v8 offset:64
    v_mfma_f32_16x16x32_bf16 v[116:119], v[216:219], v[36:39], v[116:119]
    ds_read_b64 v[60:61], v8 offset:632
    v_mfma_f32_16x16x32_bf16 v[116:119], v[248:251], v[44:47], v[116:119]
    ds_read_b64 v[62:63], v8 offset:640
    s_waitcnt lgkmcnt(6)
    v_mfma_f32_16x16x32_bf16 v[112:115], v[220:223], v[96:99], v[112:115]
    ds_read_b64 v[80:81], v8 offset:120
    ds_read_b64 v[82:83], v8 offset:128
    v_mfma_f32_16x16x32_bf16 v[116:119], v[220:223], v[40:43], v[116:119]
    ds_read_b64 v[84:85], v8 offset:696
    v_mfma_f32_16x16x32_bf16 v[116:119], v[252:255], v[96:99], v[116:119]
    ds_read_b64 v[86:87], v8 offset:704
    s_waitcnt lgkmcnt(7)
    v_mfma_f32_16x16x32_bf16 v[88:91], v[128:131], v[52:55], v[88:91]
    s_waitcnt lgkmcnt(6)
    v_mfma_f32_16x16x32_bf16 v[92:95], v[128:131], v[56:59], v[92:95]
    ds_read_b64 v[56:57], v8 offset:184
    ds_read_b64 v[58:59], v8 offset:192
    v_mfma_f32_16x16x32_bf16 v[92:95], v[160:163], v[52:55], v[92:95]
    ds_read_b64 v[128:129], v8 offset:760
    ds_read_b64 v[130:131], v8 offset:768
    v_cvt_pk_bf16_f32 v16, v112, v113
    v_cvt_pk_bf16_f32 v17, v114, v115
    v_cvt_pk_bf16_f32 v18, v116, v117
    v_cvt_pk_bf16_f32 v19, v118, v119
    s_waitcnt lgkmcnt(8)
    v_mfma_f32_16x16x32_bf16 v[88:91], v[132:135], v[60:63], v[88:91]
    ds_read_b64 v[52:53], v8 offset:248
    ds_read_b64 v[54:55], v8 offset:256
    ds_write_addtid_b32 v16 offset:33600
    ds_write_addtid_b32 v17 offset:33856
    ds_write_addtid_b32 v18 offset:34112
    ds_write_addtid_b32 v19 offset:34368
    s_waitcnt lgkmcnt(12)
    v_mfma_f32_16x16x32_bf16 v[92:95], v[132:135], v[80:83], v[92:95]
    ds_read_b64 v[160:161], v8 offset:824
    v_mov_b32 v3, 6
    ds_write_b32 v6, v3
    v_mfma_f32_16x16x32_bf16 v[92:95], v[164:167], v[60:63], v[92:95]
    ds_read_b64 v[162:163], v8 offset:832
    s_waitcnt lgkmcnt(13)
    v_mfma_f32_16x16x32_bf16 v[88:91], v[136:139], v[84:87], v[88:91]
    ds_read_b64 v[112:113], v8 offset:312
    ds_read_b64 v[114:115], v8 offset:320
    s_waitcnt lgkmcnt(13)
    v_mfma_f32_16x16x32_bf16 v[92:95], v[136:139], v[56:59], v[92:95]
    ds_read_b64 v[116:117], v8 offset:888
    v_mfma_f32_16x16x32_bf16 v[92:95], v[168:171], v[84:87], v[92:95]
    ds_read_b64 v[118:119], v8 offset:896
    s_waitcnt lgkmcnt(13)
    v_mfma_f32_16x16x32_bf16 v[88:91], v[140:143], v[128:131], v[88:91]
    ds_read_b64 v[80:81], v8 offset:376
    ds_read_b64 v[82:83], v8 offset:384
    s_waitcnt lgkmcnt(9)
    v_mfma_f32_16x16x32_bf16 v[92:95], v[140:143], v[52:55], v[92:95]
    ds_read_b64 v[132:133], v8 offset:952
    v_mfma_f32_16x16x32_bf16 v[92:95], v[172:175], v[128:131], v[92:95]
    ds_read_b64 v[134:135], v8 offset:960
    s_waitcnt lgkmcnt(8)
    v_mfma_f32_16x16x32_bf16 v[88:91], v[144:147], v[160:163], v[88:91]
    ds_read_b64 v[60:61], v8 offset:440
    ds_read_b64 v[62:63], v8 offset:448
    s_waitcnt lgkmcnt(8)
    v_mfma_f32_16x16x32_bf16 v[92:95], v[144:147], v[112:115], v[92:95]
    ds_read_b64 v[164:165], v8 offset:1016
    v_mfma_f32_16x16x32_bf16 v[92:95], v[176:179], v[160:163], v[92:95]
    ds_read_b64 v[166:167], v8 offset:1024
    s_waitcnt lgkmcnt(8)
    v_mfma_f32_16x16x32_bf16 v[88:91], v[148:151], v[116:119], v[88:91]
    ds_read_b64 v[56:57], v8 offset:504
    ds_read_b64 v[58:59], v8 offset:512
    s_waitcnt lgkmcnt(8)
    v_mfma_f32_16x16x32_bf16 v[92:95], v[148:151], v[80:83], v[92:95]
    ds_read_b64 v[136:137], v8 offset:34168
    v_mfma_f32_16x16x32_bf16 v[92:95], v[180:183], v[116:119], v[92:95]
    ds_read_b64 v[138:139], v8 offset:34176
    s_waitcnt lgkmcnt(8)
    v_mfma_f32_16x16x32_bf16 v[88:91], v[152:155], v[132:135], v[88:91]
    ds_read_b128 v[84:87], v7 offset:37504
    s_waitcnt lgkmcnt(7)
    v_mfma_f32_16x16x32_bf16 v[92:95], v[152:155], v[60:63], v[92:95]
    ds_read_b64 v[168:169], v8 offset:34232
    v_mfma_f32_16x16x32_bf16 v[92:95], v[184:187], v[132:135], v[92:95]
    ds_read_b64 v[170:171], v8 offset:34240
    s_waitcnt lgkmcnt(7)
    v_mfma_f32_16x16x32_bf16 v[88:91], v[156:159], v[164:167], v[88:91]
    ds_read_b128 v[52:55], v7 offset:37568
    s_waitcnt lgkmcnt(6)
    v_mfma_f32_16x16x32_bf16 v[92:95], v[156:159], v[56:59], v[92:95]
    ds_read_b64 v[140:141], v8 offset:34296
    v_mfma_f32_16x16x32_bf16 v[92:95], v[188:191], v[164:167], v[92:95]
    ds_read_b64 v[142:143], v8 offset:34304
    s_waitcnt lgkmcnt(6)
    v_mfma_f32_16x16x32_bf16 v[120:123], v[192:195], v[136:139], v[120:123]
    ds_read_b128 v[128:131], v7 offset:37632
    v_mfma_f32_16x16x32_bf16 v[120:123], v[224:227], v[68:71], v[120:123]
    ds_read_b64 v[172:173], v8 offset:34360
    s_waitcnt lgkmcnt(6)
    v_mfma_f32_16x16x32_bf16 v[120:123], v[84:87], v[104:107], v[120:123]
    ds_read_b64 v[174:175], v8 offset:34368
    v_cvt_pk_bf16_f32 v16, v88, v89
    v_cvt_pk_bf16_f32 v17, v90, v91
    v_cvt_pk_bf16_f32 v18, v92, v93
    v_cvt_pk_bf16_f32 v19, v94, v95
    s_waitcnt lgkmcnt(6)
    v_mfma_f32_16x16x32_bf16 v[120:123], v[196:199], v[168:171], v[120:123]
    ds_write_addtid_b32 v16 offset:4224
    ds_write_addtid_b32 v17 offset:4480
    ds_write_addtid_b32 v18 offset:4736
    ds_write_addtid_b32 v19 offset:4992
    v_mfma_f32_16x16x32_bf16 v[120:123], v[228:231], v[32:35], v[120:123]
    ds_read_b128 v[112:115], v7 offset:37696
    s_waitcnt lgkmcnt(9)
    v_mfma_f32_16x16x32_bf16 v[120:123], v[52:55], v[100:103], v[120:123]
    ds_read_b64 v[144:145], v8 offset:34424
    ds_read_b64 v[146:147], v8 offset:34432
    s_waitcnt lgkmcnt(10)
    v_mfma_f32_16x16x32_bf16 v[120:123], v[200:203], v[140:143], v[120:123]
    ds_read_b128 v[160:163], v7 offset:37760
    v_mfma_f32_16x16x32_bf16 v[120:123], v[232:235], v[72:75], v[120:123]
    ds_read_b64 v[176:177], v8 offset:34488
    s_waitcnt lgkmcnt(10)
    v_mfma_f32_16x16x32_bf16 v[120:123], v[128:131], v[48:51], v[120:123]
    ds_read_b64 v[178:179], v8 offset:34496
    s_waitcnt lgkmcnt(10)
    v_mfma_f32_16x16x32_bf16 v[120:123], v[204:207], v[172:175], v[120:123]
    ds_read_b128 v[80:83], v7 offset:37824
    v_mfma_f32_16x16x32_bf16 v[120:123], v[236:239], v[24:27], v[120:123]
    ds_read_b64 v[148:149], v8 offset:34552
    s_waitcnt lgkmcnt(7)
    v_mfma_f32_16x16x32_bf16 v[120:123], v[112:115], v[108:111], v[120:123]
    ds_read_b64 v[150:151], v8 offset:34560
    s_waitcnt lgkmcnt(6)
    v_mfma_f32_16x16x32_bf16 v[120:123], v[208:211], v[144:147], v[120:123]
    ds_read_b128 v[116:119], v7 offset:37888
    v_mfma_f32_16x16x32_bf16 v[120:123], v[240:243], v[20:23], v[120:123]
    ds_read_b64 v[180:181], v8 offset:34616
    s_waitcnt lgkmcnt(6)
    v_mfma_f32_16x16x32_bf16 v[120:123], v[160:163], v[64:67], v[120:123]
    ds_read_b64 v[182:183], v8 offset:34624
    s_waitcnt lgkmcnt(6)
    v_mfma_f32_16x16x32_bf16 v[120:123], v[212:215], v[176:179], v[120:123]
    ds_read_b128 v[60:63], v7 offset:37952
    v_mfma_f32_16x16x32_bf16 v[120:123], v[244:247], v[28:31], v[120:123]
    ds_read_b64 v[152:153], v8 offset:33656
    s_waitcnt lgkmcnt(6)
    v_mfma_f32_16x16x32_bf16 v[120:123], v[80:83], v[76:79], v[120:123]
    ds_read_b64 v[154:155], v8 offset:33664
    s_waitcnt lgkmcnt(6)
    v_mfma_f32_16x16x32_bf16 v[120:123], v[216:219], v[148:151], v[120:123]
    ds_read_b128 v[132:135], v7 offset:38016
    v_mfma_f32_16x16x32_bf16 v[120:123], v[248:251], v[36:39], v[120:123]
    ds_read_b64 v[184:185], v8 offset:33720
    s_waitcnt lgkmcnt(6)
    v_mfma_f32_16x16x32_bf16 v[120:123], v[116:119], v[44:47], v[120:123]
    ds_read_b64 v[186:187], v8 offset:33728
    s_waitcnt lgkmcnt(6)
    v_mfma_f32_16x16x32_bf16 v[120:123], v[220:223], v[180:183], v[120:123]
    ds_read_b128 v[56:59], v7 offset:38080
    v_mfma_f32_16x16x32_bf16 v[120:123], v[252:255], v[40:43], v[120:123]
    ds_read_b64 v[156:157], v8 offset:33784
    s_waitcnt lgkmcnt(6)
    v_mfma_f32_16x16x32_bf16 v[120:123], v[60:63], v[96:99], v[120:123]
    ds_read_b64 v[158:159], v8 offset:33792
    s_waitcnt lgkmcnt(6)
    v_mfma_f32_16x16x32_bf16 v[124:127], v[192:195], v[152:155], v[124:127]
    ds_read_b128 v[164:167], v7 offset:38144
    v_mfma_f32_16x16x32_bf16 v[124:127], v[224:227], v[136:139], v[124:127]
    ds_read_b64 v[188:189], v8 offset:33848
    v_mfma_f32_16x16x32_bf16 v[124:127], v[84:87], v[68:71], v[124:127]
    ds_read_b64 v[190:191], v8 offset:33856
    s_waitcnt lgkmcnt(6)
    v_mfma_f32_16x16x32_bf16 v[124:127], v[132:135], v[104:107], v[124:127]
    ds_read_b128 v[88:91], v7 offset:38208
    v_cvt_pk_bf16_f32 v16, v120, v121
    v_cvt_pk_bf16_f32 v17, v122, v123
    ds_write_addtid_b32 v16 offset:37824
    ds_write_addtid_b32 v17 offset:38080
    v_mov_b32 v3, 7
    v_mfma_f32_16x16x32_bf16 v[124:127], v[196:199], v[184:187], v[124:127]
    ds_write_b32 v6, v3
    v_mfma_f32_16x16x32_bf16 v[124:127], v[228:231], v[168:171], v[124:127]
    ds_read_b64 v[92:93], v8 offset:33912
    v_mfma_f32_16x16x32_bf16 v[124:127], v[52:55], v[32:35], v[124:127]
    ds_read_b64 v[94:95], v8 offset:33920
    s_waitcnt lgkmcnt(8)
    v_mfma_f32_16x16x32_bf16 v[124:127], v[56:59], v[100:103], v[124:127]
    ds_read_b128 v[152:155], v7 offset:38272
    v_mfma_f32_16x16x32_bf16 v[124:127], v[200:203], v[156:159], v[124:127]
    ds_read_b64 v[192:193], v8 offset:33976
    v_mfma_f32_16x16x32_bf16 v[124:127], v[232:235], v[140:143], v[124:127]
    ds_read_b64 v[194:195], v8 offset:33984
    v_mfma_f32_16x16x32_bf16 v[124:127], v[128:131], v[72:75], v[124:127]
    ds_read_b128 v[136:139], v7 offset:38336
    v_mfma_f32_16x16x32_bf16 v[124:127], v[164:167], v[48:51], v[124:127]
    ds_read_b64 v[224:225], v8 offset:34040
    s_waitcnt lgkmcnt(6)
    v_mfma_f32_16x16x32_bf16 v[124:127], v[204:207], v[188:191], v[124:127]
    ds_read_b64 v[226:227], v8 offset:34048
    v_mfma_f32_16x16x32_bf16 v[124:127], v[236:239], v[172:175], v[124:127]
    ds_read_b128 v[68:71], v7 offset:38400
    v_mfma_f32_16x16x32_bf16 v[124:127], v[112:115], v[24:27], v[124:127]
    ds_read_b64 v[84:85], v8 offset:34104
    v_mfma_f32_16x16x32_bf16 v[124:127], v[88:91], v[108:111], v[124:127]
    ds_read_b64 v[86:87], v8 offset:34112
    s_waitcnt lgkmcnt(6)
    v_mfma_f32_16x16x32_bf16 v[124:127], v[208:211], v[92:95], v[124:127]
    ds_read_b128 v[104:107], v7 offset:38464
    v_mfma_f32_16x16x32_bf16 v[124:127], v[240:243], v[144:147], v[124:127]
    v_mfma_f32_16x16x32_bf16 v[124:127], v[160:163], v[20:23], v[124:127]
    v_mfma_f32_16x16x32_bf16 v[124:127], v[152:155], v[64:67], v[124:127]
    v_mfma_f32_16x16x32_bf16 v[124:127], v[212:215], v[192:195], v[124:127]
    v_mfma_f32_16x16x32_bf16 v[124:127], v[244:247], v[176:179], v[124:127]
    v_mfma_f32_16x16x32_bf16 v[124:127], v[80:83], v[28:31], v[124:127]
    s_waitcnt lgkmcnt(0)
    v_mfma_f32_16x16x32_bf16 v[124:127], v[136:139], v[76:79], v[124:127]
    v_mfma_f32_16x16x32_bf16 v[124:127], v[216:219], v[224:227], v[124:127]
    v_mfma_f32_16x16x32_bf16 v[124:127], v[248:251], v[148:151], v[124:127]
    v_mfma_f32_16x16x32_bf16 v[124:127], v[116:119], v[36:39], v[124:127]
    v_mfma_f32_16x16x32_bf16 v[124:127], v[68:71], v[44:47], v[124:127]
    v_mfma_f32_16x16x32_bf16 v[124:127], v[220:223], v[84:87], v[124:127]
    v_mfma_f32_16x16x32_bf16 v[124:127], v[252:255], v[180:183], v[124:127]
    v_mfma_f32_16x16x32_bf16 v[124:127], v[60:63], v[40:43], v[124:127]
    v_mfma_f32_16x16x32_bf16 v[124:127], v[104:107], v[96:99], v[124:127]
    s_nop 7
    v_cvt_pk_bf16_f32 v16, v124, v125
    v_cvt_pk_bf16_f32 v17, v126, v127
    ds_write_addtid_b32 v16 offset:38336
    ds_write_addtid_b32 v17 offset:38592
    v_mov_b32 v3, 8
    ds_write_b32 v6, v3
    s_endpgm
L_BM_body:
    global_load_dword v4, v20, s[38:39]
    v_lshlrev_b32 v104, 4, v0
    v_lshl_add_u32 v105, s85, 12, v104
    s_lshl_b32 s86, s85, 1
    v_lshlrev_b32 v106, 12, v0
    v_add_u32 v106, s86, v106
    s_mov_b32 s66, 0x400000
    s_mov_b32 s67, 0x20000
    s_mov_b32 s70, 0x800
    s_mov_b32 s71, 0x20000
    s_mov_b64 s[64:65], s[42:43]
    s_mov_b64 s[68:69], s[44:45]
    s_barrier
    s_mov_b32 s90, 0xffff0000
    s_mul_i32 s91, s83, 9120
    s_lshl_b32 s86, s83, 2
    s_and_b32 s86, s86, 16
    s_sub_u32 s86, 157584, s86
    v_mov_b32 v5, s86
    v_add_u32 v104, s91, v104
    v_mov_b32 v80, 0
    v_mov_b32 v81, 0
    v_mov_b32 v82, 0
    v_mov_b32 v83, 0
    v_mov_b32 v96, 0
    v_and_b32 v1, 31, v0
    v_min_u32 v1, 27, v1
    v_lshlrev_b32 v1, 4, v1
    v_lshrrev_b32 v3, 5, v0
    v_mul_u32_u24 v3, 4576, v3
    v_add3_u32 v1, v1, v3, s91
    ds_write_b128 v1, v[80:83]
    v_and_b32 v3, 1, v0
    v_xor_b32 v3, 1, v3
    v_and_b32 v2, 48, v0
    v_mul_u32_u24 v7, 4576, v3
    v_bfe_u32 v1, v0, 1, 3
    v_lshl_add_u32 v7, v1, 6, v7
    v_add3_u32 v7, v7, v2, s91
    s_lshl_b32 s86, s83, 2
    s_and_b32 s86, s86, 8
    s_add_u32 s86, s86, 4224
    v_mul_u32_u24 v8, s86, v3
    v_lshlrev_b32 v1, 3, v1
    v_sub_u32 v8, v8, v1
    s_mul_i32 s87, s83, 8400
    s_add_u32 s87, s87, 72960
    v_add3_u32 v8, v8, v2, s87
    v_and_b32 v1, 31, v0
    v_min_u32 v1, 14, v1
    v_lshlrev_b32 v1, 2, v1
    v_lshrrev_b32 v2, 5, v0
    s_add_u32 s86, s86, -4
    v_mul_u32_u24 v2, s86, v2
    v_add3_u32 v1, v1, v2, s87
    v_mov_b32 v2, 0
    ds_write_b32 v1, v2 offset:4096
    ds_write_b32 v1, v2 offset:37696
    s_add_u32 s73, s87, 3072
    s_mul_i32 s86, s83, 1088
    s_add_u32 s72, s86, 140160
    buffer_load_dwordx4 v[64:67], v105, s[64:67], 0 offen offset:0
    buffer_load_dwordx4 v[68:71], v105, s[64:67], 0 offen offset:1024
    buffer_load_dwordx4 v[72:75], v105, s[64:67], 0 offen offset:2048
    buffer_load_dwordx4 v[76:79], v105, s[64:67], 0 offen offset:3072
    buffer_load_ushort v100, v106, s[68:71], 0 offen offset:0
    s_waitcnt vmcnt(0)
    v_mov_b32_dpp v97, v67 wave_ror:1 row_mask:0xf bank_mask:0xf
    v_mov_b32_dpp v98, v71 wave_ror:1 row_mask:0xf bank_mask:0xf
    v_mov_b32_dpp v99, v75 wave_ror:1 row_mask:0xf bank_mask:0xf
    v_lshlrev_b32 v100, 16, v100
    v_lshlrev_b32 v101, 16, v64
    v_mov_b32_dpp v96, v67 wave_shr:1 row_mask:0xf bank_mask:0xf
    v_mov_b32_dpp v97, v71 wave_shr:1 row_mask:0xf bank_mask:0xf
    v_mov_b32_dpp v98, v75 wave_shr:1 row_mask:0xf bank_mask:0xf
    v_mov_b32_dpp v99, v79 wave_shr:1 row_mask:0xf bank_mask:0xf
    v_and_b32 v102, s90, v64
    v_add_f32 v101, v101, v100
    v_cvt_pk_bf16_f32 v64, v101, v102
    ds_write_b128 v104, v[64:67] offset:448
    v_alignbit_b32 v80, v64, v96, 16
    v_alignbit_b32 v81, v65, v64, 16
    v_alignbit_b32 v82, v66, v65, 16
    v_alignbit_b32 v83, v67, v66, 16
    ds_write_b128 v104, v[80:83] offset:5024
    ds_write_b128 v104, v[68:71] offset:1472
    v_alignbit_b32 v84, v68, v97, 16
    v_alignbit_b32 v85, v69, v68, 16
    v_alignbit_b32 v86, v70, v69, 16
    v_alignbit_b32 v87, v71, v70, 16
    ds_write_b128 v104, v[84:87] offset:6048
    ds_write_b128 v104, v[72:75] offset:2496
    v_alignbit_b32 v88, v72, v98, 16
    v_alignbit_b32 v89, v73, v72, 16
    v_alignbit_b32 v90, v74, v73, 16
    v_alignbit_b32 v91, v75, v74, 16
    ds_write_b128 v104, v[88:91] offset:7072
    ds_write_b128 v104, v[76:79] offset:3520
    v_alignbit_b32 v92, v76, v99, 16
    v_alignbit_b32 v93, v77, v76, 16
    v_alignbit_b32 v94, v78, v77, 16
    v_alignbit_b32 v95, v79, v78, 16
    ds_write_b128 v104, v[92:95] offset:8096
    ds_read_b128 v[128:131], v7 offset:0
    ds_read_b128 v[160:163], v7 offset:512
    ds_read_b128 v[132:135], v7 offset:64
    ds_read_b128 v[164:167], v7 offset:576
    ds_read_b128 v[136:139], v7 offset:128
    ds_read_b128 v[168:171], v7 offset:640
    ds_read_b128 v[140:143], v7 offset:192
    ds_read_b128 v[172:175], v7 offset:704
    ds_read_b128 v[144:147], v7 offset:256
    ds_read_b128 v[176:179], v7 offset:768
    ds_read_b128 v[148:151], v7 offset:320
    ds_read_b128 v[180:183], v7 offset:832
    ds_read_b128 v[152:155], v7 offset:384
    ds_read_b128 v[184:187], v7 offset:896
    ds_read_b128 v[156:159], v7 offset:448
    ds_read_b128 v[188:191], v7 offset:960
    ds_read_b128 v[12:15], v5
    s_waitcnt lgkmcnt(0)
    v_min3_u32 v12, v12, v13, v14
    v_min_u32 v12, v12, v15
    s_nop 0
    v_readfirstlane_b32 s86, v12
    s_cmp_ge_u32 s86, 1
    s_cbranch_scc1 L_ok31
L_spin32:
    ds_read_b128 v[12:15], v5
    s_waitcnt lgkmcnt(0)
    v_min3_u32 v12, v12, v13, v14
    v_min_u32 v12, v12, v15
    s_nop 0
    v_readfirstlane_b32 s86, v12
    s_cmp_ge_u32 s86, 1
    s_cbranch_scc0 L_spin32
L_ok31:
    ds_read_b64 v[192:193], v8 offset:3640
    ds_read_b64 v[194:195], v8 offset:3648
    ds_read_b64 v[224:225], v8 offset:3128
    ds_read_b64 v[226:227], v8 offset:3136
    ds_read_b128 v[88:91], v7 offset:1024
    ds_read_b128 v[92:95], v7 offset:1536
    ds_read_b128 v[196:199], v7 offset:2048
    ds_read_b128 v[228:231], v7 offset:2560
    ds_read_b128 v[96:99], v7 offset:3072
    ds_read_b128 v[100:103], v7 offset:3584
    ds_read_b64 v[104:105], v8 offset:3704
    ds_read_b64 v[106:107], v8 offset:3712
    s_setprio 0
    s_waitcnt lgkmcnt(10)
    v_mfma_f32_16x16x32_bf16 v[64:67], v[128:131], v[192:195], 0
    ds_read_b64 v[108:109], v8 offset:3192
    s_waitcnt lgkmcnt(9)
    v_mfma_f32_16x16x32_bf16 v[68:71], v[128:131], v[224:227], 0
    ds_read_b64 v[110:111], v8 offset:3200
    v_mfma_f32_16x16x32_bf16 v[68:71], v[160:163], v[192:195], v[68:71]
    ds_read_b128 v[112:115], v7 offset:1088
    v_mfma_f32_16x16x32_bf16 v[72:75], v[160:163], v[224:227], 0
    ds_read_b128 v[116:119], v7 offset:1600
    s_waitcnt lgkmcnt(11)
    v_mfma_f32_16x16x32_bf16 v[72:75], v[88:91], v[192:195], v[72:75]
    ds_read_b128 v[200:203], v7 offset:2112
    v_mfma_f32_16x16x32_bf16 v[76:79], v[88:91], v[224:227], 0
    ds_read_b128 v[120:123], v7 offset:2624
    s_waitcnt lgkmcnt(6)
    v_mfma_f32_16x16x32_bf16 v[76:79], v[92:95], v[192:195], v[76:79]
    ds_read_b128 v[232:235], v7 offset:3136
    v_mfma_f32_16x16x32_bf16 v[80:83], v[92:95], v[224:227], 0
    ds_read_b128 v[124:127], v7 offset:3648
    v_mfma_f32_16x16x32_bf16 v[80:83], v[196:199], v[192:195], v[80:83]
    ds_read_b64 v[204:205], v8 offset:3768
    v_mfma_f32_16x16x32_bf16 v[84:87], v[196:199], v[224:227], 0
    ds_read_b64 v[206:207], v8 offset:3776
    v_mfma_f32_16x16x32_bf16 v[84:87], v[228:231], v[192:195], v[84:87]
    ds_read_b64 v[196:197], v8 offset:3256
    v_mfma_f32_16x16x32_bf16 v[88:91], v[228:231], v[224:227], 0
    ds_read_b64 v[198:199], v8 offset:3264
    v_mfma_f32_16x16x32_bf16 v[88:91], v[96:99], v[192:195], v[88:91]
    ds_read_b128 v[228:231], v7 offset:1152
    v_mfma_f32_16x16x32_bf16 v[92:95], v[96:99], v[224:227], 0
    ds_read_b128 v[224:227], v7 offset:1664
    v_mfma_f32_16x16x32_bf16 v[92:95], v[100:103], v[192:195], v[92:95]
    ds_read_b128 v[192:195], v7 offset:2176
    v_mfma_f32_16x16x32_bf16 v[64:67], v[132:135], v[104:107], v[64:67]
    ds_read_b128 v[96:99], v7 offset:2688
    s_waitcnt lgkmcnt(6)
    v_mfma_f32_16x16x32_bf16 v[68:71], v[132:135], v[108:111], v[68:71]
    ds_read_b128 v[100:103], v7 offset:3200
    v_mfma_f32_16x16x32_bf16 v[68:71], v[164:167], v[104:107], v[68:71]
    ds_read_b128 v[236:239], v7 offset:3712
    v_mfma_f32_16x16x32_bf16 v[72:75], v[164:167], v[108:111], v[72:75]
    ds_read_b64 v[208:209], v8 offset:3832
    v_mfma_f32_16x16x32_bf16 v[72:75], v[112:115], v[104:107], v[72:75]
    ds_read_b64 v[210:211], v8 offset:3840
    v_mfma_f32_16x16x32_bf16 v[76:79], v[112:115], v[108:111], v[76:79]
    ds_read_b64 v[112:113], v8 offset:3320
    v_mfma_f32_16x16x32_bf16 v[76:79], v[116:119], v[104:107], v[76:79]
    ds_read_b64 v[114:115], v8 offset:3328
    v_mfma_f32_16x16x32_bf16 v[80:83], v[116:119], v[108:111], v[80:83]
    ds_read_b128 v[116:119], v7 offset:1216
    v_mfma_f32_16x16x32_bf16 v[80:83], v[200:203], v[104:107], v[80:83]
    ds_read_b128 v[240:243], v7 offset:1728
    v_mfma_f32_16x16x32_bf16 v[84:87], v[200:203], v[108:111], v[84:87]
    ds_read_b128 v[200:203], v7 offset:2240
    v_mfma_f32_16x16x32_bf16 v[84:87], v[120:123], v[104:107], v[84:87]
    ds_read_b128 v[212:215], v7 offset:2752
    v_mfma_f32_16x16x32_bf16 v[88:91], v[120:123], v[108:111], v[88:91]
    ds_read_b128 v[120:123], v7 offset:3264
    v_mfma_f32_16x16x32_bf16 v[88:91], v[232:235], v[104:107], v[88:91]
    ds_read_b128 v[244:247], v7 offset:3776
    v_mfma_f32_16x16x32_bf16 v[92:95], v[232:235], v[108:111], v[92:95]
    ds_read_b64 v[108:109], v8 offset:3896
    v_mfma_f32_16x16x32_bf16 v[92:95], v[124:127], v[104:107], v[92:95]
    ds_read_b64 v[110:111], v8 offset:3904
    v_mfma_f32_16x16x32_bf16 v[64:67], v[136:139], v[204:207], v[64:67]
    ds_read_b64 v[104:105], v8 offset:3384
    s_waitcnt lgkmcnt(6)
    v_mfma_f32_16x16x32_bf16 v[68:71], v[136:139], v[196:199], v[68:71]
    ds_read_b64 v[106:107], v8 offset:3392
    v_mfma_f32_16x16x32_bf16 v[68:71], v[168:171], v[204:207], v[68:71]
    ds_read_b128 v[232:235], v7 offset:1280
    v_mfma_f32_16x16x32_bf16 v[72:75], v[168:171], v[196:199], v[72:75]
    ds_read_b128 v[124:127], v7 offset:1792
    v_mfma_f32_16x16x32_bf16 v[72:75], v[228:231], v[204:207], v[72:75]
    ds_read_b128 v[216:219], v7 offset:2304
    v_mfma_f32_16x16x32_bf16 v[76:79], v[228:231], v[196:199], v[76:79]
    ds_read_b128 v[228:231], v7 offset:2816
    v_mfma_f32_16x16x32_bf16 v[76:79], v[224:227], v[204:207], v[76:79]
    ds_read_b128 v[248:251], v7 offset:3328
    v_mfma_f32_16x16x32_bf16 v[80:83], v[224:227], v[196:199], v[80:83]
    ds_read_b128 v[224:227], v7 offset:3840
    v_mfma_f32_16x16x32_bf16 v[80:83], v[192:195], v[204:207], v[80:83]
    ds_read_b64 v[220:221], v8 offset:3960
    v_mfma_f32_16x16x32_bf16 v[84:87], v[192:195], v[196:199], v[84:87]
    ds_read_b64 v[222:223], v8 offset:3968
    v_mfma_f32_16x16x32_bf16 v[84:87], v[96:99], v[204:207], v[84:87]
    ds_read_b64 v[192:193], v8 offset:3448
    v_mfma_f32_16x16x32_bf16 v[88:91], v[96:99], v[196:199], v[88:91]
    ds_read_b64 v[194:195], v8 offset:3456
    v_mfma_f32_16x16x32_bf16 v[88:91], v[100:103], v[204:207], v[88:91]
    ds_read_b128 v[96:99], v7 offset:1344
    v_mfma_f32_16x16x32_bf16 v[92:95], v[100:103], v[196:199], v[92:95]
    ds_read_b128 v[196:199], v7 offset:1856
    v_mfma_f32_16x16x32_bf16 v[92:95], v[236:239], v[204:207], v[92:95]
    ds_read_b128 v[100:103], v7 offset:2368
    v_mfma_f32_16x16x32_bf16 v[64:67], v[140:143], v[208:211], v[64:67]
    ds_read_b128 v[204:207], v7 offset:2880
    v_mfma_f32_16x16x32_bf16 v[68:71], v[140:143], v[112:115], v[68:71]
    ds_read_b128 v[236:239], v7 offset:3392
    v_mfma_f32_16x16x32_bf16 v[68:71], v[172:175], v[208:211], v[68:71]
    v_mfma_f32_16x16x32_bf16 v[72:75], v[172:175], v[112:115], v[72:75]
    ds_read_b128 v[252:255], v7 offset:3904
    v_mfma_f32_16x16x32_bf16 v[72:75], v[116:119], v[208:211], v[72:75]
    ds_read_b64 v[20:21], v8 offset:4024
    v_mfma_f32_16x16x32_bf16 v[76:79], v[116:119], v[112:115], v[76:79]
    ds_read_b64 v[22:23], v8 offset:4032
    v_mfma_f32_16x16x32_bf16 v[76:79], v[240:243], v[208:211], v[76:79]
    ds_read_b64 v[116:117], v8 offset:3512
    v_mfma_f32_16x16x32_bf16 v[80:83], v[240:243], v[112:115], v[80:83]
    ds_read_b64 v[118:119], v8 offset:3520
    v_mfma_f32_16x16x32_bf16 v[80:83], v[200:203], v[208:211], v[80:83]
    ds_read_b128 v[240:243], v7 offset:1408
    v_mfma_f32_16x16x32_bf16 v[84:87], v[200:203], v[112:115], v[84:87]
    s_waitcnt lgkmcnt(5)
    v_mfma_f32_16x16x32_bf16 v[84:87], v[212:215], v[208:211], v[84:87]
    ds_read_b128 v[200:203], v7 offset:1920
    v_mfma_f32_16x16x32_bf16 v[88:91], v[212:215], v[112:115], v[88:91]
    v_mfma_f32_16x16x32_bf16 v[88:91], v[120:123], v[208:211], v[88:91]
    ds_read_b128 v[212:215], v7 offset:2432
    v_mfma_f32_16x16x32_bf16 v[92:95], v[120:123], v[112:115], v[92:95]
    v_mfma_f32_16x16x32_bf16 v[92:95], v[244:247], v[208:211], v[92:95]
    ds_read_b128 v[112:115], v7 offset:2944
    v_mfma_f32_16x16x32_bf16 v[64:67], v[144:147], v[108:111], v[64:67]
    v_mfma_f32_16x16x32_bf16 v[68:71], v[144:147], v[104:107], v[68:71]
    ds_read_b128 v[120:123], v7 offset:3456
    v_mfma_f32_16x16x32_bf16 v[68:71], v[176:179], v[108:111], v[68:71]
    v_mfma_f32_16x16x32_bf16 v[72:75], v[176:179], v[104:107], v[72:75]
    ds_read_b128 v[208:211], v7 offset:3968
    v_mfma_f32_16x16x32_bf16 v[72:75], v[232:235], v[108:111], v[72:75]
    ds_read_b64 v[244:245], v8 offset:4088
    v_mfma_f32_16x16x32_bf16 v[76:79], v[232:235], v[104:107], v[76:79]
    ds_read_b64 v[246:247], v8 offset:4096
    v_mfma_f32_16x16x32_bf16 v[76:79], v[124:127], v[108:111], v[76:79]
    ds_read_b64 v[232:233], v8 offset:3576
    v_mfma_f32_16x16x32_bf16 v[80:83], v[124:127], v[104:107], v[80:83]
    ds_read_b64 v[234:235], v8 offset:3584
    v_mfma_f32_16x16x32_bf16 v[80:83], v[216:219], v[108:111], v[80:83]
    ds_read_b128 v[124:127], v7 offset:1472
    v_mfma_f32_16x16x32_bf16 v[84:87], v[216:219], v[104:107], v[84:87]
    v_mfma_f32_16x16x32_bf16 v[84:87], v[228:231], v[108:111], v[84:87]
    ds_read_b128 v[216:219], v7 offset:1984
    v_mfma_f32_16x16x32_bf16 v[88:91], v[228:231], v[104:107], v[88:91]
    v_mfma_f32_16x16x32_bf16 v[88:91], v[248:251], v[108:111], v[88:91]
    ds_read_b128 v[24:27], v7 offset:2496
    v_mfma_f32_16x16x32_bf16 v[92:95], v[248:251], v[104:107], v[92:95]
    v_mfma_f32_16x16x32_bf16 v[92:95], v[224:227], v[108:111], v[92:95]
    ds_read_b128 v[104:107], v7 offset:3008
    v_mfma_f32_16x16x32_bf16 v[64:67], v[148:151], v[220:223], v[64:67]
    v_mfma_f32_16x16x32_bf16 v[68:71], v[148:151], v[192:195], v[68:71]
    ds_read_b128 v[108:111], v7 offset:3520
    v_mfma_f32_16x16x32_bf16 v[68:71], v[180:183], v[220:223], v[68:71]
    v_mfma_f32_16x16x32_bf16 v[72:75], v[180:183], v[192:195], v[72:75]
    ds_read_b128 v[248:251], v7 offset:4032
    v_mfma_f32_16x16x32_bf16 v[72:75], v[96:99], v[220:223], v[72:75]
    v_mfma_f32_16x16x32_bf16 v[76:79], v[96:99], v[192:195], v[76:79]
    v_mfma_f32_16x16x32_bf16 v[76:79], v[196:199], v[220:223], v[76:79]
    v_mfma_f32_16x16x32_bf16 v[80:83], v[196:199], v[192:195], v[80:83]
    v_mfma_f32_16x16x32_bf16 v[80:83], v[100:103], v[220:223], v[80:83]
    v_mfma_f32_16x16x32_bf16 v[84:87], v[100:103], v[192:195], v[84:87]
    v_mfma_f32_16x16x32_bf16 v[84:87], v[204:207], v[220:223], v[84:87]
    v_mfma_f32_16x16x32_bf16 v[88:91], v[204:207], v[192:195], v[88:91]
    v_mfma_f32_16x16x32_bf16 v[88:91], v[236:239], v[220:223], v[88:91]
    v_mfma_f32_16x16x32_bf16 v[92:95], v[236:239], v[192:195], v[92:95]
    v_mfma_f32_16x16x32_bf16 v[92:95], v[252:255], v[220:223], v[92:95]
    s_waitcnt lgkmcnt(0)
    v_mfma_f32_16x16x32_bf16 v[64:67], v[152:155], v[20:23], v[64:67]
    v_mfma_f32_16x16x32_bf16 v[68:71], v[152:155], v[116:119], v[68:71]
    v_mfma_f32_16x16x32_bf16 v[68:71], v[184:187], v[20:23], v[68:71]
    v_mfma_f32_16x16x32_bf16 v[72:75], v[184:187], v[116:119], v[72:75]
    v_mfma_f32_16x16x32_bf16 v[72:75], v[240:243], v[20:23], v[72:75]
    v_mfma_f32_16x16x32_bf16 v[76:79], v[240:243], v[116:119], v[76:79]
    v_mfma_f32_16x16x32_bf16 v[76:79], v[200:203], v[20:23], v[76:79]
    v_mfma_f32_16x16x32_bf16 v[80:83], v[200:203], v[116:119], v[80:83]
    v_mfma_f32_16x16x32_bf16 v[80:83], v[212:215], v[20:23], v[80:83]
    v_mfma_f32_16x16x32_bf16 v[84:87], v[212:215], v[116:119], v[84:87]
    v_mfma_f32_16x16x32_bf16 v[84:87], v[112:115], v[20:23], v[84:87]
    v_mfma_f32_16x16x32_bf16 v[88:91], v[112:115], v[116:119], v[88:91]
    v_mfma_f32_16x16x32_bf16 v[88:91], v[120:123], v[20:23], v[88:91]
    v_mfma_f32_16x16x32_bf16 v[92:95], v[120:123], v[116:119], v[92:95]
    ds_read_b128 v[12:15], v5
    v_mfma_f32_16x16x32_bf16 v[92:95], v[208:211], v[20:23], v[92:95]
    v_mfma_f32_16x16x32_bf16 v[64:67], v[156:159], v[244:247], v[64:67]
    v_mfma_f32_16x16x32_bf16 v[68:71], v[156:159], v[232:235], v[68:71]
    v_mfma_f32_16x16x32_bf16 v[68:71], v[188:191], v[244:247], v[68:71]
    v_mfma_f32_16x16x32_bf16 v[72:75], v[188:191], v[232:235], v[72:75]
    v_mfma_f32_16x16x32_bf16 v[72:75], v[124:127], v[244:247], v[72:75]
    s_waitcnt lgkmcnt(0)
    v_min3_u32 v12, v12, v13, v14
    v_min_u32 v12, v12, v15
    s_nop 0
    v_readfirstlane_b32 s86, v12
    s_cmp_ge_u32 s86, 2
    s_cbranch_scc1 L_ok33
L_spin34:
    s_sleep 1
    ds_read_b128 v[12:15], v5
    s_waitcnt lgkmcnt(0)
    v_min3_u32 v12, v12, v13, v14
    v_min_u32 v12, v12, v15
    s_nop 0
    v_readfirstlane_b32 s86, v12
    s_cmp_ge_u32 s86, 2
    s_cbranch_scc0 L_spin34
L_ok33:
    v_mfma_f32_16x16x32_bf16 v[76:79], v[124:127], v[232:235], v[76:79]
    ds_read_b64 v[204:205], v8 offset:37240
    v_cvt_pk_bf16_f32 v16, v64, v65
    v_cvt_pk_bf16_f32 v17, v66, v67
    v_cvt_pk_bf16_f32 v18, v68, v69
    v_cvt_pk_bf16_f32 v19, v70, v71
    s_mov_b32 m0, s72
    s_nop 0
    ds_write_addtid_b32 v16 offset:0
    v_mfma_f32_16x16x32_bf16 v[76:79], v[216:219], v[244:247], v[76:79]
    ds_write_addtid_b32 v17 offset:256
    ds_write_addtid_b32 v18 offset:512
    ds_write_addtid_b32 v19 offset:768
    v_mfma_f32_16x16x32_bf16 v[80:83], v[216:219], v[232:235], v[80:83]
    ds_read_b64 v[206:207], v8 offset:37248
    v_mfma_f32_16x16x32_bf16 v[80:83], v[24:27], v[244:247], v[80:83]
    ds_read_b128 v[192:195], v7 offset:36480
    v_mfma_f32_16x16x32_bf16 v[84:87], v[24:27], v[232:235], v[84:87]
    ds_read_b64 v[236:237], v8 offset:36728
    ds_read_b64 v[238:239], v8 offset:36736
    v_mfma_f32_16x16x32_bf16 v[84:87], v[104:107], v[244:247], v[84:87]
    ds_read_b128 v[224:227], v7 offset:36992
    v_mfma_f32_16x16x32_bf16 v[88:91], v[104:107], v[232:235], v[88:91]
    ds_read_b128 v[200:203], v7 offset:37504
    v_mfma_f32_16x16x32_bf16 v[88:91], v[108:111], v[244:247], v[88:91]
    ds_read_b128 v[124:127], v7 offset:38016
    v_mfma_f32_16x16x32_bf16 v[92:95], v[108:111], v[232:235], v[92:95]
    ds_read_b128 v[208:211], v7 offset:38528
    v_mfma_f32_16x16x32_bf16 v[92:95], v[248:251], v[244:247], v[92:95]
    ds_read_b128 v[240:243], v7 offset:39040
    s_waitcnt lgkmcnt(7)
    v_mfma_f32_16x16x32_bf16 v[96:99], v[192:195], v[204:207], 0
    ds_read_b128 v[212:215], v7 offset:39552
    s_waitcnt lgkmcnt(6)
    v_mfma_f32_16x16x32_bf16 v[100:103], v[192:195], v[236:239], 0
    ds_read_b128 v[244:247], v7 offset:40064
    s_waitcnt lgkmcnt(6)
    v_mfma_f32_16x16x32_bf16 v[100:103], v[224:227], v[204:207], v[100:103]
    ds_read_b64 v[216:217], v8 offset:37304
    v_mfma_f32_16x16x32_bf16 v[104:107], v[224:227], v[236:239], 0
    ds_read_b64 v[218:219], v8 offset:37312
    s_waitcnt lgkmcnt(6)
    v_mfma_f32_16x16x32_bf16 v[104:107], v[200:203], v[204:207], v[104:107]
    ds_read_b128 v[196:199], v7 offset:36544
    v_mfma_f32_16x16x32_bf16 v[108:111], v[200:203], v[236:239], 0
    ds_read_b64 v[248:249], v8 offset:36792
    v_mfma_f32_16x16x32_bf16 v[108:111], v[124:127], v[204:207], v[108:111]
    ds_read_b64 v[250:251], v8 offset:36800
    v_mfma_f32_16x16x32_bf16 v[112:115], v[124:127], v[236:239], 0
    ds_read_b128 v[228:231], v7 offset:37056
    s_waitcnt lgkmcnt(6)
    v_mfma_f32_16x16x32_bf16 v[112:115], v[208:211], v[204:207], v[112:115]
    ds_read_b128 v[220:223], v7 offset:37568
    v_mfma_f32_16x16x32_bf16 v[116:119], v[208:211], v[236:239], 0
    ds_read_b128 v[208:211], v7 offset:38080
    v_mfma_f32_16x16x32_bf16 v[116:119], v[240:243], v[204:207], v[116:119]
    ds_read_b128 v[252:255], v7 offset:38592
    v_mfma_f32_16x16x32_bf16 v[120:123], v[240:243], v[236:239], 0
    ds_read_b128 v[240:243], v7 offset:39104
    v_mfma_f32_16x16x32_bf16 v[120:123], v[212:215], v[204:207], v[120:123]
    ds_read_b128 v[28:31], v7 offset:39616
    v_mfma_f32_16x16x32_bf16 v[124:127], v[212:215], v[236:239], 0
    ds_read_b128 v[212:215], v7 offset:40128
    v_mfma_f32_16x16x32_bf16 v[124:127], v[244:247], v[204:207], v[124:127]
    ds_read_b64 v[244:245], v8 offset:37368
    s_waitcnt lgkmcnt(6)
    v_mfma_f32_16x16x32_bf16 v[96:99], v[196:199], v[216:219], v[96:99]
    ds_read_b64 v[246:247], v8 offset:37376
    v_mfma_f32_16x16x32_bf16 v[100:103], v[196:199], v[248:251], v[100:103]
    ds_read_b128 v[200:203], v7 offset:36608
    v_mfma_f32_16x16x32_bf16 v[100:103], v[228:231], v[216:219], v[100:103]
    ds_read_b64 v[32:33], v8 offset:36856
    v_mfma_f32_16x16x32_bf16 v[104:107], v[228:231], v[248:251], v[104:107]
    ds_read_b64 v[34:35], v8 offset:36864
    v_mfma_f32_16x16x32_bf16 v[104:107], v[220:223], v[216:219], v[104:107]
    ds_read_b128 v[232:235], v7 offset:37120
    v_mfma_f32_16x16x32_bf16 v[108:111], v[220:223], v[248:251], v[108:111]
    ds_read_b128 v[220:223], v7 offset:37632
    s_waitcnt lgkmcnt(6)
    v_mfma_f32_16x16x32_bf16 v[108:111], v[208:211], v[216:219], v[108:111]
    ds_read_b128 v[36:39], v7 offset:38144
    v_mfma_f32_16x16x32_bf16 v[112:115], v[208:211], v[248:251], v[112:115]
    ds_read_b128 v[40:43], v7 offset:38656
    v_mfma_f32_16x16x32_bf16 v[112:115], v[252:255], v[216:219], v[112:115]
    ds_read_b128 v[44:47], v7 offset:39168
    v_mfma_f32_16x16x32_bf16 v[116:119], v[252:255], v[248:251], v[116:119]
    ds_read_b128 v[252:255], v7 offset:39680
    v_mfma_f32_16x16x32_bf16 v[116:119], v[240:243], v[216:219], v[116:119]
    ds_read_b128 v[48:51], v7 offset:40192
    v_mfma_f32_16x16x32_bf16 v[120:123], v[240:243], v[248:251], v[120:123]
    ds_read_b64 v[52:53], v8 offset:37432
    v_mfma_f32_16x16x32_bf16 v[120:123], v[28:31], v[216:219], v[120:123]
    ds_read_b64 v[54:55], v8 offset:37440
    v_mfma_f32_16x16x32_bf16 v[124:127], v[28:31], v[248:251], v[124:127]
    ds_read_b128 v[204:207], v7 offset:36672
    v_mfma_f32_16x16x32_bf16 v[124:127], v[212:215], v[216:219], v[124:127]
    ds_read_b64 v[216:217], v8 offset:36920
    s_waitcnt lgkmcnt(6)
    v_mfma_f32_16x16x32_bf16 v[96:99], v[200:203], v[244:247], v[96:99]
    ds_read_b64 v[218:219], v8 offset:36928
    v_mfma_f32_16x16x32_bf16 v[100:103], v[200:203], v[32:35], v[100:103]
    ds_read_b128 v[236:239], v7 offset:37184
    v_mfma_f32_16x16x32_bf16 v[100:103], v[232:235], v[244:247], v[100:103]
    ds_read_b128 v[212:215], v7 offset:37696
    v_mfma_f32_16x16x32_bf16 v[104:107], v[232:235], v[32:35], v[104:107]
    ds_read_b128 v[248:251], v7 offset:38208
    v_mfma_f32_16x16x32_bf16 v[104:107], v[220:223], v[244:247], v[104:107]
    ds_read_b128 v[56:59], v7 offset:38720
    v_mfma_f32_16x16x32_bf16 v[108:111], v[220:223], v[32:35], v[108:111]
    ds_read_b128 v[220:223], v7 offset:39232
    v_mfma_f32_16x16x32_bf16 v[108:111], v[36:39], v[244:247], v[108:111]
    ds_read_b128 v[60:63], v7 offset:39744
    v_mfma_f32_16x16x32_bf16 v[112:115], v[36:39], v[32:35], v[112:115]
    ds_read_b128 v[20:23], v7 offset:40256
    v_mfma_f32_16x16x32_bf16 v[112:115], v[40:43], v[244:247], v[112:115]
    ds_read_b64 v[64:65], v8 offset:37496
    v_mfma_f32_16x16x32_bf16 v[116:119], v[40:43], v[32:35], v[116:119]
    ds_read_b64 v[66:67], v8 offset:37504
    v_mfma_f32_16x16x32_bf16 v[116:119], v[44:47], v[244:247], v[116:119]
    ds_read_b128 v[208:211], v7 offset:36736
    v_mfma_f32_16x16x32_bf16 v[120:123], v[44:47], v[32:35], v[120:123]
    ds_read_b64 v[68:69], v8 offset:36984
    s_waitcnt lgkmcnt(6)
    v_mfma_f32_16x16x32_bf16 v[120:123], v[252:255], v[244:247], v[120:123]
    ds_read_b64 v[70:71], v8 offset:36992
    v_mfma_f32_16x16x32_bf16 v[124:127], v[252:255], v[32:35], v[124:127]
    ds_read_b128 v[240:243], v7 offset:37248
    v_mfma_f32_16x16x32_bf16 v[124:127], v[48:51], v[244:247], v[124:127]
    ds_read_b128 v[252:255], v7 offset:37760
    v_mfma_f32_16x16x32_bf16 v[96:99], v[204:207], v[52:55], v[96:99]
    ds_read_b128 v[24:27], v7 offset:38272
    v_mfma_f32_16x16x32_bf16 v[100:103], v[204:207], v[216:219], v[100:103]
    ds_read_b128 v[28:31], v7 offset:38784
    v_mfma_f32_16x16x32_bf16 v[100:103], v[236:239], v[52:55], v[100:103]
    ds_read_b128 v[36:39], v7 offset:39296
    v_mfma_f32_16x16x32_bf16 v[104:107], v[236:239], v[216:219], v[104:107]
    ds_read_b128 v[40:43], v7 offset:39808
    v_mfma_f32_16x16x32_bf16 v[104:107], v[212:215], v[52:55], v[104:107]
    ds_read_b128 v[44:47], v7 offset:40320
    v_mfma_f32_16x16x32_bf16 v[108:111], v[212:215], v[216:219], v[108:111]
    ds_read_b64 v[32:33], v8 offset:37560
    v_mfma_f32_16x16x32_bf16 v[108:111], v[248:251], v[52:55], v[108:111]
    ds_read_b64 v[34:35], v8 offset:37568
    v_mfma_f32_16x16x32_bf16 v[112:115], v[248:251], v[216:219], v[112:115]
    ds_read_b128 v[212:215], v7 offset:36800
    v_mfma_f32_16x16x32_bf16 v[112:115], v[56:59], v[52:55], v[112:115]
    ds_read_b64 v[48:49], v8 offset:37048
    v_mfma_f32_16x16x32_bf16 v[116:119], v[56:59], v[216:219], v[116:119]
    ds_read_b64 v[50:51], v8 offset:37056
    v_mfma_f32_16x16x32_bf16 v[116:119], v[220:223], v[52:55], v[116:119]
    ds_read_b128 v[244:247], v7 offset:37312
    v_mfma_f32_16x16x32_bf16 v[120:123], v[220:223], v[216:219], v[120:123]
    ds_read_b128 v[220:223], v7 offset:37824
    s_waitcnt lgkmcnt(6)
    v_mfma_f32_16x16x32_bf16 v[120:123], v[60:63], v[52:55], v[120:123]
    ds_read_b128 v[56:59], v7 offset:38336
    v_mfma_f32_16x16x32_bf16 v[124:127], v[60:63], v[216:219], v[124:127]
    ds_read_b128 v[60:63], v7 offset:38848
    v_mfma_f32_16x16x32_bf16 v[124:127], v[20:23], v[52:55], v[124:127]
    ds_read_b128 v[20:23], v7 offset:39360
    v_mfma_f32_16x16x32_bf16 v[96:99], v[208:211], v[64:67], v[96:99]
    ds_read_b128 v[52:55], v7 offset:39872
    v_mfma_f32_16x16x32_bf16 v[100:103], v[208:211], v[68:71], v[100:103]
    v_mfma_f32_16x16x32_bf16 v[100:103], v[240:243], v[64:67], v[100:103]
    v_mfma_f32_16x16x32_bf16 v[104:107], v[240:243], v[68:71], v[104:107]
    v_mfma_f32_16x16x32_bf16 v[104:107], v[252:255], v[64:67], v[104:107]
    v_mfma_f32_16x16x32_bf16 v[108:111], v[252:255], v[68:71], v[108:111]
    v_mfma_f32_16x16x32_bf16 v[108:111], v[24:27], v[64:67], v[108:111]
    v_mfma_f32_16x16x32_bf16 v[112:115], v[24:27], v[68:71], v[112:115]
    ds_read_b128 v[24:27], v7 offset:40384
    v_mfma_f32_16x16x32_bf16 v[112:115], v[28:31], v[64:67], v[112:115]
    v_mfma_f32_16x16x32_bf16 v[116:119], v[28:31], v[68:71], v[116:119]
    ds_read_b64 v[28:29], v8 offset:37624
    v_mfma_f32_16x16x32_bf16 v[116:119], v[36:39], v[64:67], v[116:119]
    ds_read_b64 v[30:31], v8 offset:37632
    v_mfma_f32_16x16x32_bf16 v[120:123], v[36:39], v[68:71], v[120:123]
    ds_read_b128 v[216:219], v7 offset:36864
    v_mfma_f32_16x16x32_bf16 v[120:123], v[40:43], v[64:67], v[120:123]
    ds_read_b64 v[36:37], v8 offset:37112
    v_mfma_f32_16x16x32_bf16 v[124:127], v[40:43], v[68:71], v[124:127]
    ds_read_b64 v[38:39], v8 offset:37120
    v_mfma_f32_16x16x32_bf16 v[124:127], v[44:47], v[64:67], v[124:127]
    ds_read_b128 v[248:251], v7 offset:37376
    s_waitcnt lgkmcnt(6)
    v_mfma_f32_16x16x32_bf16 v[96:99], v[212:215], v[32:35], v[96:99]
    ds_read_b128 v[40:43], v7 offset:37888
    v_mfma_f32_16x16x32_bf16 v[100:103], v[212:215], v[48:51], v[100:103]
    ds_read_b128 v[68:71], v7 offset:38400
    v_mfma_f32_16x16x32_bf16 v[100:103], v[244:247], v[32:35], v[100:103]
    ds_read_b128 v[44:47], v7 offset:38912
    v_mfma_f32_16x16x32_bf16 v[104:107], v[244:247], v[48:51], v[104:107]
    ds_read_b128 v[64:67], v7 offset:39424
    v_mfma_f32_16x16x32_bf16 v[104:107], v[220:223], v[32:35], v[104:107]
    v_mfma_f32_16x16x32_bf16 v[108:111], v[220:223], v[48:51], v[108:111]
    v_mfma_f32_16x16x32_bf16 v[108:111], v[56:59], v[32:35], v[108:111]
    v_mfma_f32_16x16x32_bf16 v[112:115], v[56:59], v[48:51], v[112:115]
    ds_read_b128 v[56:59], v7 offset:39936
    v_mfma_f32_16x16x32_bf16 v[112:115], v[60:63], v[32:35], v[112:115]
    v_mfma_f32_16x16x32_bf16 v[116:119], v[60:63], v[48:51], v[116:119]
    ds_read_b128 v[60:63], v7 offset:40448
    v_mfma_f32_16x16x32_bf16 v[116:119], v[20:23], v[32:35], v[116:119]
    v_mfma_f32_16x16x32_bf16 v[120:123], v[20:23], v[48:51], v[120:123]
    ds_read_b64 v[20:21], v8 offset:37688
    v_mfma_f32_16x16x32_bf16 v[120:123], v[52:55], v[32:35], v[120:123]
    ds_read_b64 v[22:23], v8 offset:37696
    v_mfma_f32_16x16x32_bf16 v[124:127], v[52:55], v[48:51], v[124:127]
    ds_read_b128 v[220:223], v7 offset:36928
    v_mfma_f32_16x16x32_bf16 v[124:127], v[24:27], v[32:35], v[124:127]
    ds_read_b64 v[48:49], v8 offset:37176
    s_waitcnt lgkmcnt(5)
    v_mfma_f32_16x16x32_bf16 v[96:99], v[216:219], v[28:31], v[96:99]
    ds_read_b64 v[50:51], v8 offset:37184
    v_mfma_f32_16x16x32_bf16 v[100:103], v[216:219], v[36:39], v[100:103]
    ds_read_b128 v[252:255], v7 offset:37440
    v_mfma_f32_16x16x32_bf16 v[100:103], v[248:251], v[28:31], v[100:103]
    ds_read_b128 v[52:55], v7 offset:37952
    v_mfma_f32_16x16x32_bf16 v[104:107], v[248:251], v[36:39], v[104:107]
    ds_read_b128 v[24:27], v7 offset:38464
    v_mfma_f32_16x16x32_bf16 v[104:107], v[40:43], v[28:31], v[104:107]
    ds_read_b128 v[32:35], v7 offset:38976
    v_mfma_f32_16x16x32_bf16 v[108:111], v[40:43], v[36:39], v[108:111]
    ds_read_b128 v[40:43], v7 offset:39488
    v_mfma_f32_16x16x32_bf16 v[108:111], v[68:71], v[28:31], v[108:111]
    v_mfma_f32_16x16x32_bf16 v[112:115], v[68:71], v[36:39], v[112:115]
    ds_read_b128 v[68:71], v7 offset:40000
    v_mfma_f32_16x16x32_bf16 v[112:115], v[44:47], v[28:31], v[112:115]
    v_mfma_f32_16x16x32_bf16 v[116:119], v[44:47], v[36:39], v[116:119]
    ds_read_b128 v[44:47], v7 offset:40512
    v_mfma_f32_16x16x32_bf16 v[116:119], v[64:67], v[28:31], v[116:119]
    v_mfma_f32_16x16x32_bf16 v[120:123], v[64:67], v[36:39], v[120:123]
    v_mfma_f32_16x16x32_bf16 v[120:123], v[56:59], v[28:31], v[120:123]
    v_mfma_f32_16x16x32_bf16 v[124:127], v[56:59], v[36:39], v[124:127]
    ds_read_b128 v[12:15], v5
    s_waitcnt lgkmcnt(2)
    v_mfma_f32_16x16x32_bf16 v[124:127], v[60:63], v[28:31], v[124:127]
    v_mfma_f32_16x16x32_bf16 v[96:99], v[220:223], v[20:23], v[96:99]
    v_mfma_f32_16x16x32_bf16 v[100:103], v[220:223], v[48:51], v[100:103]
    v_mfma_f32_16x16x32_bf16 v[100:103], v[252:255], v[20:23], v[100:103]
    v_mfma_f32_16x16x32_bf16 v[104:107], v[252:255], v[48:51], v[104:107]
    v_mfma_f32_16x16x32_bf16 v[104:107], v[52:55], v[20:23], v[104:107]
    s_waitcnt lgkmcnt(0)
    v_min3_u32 v12, v12, v13, v14
    v_min_u32 v12, v12, v15
    s_nop 0
    v_readfirstlane_b32 s86, v12
    s_cmp_ge_u32 s86, 3
    s_cbranch_scc1 L_ok35
L_spin36:
    s_sleep 1
    ds_read_b128 v[12:15], v5
    s_waitcnt lgkmcnt(0)
    v_min3_u32 v12, v12, v13, v14
    v_min_u32 v12, v12, v15
    s_nop 0
    v_readfirstlane_b32 s86, v12
    s_cmp_ge_u32 s86, 3
    s_cbranch_scc0 L_spin36
L_ok35:
    v_mfma_f32_16x16x32_bf16 v[108:111], v[52:55], v[48:51], v[108:111]
    ds_read_b64 v[64:65], v8 offset:2616
    v_cvt_pk_bf16_f32 v16, v96, v97
    v_cvt_pk_bf16_f32 v17, v98, v99
    v_cvt_pk_bf16_f32 v18, v100, v101
    v_cvt_pk_bf16_f32 v19, v102, v103
    ds_write_addtid_b32 v16 offset:4352
    v_mfma_f32_16x16x32_bf16 v[108:111], v[24:27], v[20:23], v[108:111]
    ds_write_addtid_b32 v17 offset:4608
    ds_write_addtid_b32 v18 offset:4864
    ds_write_addtid_b32 v19 offset:5120
    v_mov_b32 v3, 2
    ds_write_b32 v6, v3
    v_mfma_f32_16x16x32_bf16 v[112:115], v[24:27], v[48:51], v[112:115]
    ds_read_b64 v[66:67], v8 offset:2624
    v_mfma_f32_16x16x32_bf16 v[112:115], v[32:35], v[20:23], v[112:115]
    ds_read_b64 v[36:37], v8 offset:2104
    v_mfma_f32_16x16x32_bf16 v[116:119], v[32:35], v[48:51], v[116:119]
    ds_read_b64 v[38:39], v8 offset:2112
    v_mfma_f32_16x16x32_bf16 v[116:119], v[40:43], v[20:23], v[116:119]
    ds_read_b128 v[56:59], v7 offset:1024
    v_mfma_f32_16x16x32_bf16 v[120:123], v[40:43], v[48:51], v[120:123]
    ds_read_b128 v[28:31], v7 offset:1536
    v_mfma_f32_16x16x32_bf16 v[120:123], v[68:71], v[20:23], v[120:123]
    ds_read_b128 v[60:63], v7 offset:2048
    v_mfma_f32_16x16x32_bf16 v[124:127], v[68:71], v[48:51], v[124:127]
    ds_read_b128 v[52:55], v7 offset:2560
    v_mfma_f32_16x16x32_bf16 v[124:127], v[44:47], v[20:23], v[124:127]
    ds_read_b64 v[96:97], v8 offset:2680
    s_waitcnt lgkmcnt(6)
    v_mfma_f32_16x16x32_bf16 v[72:75], v[128:131], v[64:67], v[72:75]
    ds_read_b64 v[98:99], v8 offset:2688
    s_waitcnt lgkmcnt(6)
    v_mfma_f32_16x16x32_bf16 v[76:79], v[128:131], v[36:39], v[76:79]
    ds_read_b64 v[100:101], v8 offset:2168
    v_mfma_f32_16x16x32_bf16 v[76:79], v[160:163], v[64:67], v[76:79]
    ds_read_b64 v[102:103], v8 offset:2176
    v_mfma_f32_16x16x32_bf16 v[80:83], v[160:163], v[36:39], v[80:83]
    ds_read_b128 v[24:27], v7 offset:1088
    s_waitcnt lgkmcnt(6)
    v_mfma_f32_16x16x32_bf16 v[80:83], v[56:59], v[64:67], v[80:83]
    ds_read_b128 v[32:35], v7 offset:1600
    v_mfma_f32_16x16x32_bf16 v[84:87], v[56:59], v[36:39], v[84:87]
    ds_read_b128 v[40:43], v7 offset:2112
    v_mfma_f32_16x16x32_bf16 v[84:87], v[28:31], v[64:67], v[84:87]
    ds_read_b128 v[48:51], v7 offset:2624
    v_mfma_f32_16x16x32_bf16 v[88:91], v[28:31], v[36:39], v[88:91]
    ds_read_b64 v[68:69], v8 offset:2744
    v_mfma_f32_16x16x32_bf16 v[88:91], v[60:63], v[64:67], v[88:91]
    ds_read_b64 v[70:71], v8 offset:2752
    v_mfma_f32_16x16x32_bf16 v[92:95], v[60:63], v[36:39], v[92:95]
    ds_read_b64 v[20:21], v8 offset:2232
    s_waitcnt lgkmcnt(6)
    v_mfma_f32_16x16x32_bf16 v[92:95], v[52:55], v[64:67], v[92:95]
    ds_read_b64 v[22:23], v8 offset:2240
    v_mfma_f32_16x16x32_bf16 v[72:75], v[132:135], v[96:99], v[72:75]
    ds_read_b128 v[44:47], v7 offset:1152
    v_mfma_f32_16x16x32_bf16 v[76:79], v[132:135], v[100:103], v[76:79]
    ds_read_b128 v[56:59], v7 offset:1664
    v_mfma_f32_16x16x32_bf16 v[76:79], v[164:167], v[96:99], v[76:79]
    ds_read_b128 v[28:31], v7 offset:2176
    v_mfma_f32_16x16x32_bf16 v[80:83], v[164:167], v[100:103], v[80:83]
    ds_read_b128 v[36:39], v7 offset:2688
    v_mfma_f32_16x16x32_bf16 v[80:83], v[24:27], v[96:99], v[80:83]
    ds_read_b64 v[60:61], v8 offset:2808
    v_mfma_f32_16x16x32_bf16 v[84:87], v[24:27], v[100:103], v[84:87]
    ds_read_b64 v[62:63], v8 offset:2816
    s_waitcnt lgkmcnt(6)
    v_mfma_f32_16x16x32_bf16 v[84:87], v[32:35], v[96:99], v[84:87]
    ds_read_b64 v[52:53], v8 offset:2296
    v_mfma_f32_16x16x32_bf16 v[88:91], v[32:35], v[100:103], v[88:91]
    ds_read_b64 v[54:55], v8 offset:2304
    v_mfma_f32_16x16x32_bf16 v[88:91], v[40:43], v[96:99], v[88:91]
    ds_read_b128 v[64:67], v7 offset:1216
    v_mfma_f32_16x16x32_bf16 v[92:95], v[40:43], v[100:103], v[92:95]
    ds_read_b128 v[24:27], v7 offset:1728
    v_mfma_f32_16x16x32_bf16 v[92:95], v[48:51], v[96:99], v[92:95]
    ds_read_b128 v[32:35], v7 offset:2240
    v_mfma_f32_16x16x32_bf16 v[72:75], v[136:139], v[68:71], v[72:75]
    ds_read_b128 v[40:43], v7 offset:2752
    v_mfma_f32_16x16x32_bf16 v[76:79], v[136:139], v[20:23], v[76:79]
    ds_read_b64 v[100:101], v8 offset:2872
    v_mfma_f32_16x16x32_bf16 v[76:79], v[168:171], v[68:71], v[76:79]
    ds_read_b64 v[102:103], v8 offset:2880
    v_mfma_f32_16x16x32_bf16 v[80:83], v[168:171], v[20:23], v[80:83]
    ds_read_b64 v[48:49], v8 offset:2360
    s_waitcnt lgkmcnt(6)
    v_mfma_f32_16x16x32_bf16 v[80:83], v[44:47], v[68:71], v[80:83]
    ds_read_b64 v[50:51], v8 offset:2368
    v_mfma_f32_16x16x32_bf16 v[84:87], v[44:47], v[20:23], v[84:87]
    ds_read_b128 v[96:99], v7 offset:1280
    v_mfma_f32_16x16x32_bf16 v[84:87], v[56:59], v[68:71], v[84:87]
    ds_read_b128 v[44:47], v7 offset:1792
    v_mfma_f32_16x16x32_bf16 v[88:91], v[56:59], v[20:23], v[88:91]
    ds_read_b128 v[56:59], v7 offset:2304
    v_mfma_f32_16x16x32_bf16 v[88:91], v[28:31], v[68:71], v[88:91]
    v_mfma_f32_16x16x32_bf16 v[92:95], v[28:31], v[20:23], v[92:95]
    ds_read_b128 v[20:23], v7 offset:2816
    v_mfma_f32_16x16x32_bf16 v[92:95], v[36:39], v[68:71], v[92:95]
    ds_read_b64 v[28:29], v8 offset:2936
    v_mfma_f32_16x16x32_bf16 v[72:75], v[140:143], v[60:63], v[72:75]
    ds_read_b64 v[30:31], v8 offset:2944
    v_mfma_f32_16x16x32_bf16 v[76:79], v[140:143], v[52:55], v[76:79]
    ds_read_b64 v[36:37], v8 offset:2424
    v_mfma_f32_16x16x32_bf16 v[76:79], v[172:175], v[60:63], v[76:79]
    ds_read_b64 v[38:39], v8 offset:2432
    v_mfma_f32_16x16x32_bf16 v[80:83], v[172:175], v[52:55], v[80:83]
    ds_read_b128 v[68:71], v7 offset:1344
    v_mfma_f32_16x16x32_bf16 v[80:83], v[64:67], v[60:63], v[80:83]
    v_mfma_f32_16x16x32_bf16 v[84:87], v[64:67], v[52:55], v[84:87]
    ds_read_b128 v[64:67], v7 offset:1856
    s_waitcnt lgkmcnt(5)
    v_mfma_f32_16x16x32_bf16 v[84:87], v[24:27], v[60:63], v[84:87]
    v_mfma_f32_16x16x32_bf16 v[88:91], v[24:27], v[52:55], v[88:91]
    ds_read_b128 v[24:27], v7 offset:2368
    v_mfma_f32_16x16x32_bf16 v[88:91], v[32:35], v[60:63], v[88:91]
    v_mfma_f32_16x16x32_bf16 v[92:95], v[32:35], v[52:55], v[92:95]
    ds_read_b128 v[32:35], v7 offset:2880
    v_mfma_f32_16x16x32_bf16 v[92:95], v[40:43], v[60:63], v[92:95]
    ds_read_b64 v[52:53], v8 offset:3000
    v_mfma_f32_16x16x32_bf16 v[72:75], v[144:147], v[100:103], v[72:75]
    ds_read_b64 v[54:55], v8 offset:3008
    v_mfma_f32_16x16x32_bf16 v[76:79], v[144:147], v[48:51], v[76:79]
    ds_read_b64 v[40:41], v8 offset:2488
    v_mfma_f32_16x16x32_bf16 v[76:79], v[176:179], v[100:103], v[76:79]
    ds_read_b64 v[42:43], v8 offset:2496
    v_mfma_f32_16x16x32_bf16 v[80:83], v[176:179], v[48:51], v[80:83]
    ds_read_b128 v[60:63], v7 offset:1408
    v_mfma_f32_16x16x32_bf16 v[80:83], v[96:99], v[100:103], v[80:83]
    v_mfma_f32_16x16x32_bf16 v[84:87], v[96:99], v[48:51], v[84:87]
    ds_read_b128 v[96:99], v7 offset:1920
    v_mfma_f32_16x16x32_bf16 v[84:87], v[44:47], v[100:103], v[84:87]
    v_mfma_f32_16x16x32_bf16 v[88:91], v[44:47], v[48:51], v[88:91]
    ds_read_b128 v[44:47], v7 offset:2432
    v_mfma_f32_16x16x32_bf16 v[88:91], v[56:59], v[100:103], v[88:91]
    v_mfma_f32_16x16x32_bf16 v[92:95], v[56:59], v[48:51], v[92:95]
    ds_read_b128 v[48:51], v7 offset:2944
    v_mfma_f32_16x16x32_bf16 v[92:95], v[20:23], v[100:103], v[92:95]
    ds_read_b64 v[56:57], v8 offset:3064
    s_waitcnt lgkmcnt(4)
    v_mfma_f32_16x16x32_bf16 v[72:75], v[148:151], v[28:31], v[72:75]
    ds_read_b64 v[58:59], v8 offset:3072
    v_mfma_f32_16x16x32_bf16 v[76:79], v[148:151], v[36:39], v[76:79]
    ds_read_b64 v[20:21], v8 offset:2552
    v_mfma_f32_16x16x32_bf16 v[76:79], v[180:183], v[28:31], v[76:79]
    ds_read_b64 v[22:23], v8 offset:2560
    v_mfma_f32_16x16x32_bf16 v[80:83], v[180:183], v[36:39], v[80:83]
    ds_read_b128 v[100:103], v7 offset:1472
    v_mfma_f32_16x16x32_bf16 v[80:83], v[68:71], v[28:31], v[80:83]
    v_mfma_f32_16x16x32_bf16 v[84:87], v[68:71], v[36:39], v[84:87]
    ds_read_b128 v[68:71], v7 offset:1984
    v_mfma_f32_16x16x32_bf16 v[84:87], v[64:67], v[28:31], v[84:87]
    v_mfma_f32_16x16x32_bf16 v[88:91], v[64:67], v[36:39], v[88:91]
    ds_read_b128 v[64:67], v7 offset:2496
    v_mfma_f32_16x16x32_bf16 v[88:91], v[24:27], v[28:31], v[88:91]
    v_mfma_f32_16x16x32_bf16 v[92:95], v[24:27], v[36:39], v[92:95]
    ds_read_b128 v[24:27], v7 offset:3008
    v_mfma_f32_16x16x32_bf16 v[92:95], v[32:35], v[28:31], v[92:95]
    ds_read_b64 v[36:37], v8 offset:36216
    v_mfma_f32_16x16x32_bf16 v[72:75], v[152:155], v[52:55], v[72:75]
    ds_read_b64 v[38:39], v8 offset:36224
    v_mfma_f32_16x16x32_bf16 v[76:79], v[152:155], v[40:43], v[76:79]
    ds_read_b64 v[28:29], v8 offset:35704
    v_mfma_f32_16x16x32_bf16 v[76:79], v[184:187], v[52:55], v[76:79]
    ds_read_b64 v[30:31], v8 offset:35712
    v_mfma_f32_16x16x32_bf16 v[80:83], v[184:187], v[40:43], v[80:83]
    ds_read_b64 v[32:33], v8 offset:36280
    v_mfma_f32_16x16x32_bf16 v[80:83], v[60:63], v[52:55], v[80:83]
    ds_read_b64 v[34:35], v8 offset:36288
    v_mfma_f32_16x16x32_bf16 v[84:87], v[60:63], v[40:43], v[84:87]
    ds_read_b64 v[60:61], v8 offset:35768
    s_waitcnt lgkmcnt(6)
    v_mfma_f32_16x16x32_bf16 v[84:87], v[96:99], v[52:55], v[84:87]
    ds_read_b64 v[62:63], v8 offset:35776
    v_mfma_f32_16x16x32_bf16 v[88:91], v[96:99], v[40:43], v[88:91]
    ds_read_b64 v[96:97], v8 offset:36344
    v_mfma_f32_16x16x32_bf16 v[88:91], v[44:47], v[52:55], v[88:91]
    ds_read_b64 v[98:99], v8 offset:36352
    v_mfma_f32_16x16x32_bf16 v[92:95], v[44:47], v[40:43], v[92:95]
    ds_read_b64 v[40:41], v8 offset:35832
    v_mfma_f32_16x16x32_bf16 v[92:95], v[48:51], v[52:55], v[92:95]
    ds_read_b64 v[42:43], v8 offset:35840
    v_mfma_f32_16x16x32_bf16 v[72:75], v[156:159], v[56:59], v[72:75]
    ds_read_b64 v[44:45], v8 offset:36408
    v_mfma_f32_16x16x32_bf16 v[76:79], v[156:159], v[20:23], v[76:79]
    ds_read_b64 v[46:47], v8 offset:36416
    v_mfma_f32_16x16x32_bf16 v[76:79], v[188:191], v[56:59], v[76:79]
    ds_read_b64 v[48:49], v8 offset:35896
    v_mfma_f32_16x16x32_bf16 v[80:83], v[188:191], v[20:23], v[80:83]
    ds_read_b64 v[50:51], v8 offset:35904
    v_mfma_f32_16x16x32_bf16 v[80:83], v[100:103], v[56:59], v[80:83]
    ds_read_b64 v[52:53], v8 offset:36472
    v_mfma_f32_16x16x32_bf16 v[84:87], v[100:103], v[20:23], v[84:87]
    ds_read_b64 v[54:55], v8 offset:36480
    v_mfma_f32_16x16x32_bf16 v[84:87], v[68:71], v[56:59], v[84:87]
    ds_read_b64 v[100:101], v8 offset:35960
    v_cvt_pk_bf16_f32 v16, v72, v73
    v_cvt_pk_bf16_f32 v17, v74, v75
    v_cvt_pk_bf16_f32 v18, v76, v77
    v_cvt_pk_bf16_f32 v19, v78, v79
    ds_write_addtid_b32 v16 offset:8704
    v_mfma_f32_16x16x32_bf16 v[88:91], v[68:71], v[20:23], v[88:91]
    ds_write_addtid_b32 v17 offset:8960
    ds_write_addtid_b32 v18 offset:9216
    ds_write_addtid_b32 v19 offset:9472
    v_mfma_f32_16x16x32_bf16 v[88:91], v[64:67], v[56:59], v[88:91]
    ds_read_b64 v[102:103], v8 offset:35968
    v_mfma_f32_16x16x32_bf16 v[92:95], v[64:67], v[20:23], v[92:95]
    ds_read_b64 v[68:69], v8 offset:36536
    v_mfma_f32_16x16x32_bf16 v[92:95], v[24:27], v[56:59], v[92:95]
    ds_read_b64 v[70:71], v8 offset:36544
    s_waitcnt lgkmcnt(9)
    v_mfma_f32_16x16x32_bf16 v[104:107], v[192:195], v[36:39], v[104:107]
    ds_read_b64 v[72:73], v8 offset:36024
    v_mfma_f32_16x16x32_bf16 v[108:111], v[192:195], v[28:31], v[108:111]
    ds_read_b64 v[74:75], v8 offset:36032
    v_mfma_f32_16x16x32_bf16 v[108:111], v[224:227], v[36:39], v[108:111]
    ds_read_b64 v[76:77], v8 offset:36600
    v_mfma_f32_16x16x32_bf16 v[104:107], v[196:199], v[32:35], v[104:107]
    ds_read_b64 v[78:79], v8 offset:36608
    v_mfma_f32_16x16x32_bf16 v[108:111], v[196:199], v[60:63], v[108:111]
    ds_read_b64 v[20:21], v8 offset:36088
    v_mfma_f32_16x16x32_bf16 v[108:111], v[228:231], v[32:35], v[108:111]
    ds_read_b64 v[22:23], v8 offset:36096
    v_mfma_f32_16x16x32_bf16 v[104:107], v[200:203], v[96:99], v[104:107]
    ds_read_b64 v[64:65], v8 offset:36664
    v_mfma_f32_16x16x32_bf16 v[108:111], v[200:203], v[40:43], v[108:111]
    ds_read_b64 v[66:67], v8 offset:36672
    v_mfma_f32_16x16x32_bf16 v[108:111], v[232:235], v[96:99], v[108:111]
    ds_read_b64 v[24:25], v8 offset:36152
    v_mfma_f32_16x16x32_bf16 v[104:107], v[204:207], v[44:47], v[104:107]
    ds_read_b64 v[26:27], v8 offset:36160
    v_mfma_f32_16x16x32_bf16 v[108:111], v[204:207], v[48:51], v[108:111]
    ds_read_b64 v[56:57], v8 offset:35704
    v_mfma_f32_16x16x32_bf16 v[108:111], v[236:239], v[44:47], v[108:111]
    ds_read_b64 v[58:59], v8 offset:35712
    s_waitcnt lgkmcnt(6)
    v_mfma_f32_16x16x32_bf16 v[104:107], v[208:211], v[52:55], v[104:107]
    ds_read_b64 v[28:29], v8 offset:36216
    v_mfma_f32_16x16x32_bf16 v[108:111], v[208:211], v[100:103], v[108:111]
    ds_read_b64 v[30:31], v8 offset:36224
    v_mfma_f32_16x16x32_bf16 v[108:111], v[240:243], v[52:55], v[108:111]
    ds_read_b128 v[36:39], v7 offset:37504
    v_mfma_f32_16x16x32_bf16 v[104:107], v[212:215], v[68:71], v[104:107]
    ds_read_b128 v[60:63], v7 offset:38016
    v_mfma_f32_16x16x32_bf16 v[108:111], v[212:215], v[72:75], v[108:111]
    ds_read_b128 v[32:35], v7 offset:38528
    v_mfma_f32_16x16x32_bf16 v[108:111], v[244:247], v[68:71], v[108:111]
    ds_read_b128 v[40:43], v7 offset:39040
    v_mfma_f32_16x16x32_bf16 v[104:107], v[216:219], v[76:79], v[104:107]
    ds_read_b64 v[96:97], v8 offset:35768
    v_mfma_f32_16x16x32_bf16 v[108:111], v[216:219], v[20:23], v[108:111]
    ds_read_b64 v[98:99], v8 offset:35776
    v_mfma_f32_16x16x32_bf16 v[108:111], v[248:251], v[76:79], v[108:111]
    ds_read_b64 v[48:49], v8 offset:36280
    s_waitcnt lgkmcnt(6)
    v_mfma_f32_16x16x32_bf16 v[104:107], v[220:223], v[64:67], v[104:107]
    ds_read_b64 v[50:51], v8 offset:36288
    v_mfma_f32_16x16x32_bf16 v[108:111], v[220:223], v[24:27], v[108:111]
    ds_read_b128 v[44:47], v7 offset:37568
    v_mfma_f32_16x16x32_bf16 v[108:111], v[252:255], v[64:67], v[108:111]
    ds_read_b128 v[100:103], v7 offset:38080
    v_mfma_f32_16x16x32_bf16 v[112:115], v[224:227], v[56:59], v[112:115]
    ds_read_b128 v[52:55], v7 offset:38592
    v_mfma_f32_16x16x32_bf16 v[112:115], v[36:39], v[28:31], v[112:115]
    ds_read_b128 v[72:75], v7 offset:39104
    v_mfma_f32_16x16x32_bf16 v[116:119], v[36:39], v[56:59], v[116:119]
    ds_read_b64 v[68:69], v8 offset:35832
    s_waitcnt lgkmcnt(6)
    v_mfma_f32_16x16x32_bf16 v[116:119], v[60:63], v[28:31], v[116:119]
    ds_read_b64 v[70:71], v8 offset:35840
    v_cvt_pk_bf16_f32 v16, v104, v105
    v_cvt_pk_bf16_f32 v17, v106, v107
    v_cvt_pk_bf16_f32 v18, v108, v109
    v_cvt_pk_bf16_f32 v19, v110, v111
    ds_write_addtid_b32 v16 offset:13056
    v_mfma_f32_16x16x32_bf16 v[120:123], v[60:63], v[56:59], v[120:123]
    ds_write_addtid_b32 v17 offset:13312
    ds_write_addtid_b32 v18 offset:13568
    ds_write_addtid_b32 v19 offset:13824
    v_mov_b32 v3, 4
    ds_write_b32 v6, v3
    v_mfma_f32_16x16x32_bf16 v[120:123], v[32:35], v[28:31], v[120:123]
    ds_read_b64 v[20:21], v8 offset:36344
    v_mfma_f32_16x16x32_bf16 v[124:127], v[32:35], v[56:59], v[124:127]
    ds_read_b64 v[22:23], v8 offset:36352
    v_mfma_f32_16x16x32_bf16 v[124:127], v[40:43], v[28:31], v[124:127]
    ds_read_b128 v[76:79], v7 offset:37632
    v_mfma_f32_16x16x32_bf16 v[112:115], v[228:231], v[96:99], v[112:115]
    ds_read_b128 v[24:27], v7 offset:38144
    s_waitcnt lgkmcnt(10)
    v_mfma_f32_16x16x32_bf16 v[112:115], v[44:47], v[48:51], v[112:115]
    ds_read_b128 v[64:67], v7 offset:38656
    v_mfma_f32_16x16x32_bf16 v[116:119], v[44:47], v[96:99], v[116:119]
    ds_read_b128 v[36:39], v7 offset:39168
    v_mfma_f32_16x16x32_bf16 v[116:119], v[100:103], v[48:51], v[116:119]
    ds_read_b64 v[60:61], v8 offset:35896
    v_mfma_f32_16x16x32_bf16 v[120:123], v[100:103], v[96:99], v[120:123]
    ds_read_b64 v[62:63], v8 offset:35904
    v_mfma_f32_16x16x32_bf16 v[120:123], v[52:55], v[48:51], v[120:123]
    ds_read_b64 v[104:105], v8 offset:36408
    v_mfma_f32_16x16x32_bf16 v[124:127], v[52:55], v[96:99], v[124:127]
    ds_read_b64 v[106:107], v8 offset:36416
    v_mfma_f32_16x16x32_bf16 v[124:127], v[72:75], v[48:51], v[124:127]
    ds_read_b128 v[108:111], v7 offset:37696
    s_waitcnt lgkmcnt(6)
    v_mfma_f32_16x16x32_bf16 v[112:115], v[232:235], v[68:71], v[112:115]
    ds_read_b128 v[32:35], v7 offset:38208
    v_mfma_f32_16x16x32_bf16 v[112:115], v[76:79], v[20:23], v[112:115]
    ds_read_b128 v[56:59], v7 offset:38720
    v_mfma_f32_16x16x32_bf16 v[116:119], v[76:79], v[68:71], v[116:119]
    ds_read_b128 v[28:31], v7 offset:39232
    v_mfma_f32_16x16x32_bf16 v[116:119], v[24:27], v[20:23], v[116:119]
    ds_read_b64 v[40:41], v8 offset:35960
    v_mfma_f32_16x16x32_bf16 v[120:123], v[24:27], v[68:71], v[120:123]
    ds_read_b64 v[42:43], v8 offset:35968
    v_mfma_f32_16x16x32_bf16 v[120:123], v[64:67], v[20:23], v[120:123]
    ds_read_b64 v[44:45], v8 offset:36472
    v_mfma_f32_16x16x32_bf16 v[124:127], v[64:67], v[68:71], v[124:127]
    ds_read_b64 v[46:47], v8 offset:36480
    s_waitcnt lgkmcnt(6)
    v_mfma_f32_16x16x32_bf16 v[124:127], v[36:39], v[20:23], v[124:127]
    ds_read_b128 v[100:103], v7 offset:37760
    v_mfma_f32_16x16x32_bf16 v[112:115], v[236:239], v[60:63], v[112:115]
    ds_read_b128 v[52:55], v7 offset:38272
    v_mfma_f32_16x16x32_bf16 v[112:115], v[108:111], v[104:107], v[112:115]
    ds_read_b128 v[96:99], v7 offset:38784
    v_mfma_f32_16x16x32_bf16 v[116:119], v[108:111], v[60:63], v[116:119]
    ds_read_b128 v[48:51], v7 offset:39296
    v_mfma_f32_16x16x32_bf16 v[116:119], v[32:35], v[104:107], v[116:119]
    ds_read_b64 v[72:73], v8 offset:36024
    v_mfma_f32_16x16x32_bf16 v[120:123], v[32:35], v[60:63], v[120:123]
    ds_read_b64 v[74:75], v8 offset:36032
    s_waitcnt lgkmcnt(6)
    v_mfma_f32_16x16x32_bf16 v[120:123], v[56:59], v[104:107], v[120:123]
    ds_read_b64 v[76:77], v8 offset:36536
    v_mfma_f32_16x16x32_bf16 v[124:127], v[56:59], v[60:63], v[124:127]
    ds_read_b64 v[78:79], v8 offset:36544
    v_mfma_f32_16x16x32_bf16 v[124:127], v[28:31], v[104:107], v[124:127]
    ds_read_b128 v[24:27], v7 offset:37824
    v_mfma_f32_16x16x32_bf16 v[112:115], v[240:243], v[40:43], v[112:115]
    ds_read_b128 v[64:67], v7 offset:38336
    s_waitcnt lgkmcnt(6)
    v_mfma_f32_16x16x32_bf16 v[112:115], v[100:103], v[44:47], v[112:115]
    ds_read_b128 v[68:71], v7 offset:38848
    v_mfma_f32_16x16x32_bf16 v[116:119], v[100:103], v[40:43], v[116:119]
    ds_read_b128 v[20:23], v7 offset:39360
    v_mfma_f32_16x16x32_bf16 v[116:119], v[52:55], v[44:47], v[116:119]
    ds_read_b64 v[36:37], v8 offset:36088
    v_mfma_f32_16x16x32_bf16 v[120:123], v[52:55], v[40:43], v[120:123]
    ds_read_b64 v[38:39], v8 offset:36096
    v_mfma_f32_16x16x32_bf16 v[120:123], v[96:99], v[44:47], v[120:123]
    ds_read_b64 v[108:109], v8 offset:36600
    v_mfma_f32_16x16x32_bf16 v[124:127], v[96:99], v[40:43], v[124:127]
    ds_read_b64 v[110:111], v8 offset:36608
    v_mfma_f32_16x16x32_bf16 v[124:127], v[48:51], v[44:47], v[124:127]
    ds_read_b128 v[32:35], v7 offset:37888
    s_waitcnt lgkmcnt(6)
    v_mfma_f32_16x16x32_bf16 v[112:115], v[244:247], v[72:75], v[112:115]
    ds_read_b128 v[56:59], v7 offset:38400
    v_mfma_f32_16x16x32_bf16 v[112:115], v[24:27], v[76:79], v[112:115]
    ds_read_b128 v[60:63], v7 offset:38912
    v_mfma_f32_16x16x32_bf16 v[116:119], v[24:27], v[72:75], v[116:119]
    ds_read_b128 v[28:31], v7 offset:39424
    v_mfma_f32_16x16x32_bf16 v[116:119], v[64:67], v[76:79], v[116:119]
    ds_read_b64 v[104:105], v8 offset:36152
    v_mfma_f32_16x16x32_bf16 v[120:123], v[64:67], v[72:75], v[120:123]
    ds_read_b64 v[106:107], v8 offset:36160
    v_mfma_f32_16x16x32_bf16 v[120:123], v[68:71], v[76:79], v[120:123]
    ds_read_b64 v[100:101], v8 offset:36664
    v_mfma_f32_16x16x32_bf16 v[124:127], v[68:71], v[72:75], v[124:127]
    ds_read_b64 v[102:103], v8 offset:36672
    s_waitcnt lgkmcnt(6)
    v_mfma_f32_16x16x32_bf16 v[124:127], v[20:23], v[76:79], v[124:127]
    ds_read_b128 v[52:55], v7 offset:37952
    ds_read_b128 v[12:15], v5
    v_mfma_f32_16x16x32_bf16 v[112:115], v[248:251], v[36:39], v[112:115]
    ds_read_b128 v[40:43], v7 offset:38464
    v_mfma_f32_16x16x32_bf16 v[112:115], v[32:35], v[108:111], v[112:115]
    ds_read_b128 v[96:99], v7 offset:38976
    v_mfma_f32_16x16x32_bf16 v[116:119], v[32:35], v[36:39], v[116:119]
    ds_read_b128 v[44:47], v7 offset:39488
    v_mfma_f32_16x16x32_bf16 v[116:119], v[56:59], v[108:111], v[116:119]
    v_mfma_f32_16x16x32_bf16 v[120:123], v[56:59], v[36:39], v[120:123]
    s_waitcnt lgkmcnt(5)
    v_mfma_f32_16x16x32_bf16 v[120:123], v[60:63], v[108:111], v[120:123]
    s_waitcnt lgkmcnt(3)
    v_min3_u32 v12, v12, v13, v14
    v_min_u32 v12, v12, v15
    s_nop 0
    v_readfirstlane_b32 s86, v12
    s_cmp_ge_u32 s86, 4
    s_cbranch_scc1 L_ok37
L_spin38:
    s_sleep 1
    ds_read_b128 v[12:15], v5
    s_waitcnt lgkmcnt(0)
    v_min3_u32 v12, v12, v13, v14
    v_min_u32 v12, v12, v15
    s_nop 0
    v_readfirstlane_b32 s86, v12
    s_cmp_ge_u32 s86, 4
    s_cbranch_scc0 L_spin38
L_ok37:
    v_mfma_f32_16x16x32_bf16 v[124:127], v[60:63], v[36:39], v[124:127]
    ds_read_b64 v[48:49], v8 offset:1592
    v_mfma_f32_16x16x32_bf16 v[124:127], v[28:31], v[108:111], v[124:127]
    ds_read_b64 v[50:51], v8 offset:1600
    v_mfma_f32_16x16x32_bf16 v[112:115], v[252:255], v[104:107], v[112:115]
    ds_read_b64 v[24:25], v8 offset:1080
    v_mfma_f32_16x16x32_bf16 v[112:115], v[52:55], v[100:103], v[112:115]
    ds_read_b64 v[26:27], v8 offset:1088
    v_mfma_f32_16x16x32_bf16 v[116:119], v[52:55], v[104:107], v[116:119]
    ds_read_b128 v[64:67], v7 offset:1024
    s_waitcnt lgkmcnt(5)
    v_mfma_f32_16x16x32_bf16 v[116:119], v[40:43], v[100:103], v[116:119]
    ds_read_b128 v[68:71], v7 offset:1536
    v_mfma_f32_16x16x32_bf16 v[120:123], v[40:43], v[104:107], v[120:123]
    ds_read_b64 v[72:73], v8 offset:1656
    v_mfma_f32_16x16x32_bf16 v[120:123], v[96:99], v[100:103], v[120:123]
    ds_read_b64 v[74:75], v8 offset:1664
    v_mfma_f32_16x16x32_bf16 v[124:127], v[96:99], v[104:107], v[124:127]
    ds_read_b64 v[20:21], v8 offset:1144
    v_mfma_f32_16x16x32_bf16 v[124:127], v[44:47], v[100:103], v[124:127]
    ds_read_b64 v[22:23], v8 offset:1152
    s_waitcnt lgkmcnt(6)
    v_mfma_f32_16x16x32_bf16 v[80:83], v[128:131], v[48:51], v[80:83]
    ds_read_b128 v[76:79], v7 offset:1088
    v_mfma_f32_16x16x32_bf16 v[84:87], v[128:131], v[24:27], v[84:87]
    ds_read_b128 v[32:35], v7 offset:1600
    v_mfma_f32_16x16x32_bf16 v[84:87], v[160:163], v[48:51], v[84:87]
    ds_read_b64 v[56:57], v8 offset:1720
    v_mfma_f32_16x16x32_bf16 v[88:91], v[160:163], v[24:27], v[88:91]
    ds_read_b64 v[58:59], v8 offset:1728
    s_waitcnt lgkmcnt(6)
    v_mfma_f32_16x16x32_bf16 v[88:91], v[64:67], v[48:51], v[88:91]
    ds_read_b64 v[36:37], v8 offset:1208
    v_mfma_f32_16x16x32_bf16 v[92:95], v[64:67], v[24:27], v[92:95]
    ds_read_b64 v[38:39], v8 offset:1216
    v_mfma_f32_16x16x32_bf16 v[92:95], v[68:71], v[48:51], v[92:95]
    ds_read_b128 v[60:63], v7 offset:1152
    v_mfma_f32_16x16x32_bf16 v[80:83], v[132:135], v[72:75], v[80:83]
    ds_read_b128 v[28:31], v7 offset:1664
    s_waitcnt lgkmcnt(6)
    v_mfma_f32_16x16x32_bf16 v[84:87], v[132:135], v[20:23], v[84:87]
    ds_read_b64 v[108:109], v8 offset:1784
    v_mfma_f32_16x16x32_bf16 v[84:87], v[164:167], v[72:75], v[84:87]
    ds_read_b64 v[110:111], v8 offset:1792
    v_mfma_f32_16x16x32_bf16 v[88:91], v[164:167], v[20:23], v[88:91]
    ds_read_b64 v[52:53], v8 offset:1272
    v_mfma_f32_16x16x32_bf16 v[88:91], v[76:79], v[72:75], v[88:91]
    ds_read_b64 v[54:55], v8 offset:1280
    v_mfma_f32_16x16x32_bf16 v[92:95], v[76:79], v[20:23], v[92:95]
    ds_read_b128 v[40:43], v7 offset:1216
    v_mfma_f32_16x16x32_bf16 v[92:95], v[32:35], v[72:75], v[92:95]
    ds_read_b128 v[96:99], v7 offset:1728
    s_waitcnt lgkmcnt(6)
    v_mfma_f32_16x16x32_bf16 v[80:83], v[136:139], v[56:59], v[80:83]
    ds_read_b64 v[104:105], v8 offset:1848
    v_mfma_f32_16x16x32_bf16 v[84:87], v[136:139], v[36:39], v[84:87]
    ds_read_b64 v[106:107], v8 offset:1856
    v_mfma_f32_16x16x32_bf16 v[84:87], v[168:171], v[56:59], v[84:87]
    ds_read_b64 v[44:45], v8 offset:1336
    v_mfma_f32_16x16x32_bf16 v[88:91], v[168:171], v[36:39], v[88:91]
    ds_read_b64 v[46:47], v8 offset:1344
    v_mfma_f32_16x16x32_bf16 v[88:91], v[60:63], v[56:59], v[88:91]
    ds_read_b128 v[100:103], v7 offset:1280
    v_mfma_f32_16x16x32_bf16 v[92:95], v[60:63], v[36:39], v[92:95]
    ds_read_b128 v[24:27], v7 offset:1792
    v_mfma_f32_16x16x32_bf16 v[92:95], v[28:31], v[56:59], v[92:95]
    ds_read_b64 v[64:65], v8 offset:1912
    s_waitcnt lgkmcnt(6)
    v_mfma_f32_16x16x32_bf16 v[80:83], v[140:143], v[108:111], v[80:83]
    ds_read_b64 v[66:67], v8 offset:1920
    v_mfma_f32_16x16x32_bf16 v[84:87], v[140:143], v[52:55], v[84:87]
    ds_read_b64 v[48:49], v8 offset:1400
    v_mfma_f32_16x16x32_bf16 v[84:87], v[172:175], v[108:111], v[84:87]
    ds_read_b64 v[50:51], v8 offset:1408
    v_mfma_f32_16x16x32_bf16 v[88:91], v[172:175], v[52:55], v[88:91]
    ds_read_b128 v[68:71], v7 offset:1344
    v_mfma_f32_16x16x32_bf16 v[88:91], v[40:43], v[108:111], v[88:91]
    ds_read_b128 v[20:23], v7 offset:1856
    v_mfma_f32_16x16x32_bf16 v[92:95], v[40:43], v[52:55], v[92:95]
    ds_read_b64 v[76:77], v8 offset:1976
    v_mfma_f32_16x16x32_bf16 v[92:95], v[96:99], v[108:111], v[92:95]
    ds_read_b64 v[78:79], v8 offset:1984
    s_waitcnt lgkmcnt(6)
    v_mfma_f32_16x16x32_bf16 v[80:83], v[144:147], v[104:107], v[80:83]
    ds_read_b64 v[32:33], v8 offset:1464
    v_mfma_f32_16x16x32_bf16 v[84:87], v[144:147], v[44:47], v[84:87]
    ds_read_b64 v[34:35], v8 offset:1472
    v_mfma_f32_16x16x32_bf16 v[84:87], v[176:179], v[104:107], v[84:87]
    ds_read_b128 v[72:75], v7 offset:1408
    v_mfma_f32_16x16x32_bf16 v[88:91], v[176:179], v[44:47], v[88:91]
    ds_read_b128 v[36:39], v7 offset:1920
    v_mfma_f32_16x16x32_bf16 v[88:91], v[100:103], v[104:107], v[88:91]
    ds_read_b64 v[60:61], v8 offset:2040
    v_mfma_f32_16x16x32_bf16 v[92:95], v[100:103], v[44:47], v[92:95]
    ds_read_b64 v[62:63], v8 offset:2048
    v_mfma_f32_16x16x32_bf16 v[92:95], v[24:27], v[104:107], v[92:95]
    ds_read_b64 v[28:29], v8 offset:1528
    v_mfma_f32_16x16x32_bf16 v[80:83], v[148:151], v[64:67], v[80:83]
    ds_read_b64 v[30:31], v8 offset:1536
    s_waitcnt lgkmcnt(6)
    v_mfma_f32_16x16x32_bf16 v[84:87], v[148:151], v[48:51], v[84:87]
    ds_read_b128 v[56:59], v7 offset:1472
    v_mfma_f32_16x16x32_bf16 v[84:87], v[180:183], v[64:67], v[84:87]
    ds_read_b128 v[40:43], v7 offset:1984
    v_mfma_f32_16x16x32_bf16 v[88:91], v[180:183], v[48:51], v[88:91]
    ds_read_b64 v[52:53], v8 offset:35192
    v_mfma_f32_16x16x32_bf16 v[88:91], v[68:71], v[64:67], v[88:91]
    ds_read_b64 v[54:55], v8 offset:35200
    v_mfma_f32_16x16x32_bf16 v[92:95], v[68:71], v[48:51], v[92:95]
    ds_read_b64 v[96:97], v8 offset:34680
    v_mfma_f32_16x16x32_bf16 v[92:95], v[20:23], v[64:67], v[92:95]
    ds_read_b64 v[98:99], v8 offset:34688
    v_mfma_f32_16x16x32_bf16 v[80:83], v[152:155], v[76:79], v[80:83]
    ds_read_b64 v[108:109], v8 offset:35256
    v_mfma_f32_16x16x32_bf16 v[84:87], v[152:155], v[32:35], v[84:87]
    ds_read_b64 v[110:111], v8 offset:35264
    v_mfma_f32_16x16x32_bf16 v[84:87], v[184:187], v[76:79], v[84:87]
    ds_read_b64 v[44:45], v8 offset:34744
    v_mfma_f32_16x16x32_bf16 v[88:91], v[184:187], v[32:35], v[88:91]
    ds_read_b64 v[46:47], v8 offset:34752
    s_waitcnt lgkmcnt(6)
    v_mfma_f32_16x16x32_bf16 v[88:91], v[72:75], v[76:79], v[88:91]
    ds_read_b64 v[100:101], v8 offset:35320
    v_mfma_f32_16x16x32_bf16 v[92:95], v[72:75], v[32:35], v[92:95]
    ds_read_b64 v[102:103], v8 offset:35328
    v_mfma_f32_16x16x32_bf16 v[92:95], v[36:39], v[76:79], v[92:95]
    ds_read_b64 v[24:25], v8 offset:34808
    v_mfma_f32_16x16x32_bf16 v[80:83], v[156:159], v[60:63], v[80:83]
    ds_read_b64 v[26:27], v8 offset:34816
    v_mfma_f32_16x16x32_bf16 v[84:87], v[156:159], v[28:31], v[84:87]
    ds_read_b64 v[104:105], v8 offset:35384
    v_mfma_f32_16x16x32_bf16 v[84:87], v[188:191], v[60:63], v[84:87]
    ds_read_b64 v[106:107], v8 offset:35392
    v_mfma_f32_16x16x32_bf16 v[88:91], v[188:191], v[28:31], v[88:91]
    ds_read_b64 v[48:49], v8 offset:34872
    v_mfma_f32_16x16x32_bf16 v[88:91], v[56:59], v[60:63], v[88:91]
    ds_read_b64 v[50:51], v8 offset:34880
    v_mfma_f32_16x16x32_bf16 v[92:95], v[56:59], v[28:31], v[92:95]
    ds_read_b64 v[68:69], v8 offset:35448
    v_mfma_f32_16x16x32_bf16 v[92:95], v[40:43], v[60:63], v[92:95]
    ds_read_b64 v[70:71], v8 offset:35456
    v_cvt_pk_bf16_f32 v16, v80, v81
    v_cvt_pk_bf16_f32 v17, v82, v83
    v_cvt_pk_bf16_f32 v18, v84, v85
    v_cvt_pk_bf16_f32 v19, v86, v87
    s_mov_b32 m0, s73
    s_nop 0
    ds_write_addtid_b32 v16 offset:0
    v_mfma_f32_16x16x32_bf16 v[112:115], v[192:195], v[52:55], v[112:115]
    ds_write_addtid_b32 v17 offset:256
    ds_write_addtid_b32 v18 offset:512
    ds_write_addtid_b32 v19 offset:768
    s_waitcnt lgkmcnt(9)
    v_mfma_f32_16x16x32_bf16 v[116:119], v[192:195], v[96:99], v[116:119]
    ds_read_b64 v[20:21], v8 offset:34936
    v_mfma_f32_16x16x32_bf16 v[116:119], v[224:227], v[52:55], v[116:119]
    ds_read_b64 v[22:23], v8 offset:34944
    v_mfma_f32_16x16x32_bf16 v[112:115], v[196:199], v[108:111], v[112:115]
    ds_read_b64 v[64:65], v8 offset:35512
    v_mfma_f32_16x16x32_bf16 v[116:119], v[196:199], v[44:47], v[116:119]
    ds_read_b64 v[66:67], v8 offset:35520
    v_mfma_f32_16x16x32_bf16 v[116:119], v[228:231], v[108:111], v[116:119]
    ds_read_b64 v[32:33], v8 offset:35000
    v_mfma_f32_16x16x32_bf16 v[112:115], v[200:203], v[100:103], v[112:115]
    ds_read_b64 v[34:35], v8 offset:35008
    v_mfma_f32_16x16x32_bf16 v[116:119], v[200:203], v[24:27], v[116:119]
    ds_read_b64 v[72:73], v8 offset:35576
    ds_read_b128 v[12:15], v5
    v_mfma_f32_16x16x32_bf16 v[116:119], v[232:235], v[100:103], v[116:119]
    ds_read_b64 v[74:75], v8 offset:35584
    s_waitcnt lgkmcnt(7)
    v_mfma_f32_16x16x32_bf16 v[112:115], v[204:207], v[104:107], v[112:115]
    ds_read_b64 v[36:37], v8 offset:35064
    v_mfma_f32_16x16x32_bf16 v[116:119], v[204:207], v[48:51], v[116:119]
    ds_read_b64 v[38:39], v8 offset:35072
    v_mfma_f32_16x16x32_bf16 v[116:119], v[236:239], v[104:107], v[116:119]
    ds_read_b64 v[76:77], v8 offset:35640
    v_mfma_f32_16x16x32_bf16 v[112:115], v[208:211], v[68:71], v[112:115]
    ds_read_b64 v[78:79], v8 offset:35648
    v_mfma_f32_16x16x32_bf16 v[116:119], v[208:211], v[20:23], v[116:119]
    ds_read_b64 v[28:29], v8 offset:35128
    s_waitcnt lgkmcnt(6)
    v_min3_u32 v12, v12, v13, v14
    v_min_u32 v12, v12, v15
    s_nop 0
    v_readfirstlane_b32 s86, v12
    s_cmp_ge_u32 s86, 5
    s_cbranch_scc1 L_ok39
L_spin40:
    s_sleep 1
    ds_read_b128 v[12:15], v5
    s_waitcnt lgkmcnt(0)
    v_min3_u32 v12, v12, v13, v14
    v_min_u32 v12, v12, v15
    s_nop 0
    v_readfirstlane_b32 s86, v12
    s_cmp_ge_u32 s86, 5
    s_cbranch_scc0 L_spin40
L_ok39:
    v_mfma_f32_16x16x32_bf16 v[116:119], v[240:243], v[68:71], v[116:119]
    ds_read_b64 v[30:31], v8 offset:35136
    v_mfma_f32_16x16x32_bf16 v[112:115], v[212:215], v[64:67], v[112:115]
    ds_read_b64 v[56:57], v8 offset:568
    v_mfma_f32_16x16x32_bf16 v[116:119], v[212:215], v[32:35], v[116:119]
    ds_read_b64 v[58:59], v8 offset:576
    v_mfma_f32_16x16x32_bf16 v[116:119], v[244:247], v[64:67], v[116:119]
    ds_read_b64 v[40:41], v8 offset:56
    s_waitcnt lgkmcnt(6)
    v_mfma_f32_16x16x32_bf16 v[112:115], v[216:219], v[72:75], v[112:115]
    ds_read_b64 v[42:43], v8 offset:64
    v_mfma_f32_16x16x32_bf16 v[116:119], v[216:219], v[36:39], v[116:119]
    ds_read_b64 v[60:61], v8 offset:632
    v_mfma_f32_16x16x32_bf16 v[116:119], v[248:251], v[72:75], v[116:119]
    ds_read_b64 v[62:63], v8 offset:640
    s_waitcnt lgkmcnt(6)
    v_mfma_f32_16x16x32_bf16 v[112:115], v[220:223], v[76:79], v[112:115]
    ds_read_b64 v[80:81], v8 offset:120
    ds_read_b64 v[82:83], v8 offset:128
    v_mfma_f32_16x16x32_bf16 v[116:119], v[220:223], v[28:31], v[116:119]
    ds_read_b64 v[84:85], v8 offset:696
    v_mfma_f32_16x16x32_bf16 v[116:119], v[252:255], v[76:79], v[116:119]
    ds_read_b64 v[86:87], v8 offset:704
    s_waitcnt lgkmcnt(7)
    v_mfma_f32_16x16x32_bf16 v[88:91], v[128:131], v[56:59], v[88:91]
    s_waitcnt lgkmcnt(6)
    v_mfma_f32_16x16x32_bf16 v[92:95], v[128:131], v[40:43], v[92:95]
    ds_read_b64 v[40:41], v8 offset:184
    ds_read_b64 v[42:43], v8 offset:192
    v_mfma_f32_16x16x32_bf16 v[92:95], v[160:163], v[56:59], v[92:95]
    ds_read_b64 v[128:129], v8 offset:760
    ds_read_b64 v[130:131], v8 offset:768
    v_cvt_pk_bf16_f32 v16, v112, v113
    v_cvt_pk_bf16_f32 v17, v114, v115
    v_cvt_pk_bf16_f32 v18, v116, v117
    v_cvt_pk_bf16_f32 v19, v118, v119
    s_waitcnt lgkmcnt(8)
    v_mfma_f32_16x16x32_bf16 v[88:91], v[132:135], v[60:63], v[88:91]
    ds_read_b64 v[56:57], v8 offset:248
    ds_read_b64 v[58:59], v8 offset:256
    ds_write_addtid_b32 v16 offset:33600
    ds_write_addtid_b32 v17 offset:33856
    ds_write_addtid_b32 v18 offset:34112
    ds_write_addtid_b32 v19 offset:34368
    s_waitcnt lgkmcnt(12)
    v_mfma_f32_16x16x32_bf16 v[92:95], v[132:135], v[80:83], v[92:95]
    ds_read_b64 v[160:161], v8 offset:824
    v_mov_b32 v3, 6
    ds_write_b32 v6, v3
    v_mfma_f32_16x16x32_bf16 v[92:95], v[164:167], v[60:63], v[92:95]
    ds_read_b64 v[162:163], v8 offset:832
    s_waitcnt lgkmcnt(13)
    v_mfma_f32_16x16x32_bf16 v[88:91], v[136:139], v[84:87], v[88:91]
    ds_read_b64 v[112:113], v8 offset:312
    ds_read_b64 v[114:115], v8 offset:320
    s_waitcnt lgkmcnt(13)
    v_mfma_f32_16x16x32_bf16 v[92:95], v[136:139], v[40:43], v[92:95]
    ds_read_b64 v[116:117], v8 offset:888
    v_mfma_f32_16x16x32_bf16 v[92:95], v[168:171], v[84:87], v[92:95]
    ds_read_b64 v[118:119], v8 offset:896
    s_waitcnt lgkmcnt(13)
    v_mfma_f32_16x16x32_bf16 v[88:91], v[140:143], v[128:131], v[88:91]
    ds_read_b64 v[80:81], v8 offset:376
    ds_read_b64 v[82:83], v8 offset:384
    s_waitcnt lgkmcnt(9)
    v_mfma_f32_16x16x32_bf16 v[92:95], v[140:143], v[56:59], v[92:95]
    ds_read_b64 v[132:133], v8 offset:952
    v_mfma_f32_16x16x32_bf16 v[92:95], v[172:175], v[128:131], v[92:95]
    ds_read_b64 v[134:135], v8 offset:960
    s_waitcnt lgkmcnt(8)
    v_mfma_f32_16x16x32_bf16 v[88:91], v[144:147], v[160:163], v[88:91]
    ds_read_b64 v[60:61], v8 offset:440
    ds_read_b64 v[62:63], v8 offset:448
    s_waitcnt lgkmcnt(8)
    v_mfma_f32_16x16x32_bf16 v[92:95], v[144:147], v[112:115], v[92:95]
    ds_read_b64 v[164:165], v8 offset:1016
    v_mfma_f32_16x16x32_bf16 v[92:95], v[176:179], v[160:163], v[92:95]
    ds_read_b64 v[166:167], v8 offset:1024
    s_waitcnt lgkmcnt(8)
    v_mfma_f32_16x16x32_bf16 v[88:91], v[148:151], v[116:119], v[88:91]
    ds_read_b64 v[40:41], v8 offset:504
    ds_read_b64 v[42:43], v8 offset:512
    s_waitcnt lgkmcnt(8)
    v_mfma_f32_16x16x32_bf16 v[92:95], v[148:151], v[80:83], v[92:95]
    ds_read_b64 v[136:137], v8 offset:34168
    v_mfma_f32_16x16x32_bf16 v[92:95], v[180:183], v[116:119], v[92:95]
    ds_read_b64 v[138:139], v8 offset:34176
    s_waitcnt lgkmcnt(8)
    v_mfma_f32_16x16x32_bf16 v[88:91], v[152:155], v[132:135], v[88:91]
    ds_read_b128 v[84:87], v7 offset:37504
    s_waitcnt lgkmcnt(7)
    v_mfma_f32_16x16x32_bf16 v[92:95], v[152:155], v[60:63], v[92:95]
    ds_read_b64 v[168:169], v8 offset:34232
    v_mfma_f32_16x16x32_bf16 v[92:95], v[184:187], v[132:135], v[92:95]
    ds_read_b64 v[170:171], v8 offset:34240
    s_waitcnt lgkmcnt(7)
    v_mfma_f32_16x16x32_bf16 v[88:91], v[156:159], v[164:167], v[88:91]
    ds_read_b128 v[56:59], v7 offset:37568
    s_waitcnt lgkmcnt(6)
    v_mfma_f32_16x16x32_bf16 v[92:95], v[156:159], v[40:43], v[92:95]
    ds_read_b64 v[140:141], v8 offset:34296
    v_mfma_f32_16x16x32_bf16 v[92:95], v[188:191], v[164:167], v[92:95]
    ds_read_b64 v[142:143], v8 offset:34304
    s_waitcnt lgkmcnt(6)
    v_mfma_f32_16x16x32_bf16 v[120:123], v[192:195], v[136:139], v[120:123]
    ds_read_b128 v[128:131], v7 offset:37632
    v_mfma_f32_16x16x32_bf16 v[120:123], v[224:227], v[96:99], v[120:123]
    ds_read_b64 v[172:173], v8 offset:34360
    s_waitcnt lgkmcnt(6)
    v_mfma_f32_16x16x32_bf16 v[120:123], v[84:87], v[52:55], v[120:123]
    ds_read_b64 v[174:175], v8 offset:34368
    v_cvt_pk_bf16_f32 v16, v88, v89
    v_cvt_pk_bf16_f32 v17, v90, v91
    v_cvt_pk_bf16_f32 v18, v92, v93
    v_cvt_pk_bf16_f32 v19, v94, v95
    s_waitcnt lgkmcnt(6)
    v_mfma_f32_16x16x32_bf16 v[120:123], v[196:199], v[168:171], v[120:123]
    ds_write_addtid_b32 v16 offset:4224
    ds_write_addtid_b32 v17 offset:4480
    ds_write_addtid_b32 v18 offset:4736
    ds_write_addtid_b32 v19 offset:4992
    v_mfma_f32_16x16x32_bf16 v[120:123], v[228:231], v[44:47], v[120:123]
    ds_read_b128 v[112:115], v7 offset:37696
    s_waitcnt lgkmcnt(9)
    v_mfma_f32_16x16x32_bf16 v[120:123], v[56:59], v[108:111], v[120:123]
    ds_read_b64 v[144:145], v8 offset:34424
    ds_read_b64 v[146:147], v8 offset:34432
    s_waitcnt lgkmcnt(10)
    v_mfma_f32_16x16x32_bf16 v[120:123], v[200:203], v[140:143], v[120:123]
    ds_read_b128 v[160:163], v7 offset:37760
    v_mfma_f32_16x16x32_bf16 v[120:123], v[232:235], v[24:27], v[120:123]
    ds_read_b64 v[176:177], v8 offset:34488
    s_waitcnt lgkmcnt(10)
    v_mfma_f32_16x16x32_bf16 v[120:123], v[128:131], v[100:103], v[120:123]
    ds_read_b64 v[178:179], v8 offset:34496
    s_waitcnt lgkmcnt(10)
    v_mfma_f32_16x16x32_bf16 v[120:123], v[204:207], v[172:175], v[120:123]
    ds_read_b128 v[80:83], v7 offset:37824
    v_mfma_f32_16x16x32_bf16 v[120:123], v[236:239], v[48:51], v[120:123]
    ds_read_b64 v[148:149], v8 offset:34552
    s_waitcnt lgkmcnt(7)
    v_mfma_f32_16x16x32_bf16 v[120:123], v[112:115], v[104:107], v[120:123]
    ds_read_b64 v[150:151], v8 offset:34560
    s_waitcnt lgkmcnt(6)
    v_mfma_f32_16x16x32_bf16 v[120:123], v[208:211], v[144:147], v[120:123]
    ds_read_b128 v[116:119], v7 offset:37888
    v_mfma_f32_16x16x32_bf16 v[120:123], v[240:243], v[20:23], v[120:123]
    ds_read_b64 v[180:181], v8 offset:34616
    s_waitcnt lgkmcnt(6)
    v_mfma_f32_16x16x32_bf16 v[120:123], v[160:163], v[68:71], v[120:123]
    ds_read_b64 v[182:183], v8 offset:34624
    s_waitcnt lgkmcnt(6)
    v_mfma_f32_16x16x32_bf16 v[120:123], v[212:215], v[176:179], v[120:123]
    ds_read_b128 v[60:63], v7 offset:37952
    v_mfma_f32_16x16x32_bf16 v[120:123], v[244:247], v[32:35], v[120:123]
    ds_read_b64 v[152:153], v8 offset:33656
    s_waitcnt lgkmcnt(6)
    v_mfma_f32_16x16x32_bf16 v[120:123], v[80:83], v[64:67], v[120:123]
    ds_read_b64 v[154:155], v8 offset:33664
    s_waitcnt lgkmcnt(6)
    v_mfma_f32_16x16x32_bf16 v[120:123], v[216:219], v[148:151], v[120:123]
    ds_read_b128 v[132:135], v7 offset:38016
    v_mfma_f32_16x16x32_bf16 v[120:123], v[248:251], v[36:39], v[120:123]
    ds_read_b64 v[184:185], v8 offset:33720
    s_waitcnt lgkmcnt(6)
    v_mfma_f32_16x16x32_bf16 v[120:123], v[116:119], v[72:75], v[120:123]
    ds_read_b64 v[186:187], v8 offset:33728
    s_waitcnt lgkmcnt(6)
    v_mfma_f32_16x16x32_bf16 v[120:123], v[220:223], v[180:183], v[120:123]
    ds_read_b128 v[40:43], v7 offset:38080
    v_mfma_f32_16x16x32_bf16 v[120:123], v[252:255], v[28:31], v[120:123]
    ds_read_b64 v[156:157], v8 offset:33784
    s_waitcnt lgkmcnt(6)
    v_mfma_f32_16x16x32_bf16 v[120:123], v[60:63], v[76:79], v[120:123]
    ds_read_b64 v[158:159], v8 offset:33792
    s_waitcnt lgkmcnt(6)
    v_mfma_f32_16x16x32_bf16 v[124:127], v[192:195], v[152:155], v[124:127]
    ds_read_b128 v[164:167], v7 offset:38144
    v_mfma_f32_16x16x32_bf16 v[124:127], v[224:227], v[136:139], v[124:127]
    ds_read_b64 v[188:189], v8 offset:33848
    v_mfma_f32_16x16x32_bf16 v[124:127], v[84:87], v[96:99], v[124:127]
    ds_read_b64 v[190:191], v8 offset:33856
    s_waitcnt lgkmcnt(6)
    v_mfma_f32_16x16x32_bf16 v[124:127], v[132:135], v[52:55], v[124:127]
    ds_read_b128 v[88:91], v7 offset:38208
    v_cvt_pk_bf16_f32 v16, v120, v121
    v_cvt_pk_bf16_f32 v17, v122, v123
    ds_write_addtid_b32 v16 offset:37824
    ds_write_addtid_b32 v17 offset:38080
    v_mov_b32 v3, 7
    v_mfma_f32_16x16x32_bf16 v[124:127], v[196:199], v[184:187], v[124:127]
    ds_write_b32 v6, v3
    v_mfma_f32_16x16x32_bf16 v[124:127], v[228:231], v[168:171], v[124:127]
    ds_read_b64 v[92:93], v8 offset:33912
    v_mfma_f32_16x16x32_bf16 v[124:127], v[56:59], v[44:47], v[124:127]
    ds_read_b64 v[94:95], v8 offset:33920
    s_waitcnt lgkmcnt(8)
    v_mfma_f32_16x16x32_bf16 v[124:127], v[40:43], v[108:111], v[124:127]
    ds_read_b128 v[152:155], v7 offset:38272
    v_mfma_f32_16x16x32_bf16 v[124:127], v[200:203], v[156:159], v[124:127]
    ds_read_b64 v[192:193], v8 offset:33976
    v_mfma_f32_16x16x32_bf16 v[124:127], v[232:235], v[140:143], v[124:127]
    ds_read_b64 v[194:195], v8 offset:33984
    v_mfma_f32_16x16x32_bf16 v[124:127], v[128:131], v[24:27], v[124:127]
    ds_read_b128 v[136:139], v7 offset:38336
    v_mfma_f32_16x16x32_bf16 v[124:127], v[164:167], v[100:103], v[124:127]
    ds_read_b64 v[224:225], v8 offset:34040
    s_waitcnt lgkmcnt(6)
    v_mfma_f32_16x16x32_bf16 v[124:127], v[204:207], v[188:191], v[124:127]
    ds_read_b64 v[226:227], v8 offset:34048
    v_mfma_f32_16x16x32_bf16 v[124:127], v[236:239], v[172:175], v[124:127]
    ds_read_b128 v[96:99], v7 offset:38400
    v_mfma_f32_16x16x32_bf16 v[124:127], v[112:115], v[48:51], v[124:127]
    ds_read_b64 v[84:85], v8 offset:34104
    v_mfma_f32_16x16x32_bf16 v[124:127], v[88:91], v[104:107], v[124:127]
    ds_read_b64 v[86:87], v8 offset:34112
    s_waitcnt lgkmcnt(6)
    v_mfma_f32_16x16x32_bf16 v[124:127], v[208:211], v[92:95], v[124:127]
    ds_read_b128 v[52:55], v7 offset:38464
    v_mfma_f32_16x16x32_bf16 v[124:127], v[240:243], v[144:147], v[124:127]
    v_mfma_f32_16x16x32_bf16 v[124:127], v[160:163], v[20:23], v[124:127]
    v_mfma_f32_16x16x32_bf16 v[124:127], v[152:155], v[68:71], v[124:127]
    v_mfma_f32_16x16x32_bf16 v[124:127], v[212:215], v[192:195], v[124:127]
    v_mfma_f32_16x16x32_bf16 v[124:127], v[244:247], v[176:179], v[124:127]
    v_mfma_f32_16x16x32_bf16 v[124:127], v[80:83], v[32:35], v[124:127]
    s_waitcnt lgkmcnt(0)
    v_mfma_f32_16x16x32_bf16 v[124:127], v[136:139], v[64:67], v[124:127]
    v_mfma_f32_16x16x32_bf16 v[124:127], v[216:219], v[224:227], v[124:127]
    v_mfma_f32_16x16x32_bf16 v[124:127], v[248:251], v[148:151], v[124:127]
    v_mfma_f32_16x16x32_bf16 v[124:127], v[116:119], v[36:39], v[124:127]
    v_mfma_f32_16x16x32_bf16 v[124:127], v[96:99], v[72:75], v[124:127]
    v_mfma_f32_16x16x32_bf16 v[124:127], v[220:223], v[84:87], v[124:127]
    v_mfma_f32_16x16x32_bf16 v[124:127], v[252:255], v[180:183], v[124:127]
    v_mfma_f32_16x16x32_bf16 v[124:127], v[60:63], v[28:31], v[124:127]
    v_mfma_f32_16x16x32_bf16 v[124:127], v[52:55], v[76:79], v[124:127]
    s_nop 7
    v_cvt_pk_bf16_f32 v16, v124, v125
    v_cvt_pk_bf16_f32 v17, v126, v127
    ds_write_addtid_b32 v16 offset:38336
    ds_write_addtid_b32 v17 offset:38592
    v_mov_b32 v3, 8
    ds_write_b32 v6, v3
    s_endpgm
L_hot_end:
L_direct1:
    v_lshrrev_b32 v140, 4, v0
    v_and_b32 v141, 15, v0
    v_lshlrev_b32 v141, 3, v141
    v_lshlrev_b32 v140, 4, v140
    s_mov_b32 s16, 0x40000
    s_mov_b32 s17, 0x840080
    v_lshrrev_b64 v[132:133], v140, s[16:17]
    v_and_b32 v132, 0xffff, v132
    v_add_u32 v132, v132, v141
    v_cvt_f32_u32 v120, v132
    s_mov_b32 s16, 0x50001
    s_mov_b32 s17, 0x850081
    v_lshrrev_b64 v[132:133], v140, s[16:17]
    v_and_b32 v132, 0xffff, v132
    v_add_u32 v132, v132, v141
    v_cvt_f32_u32 v121, v132
    s_mov_b32 s16, 0x60002
    s_mov_b32 s17, 0x860082
    v_lshrrev_b64 v[132:133], v140, s[16:17]
    v_and_b32 v132, 0xffff, v132
    v_add_u32 v132, v132, v141
    v_cvt_f32_u32 v122, v132
    s_mov_b32 s16, 0x70003
    s_mov_b32 s17, 0x870083
    v_lshrrev_b64 v[132:133], v140, s[16:17]
    v_and_b32 v132, 0xffff, v132
    v_add_u32 v132, v132, v141
    v_cvt_f32_u32 v123, v132
    s_mov_b32 s16, 0x1800100
    s_mov_b32 s17, 0x3000200
    v_lshrrev_b64 v[132:133], v140, s[16:17]
    v_and_b32 v132, 0xffff, v132
    v_add_u32 v132, v132, v141
    v_cvt_f32_u32 v124, v132
    s_mov_b32 s16, 0x1820102
    s_mov_b32 s17, 0x3040204
    v_lshrrev_b64 v[132:133], v140, s[16:17]
    v_and_b32 v132, 0xffff, v132
    v_add_u32 v132, v132, v141
    v_cvt_f32_u32 v125, v132
    s_mov_b32 s16, 0x1840104
    s_mov_b32 s17, 0x3800280
    v_lshrrev_b64 v[132:133], v140, s[16:17]
    v_and_b32 v132, 0xffff, v132
    v_add_u32 v132, v132, v141
    v_cvt_f32_u32 v126, v132
    s_mov_b32 s16, 0x1860106
    s_mov_b32 s17, 0x3840284
    v_lshrrev_b64 v[132:133], v140, s[16:17]
    v_and_b32 v132, 0xffff, v132
    v_add_u32 v132, v132, v141
    v_cvt_f32_u32 v127, v132
    s_mov_b32 s16, 0x5000400
    s_mov_b32 s17, 0x7000600
    v_lshrrev_b64 v[132:133], v140, s[16:17]
    v_and_b32 v132, 0xffff, v132
    v_add_u32 v132, v132, v141
    v_cvt_f32_u32 v128, v132
    s_mov_b32 s16, 0x5800480
    s_mov_b32 s17, 0x7800680
    v_lshrrev_b64 v[132:133], v140, s[16:17]
    v_and_b32 v132, 0xffff, v132
    v_add_u32 v132, v132, v141
    v_cvt_f32_u32 v129, v132
    s_mov_b32 s16, 0x6000500
    s_mov_b32 s17, 0x8000700
    v_lshrrev_b64 v[132:133], v140, s[16:17]
    v_and_b32 v132, 0xffff, v132
    v_add_u32 v132, v132, v141
    v_cvt_f32_u32 v130, v132
    s_mov_b32 s16, 0x2000180
    s_mov_b32 s17, 0x4000300
    v_lshrrev_b64 v[132:133], v140, s[16:17]
    v_and_b32 v132, 0xffff, v132
    v_add_u32 v132, v132, v141
    v_cvt_f32_u32 v131, v132
    v_mov_b32 v248, 0
    v_mov_b32 v249, 0
    v_mov_b32 v250, 0
    v_mov_b32 v251, 0
    v_mov_b32 v252, 0
    v_mov_b32 v253, 0
    v_mov_b32 v254, 0
    v_mov_b32 v255, 0
    v_mov_b32 v168, 0
    v_mov_b32 v169, 0
    v_mov_b32 v170, 0
    v_mov_b32 v171, 0
    s_mov_b32 s20, 0
L_dloop5:
    v_readlane_b32 s16, v68, s20
    v_readlane_b32 s17, v70, s20
    v_readlane_b32 s18, v88, s20
    v_readlane_b32 s19, v90, s20
    s_nop 1
    v_mul_f32 v133, s17, v120
    v_mul_f32 v132, s16, v120
    v_fract_f32 v133, v133
    v_exp_f32 v132, v132
    v_cos_f32 v134, v133
    v_sin_f32 v135, v133
    v_mul_f32 v134, s18, v134
    v_fma_f32 v134, -v135, s19, v134
    v_fmac_f32 v248, v132, v134
    v_mul_f32 v133, s17, v121
    v_mul_f32 v132, s16, v121
    v_fract_f32 v133, v133
    v_exp_f32 v132, v132
    v_cos_f32 v134, v133
    v_sin_f32 v135, v133
    v_mul_f32 v134, s18, v134
    v_fma_f32 v134, -v135, s19, v134
    v_fmac_f32 v249, v132, v134
    v_mul_f32 v133, s17, v122
    v_mul_f32 v132, s16, v122
    v_fract_f32 v133, v133
    v_exp_f32 v132, v132
    v_cos_f32 v134, v133
    v_sin_f32 v135, v133
    v_mul_f32 v134, s18, v134
    v_fma_f32 v134, -v135, s19, v134
    v_fmac_f32 v250, v132, v134
    v_mul_f32 v133, s17, v123
    v_mul_f32 v132, s16, v123
    v_fract_f32 v133, v133
    v_exp_f32 v132, v132
    v_cos_f32 v134, v133
    v_sin_f32 v135, v133
    v_mul_f32 v134, s18, v134
    v_fma_f32 v134, -v135, s19, v134
    v_fmac_f32 v251, v132, v134
    v_mul_f32 v133, s17, v124
    v_mul_f32 v132, s16, v124
    v_fract_f32 v133, v133
    v_exp_f32 v132, v132
    v_cos_f32 v134, v133
    v_sin_f32 v135, v133
    v_mul_f32 v134, s18, v134
    v_fma_f32 v134, -v135, s19, v134
    v_fmac_f32 v252, v132, v134
    v_mul_f32 v133, s17, v125
    v_mul_f32 v132, s16, v125
    v_fract_f32 v133, v133
    v_exp_f32 v132, v132
    v_cos_f32 v134, v133
    v_sin_f32 v135, v133
    v_mul_f32 v134, s18, v134
    v_fma_f32 v134, -v135, s19, v134
    v_fmac_f32 v253, v132, v134
    v_mul_f32 v133, s17, v126
    v_mul_f32 v132, s16, v126
    v_fract_f32 v133, v133
    v_exp_f32 v132, v132
    v_cos_f32 v134, v133
    v_sin_f32 v135, v133
    v_mul_f32 v134, s18, v134
    v_fma_f32 v134, -v135, s19, v134
    v_fmac_f32 v254, v132, v134
    v_mul_f32 v133, s17, v127
    v_mul_f32 v132, s16, v127
    v_fract_f32 v133, v133
    v_exp_f32 v132, v132
    v_cos_f32 v134, v133
    v_sin_f32 v135, v133
    v_mul_f32 v134, s18, v134
    v_fma_f32 v134, -v135, s19, v134
    v_fmac_f32 v255, v132, v134
    v_mul_f32 v133, s17, v128
    v_mul_f32 v132, s16, v128
    v_fract_f32 v133, v133
    v_exp_f32 v132, v132
    v_cos_f32 v134, v133
    v_sin_f32 v135, v133
    v_mul_f32 v134, s18, v134
    v_fma_f32 v134, -v135, s19, v134
    v_fmac_f32 v168, v132, v134
    v_mul_f32 v133, s17, v129
    v_mul_f32 v132, s16, v129
    v_fract_f32 v133, v133
    v_exp_f32 v132, v132
    v_cos_f32 v134, v133
    v_sin_f32 v135, v133
    v_mul_f32 v134, s18, v134
    v_fma_f32 v134, -v135, s19, v134
    v_fmac_f32 v169, v132, v134
    v_mul_f32 v133, s17, v130
    v_mul_f32 v132, s16, v130
    v_fract_f32 v133, v133
    v_exp_f32 v132, v132
    v_cos_f32 v134, v133
    v_sin_f32 v135, v133
    v_mul_f32 v134, s18, v134
    v_fma_f32 v134, -v135, s19, v134
    v_fmac_f32 v170, v132, v134
    v_mul_f32 v133, s17, v131
    v_mul_f32 v132, s16, v131
    v_fract_f32 v133, v133
    v_exp_f32 v132, v132
    v_cos_f32 v134, v133
    v_sin_f32 v135, v133
    v_mul_f32 v134, s18, v134
    v_fma_f32 v134, -v135, s19, v134
    v_fmac_f32 v171, v132, v134
    v_readlane_b32 s16, v69, s20
    v_readlane_b32 s17, v71, s20
    v_readlane_b32 s18, v89, s20
    v_readlane_b32 s19, v91, s20
    s_nop 1
    v_mul_f32 v133, s17, v120
    v_mul_f32 v132, s16, v120
    v_fract_f32 v133, v133
    v_exp_f32 v132, v132
    v_cos_f32 v134, v133
    v_sin_f32 v135, v133
    v_mul_f32 v134, s18, v134
    v_fma_f32 v134, -v135, s19, v134
    v_fmac_f32 v248, v132, v134
    v_mul_f32 v133, s17, v121
    v_mul_f32 v132, s16, v121
    v_fract_f32 v133, v133
    v_exp_f32 v132, v132
    v_cos_f32 v134, v133
    v_sin_f32 v135, v133
    v_mul_f32 v134, s18, v134
    v_fma_f32 v134, -v135, s19, v134
    v_fmac_f32 v249, v132, v134
    v_mul_f32 v133, s17, v122
    v_mul_f32 v132, s16, v122
    v_fract_f32 v133, v133
    v_exp_f32 v132, v132
    v_cos_f32 v134, v133
    v_sin_f32 v135, v133
    v_mul_f32 v134, s18, v134
    v_fma_f32 v134, -v135, s19, v134
    v_fmac_f32 v250, v132, v134
    v_mul_f32 v133, s17, v123
    v_mul_f32 v132, s16, v123
    v_fract_f32 v133, v133
    v_exp_f32 v132, v132
    v_cos_f32 v134, v133
    v_sin_f32 v135, v133
    v_mul_f32 v134, s18, v134
    v_fma_f32 v134, -v135, s19, v134
    v_fmac_f32 v251, v132, v134
    v_mul_f32 v133, s17, v124
    v_mul_f32 v132, s16, v124
    v_fract_f32 v133, v133
    v_exp_f32 v132, v132
    v_cos_f32 v134, v133
    v_sin_f32 v135, v133
    v_mul_f32 v134, s18, v134
    v_fma_f32 v134, -v135, s19, v134
    v_fmac_f32 v252, v132, v134
    v_mul_f32 v133, s17, v125
    v_mul_f32 v132, s16, v125
    v_fract_f32 v133, v133
    v_exp_f32 v132, v132
    v_cos_f32 v134, v133
    v_sin_f32 v135, v133
    v_mul_f32 v134, s18, v134
    v_fma_f32 v134, -v135, s19, v134
    v_fmac_f32 v253, v132, v134
    v_mul_f32 v133, s17, v126
    v_mul_f32 v132, s16, v126
    v_fract_f32 v133, v133
    v_exp_f32 v132, v132
    v_cos_f32 v134, v133
    v_sin_f32 v135, v133
    v_mul_f32 v134, s18, v134
    v_fma_f32 v134, -v135, s19, v134
    v_fmac_f32 v254, v132, v134
    v_mul_f32 v133, s17, v127
    v_mul_f32 v132, s16, v127
    v_fract_f32 v133, v133
    v_exp_f32 v132, v132
    v_cos_f32 v134, v133
    v_sin_f32 v135, v133
    v_mul_f32 v134, s18, v134
    v_fma_f32 v134, -v135, s19, v134
    v_fmac_f32 v255, v132, v134
    v_mul_f32 v133, s17, v128
    v_mul_f32 v132, s16, v128
    v_fract_f32 v133, v133
    v_exp_f32 v132, v132
    v_cos_f32 v134, v133
    v_sin_f32 v135, v133
    v_mul_f32 v134, s18, v134
    v_fma_f32 v134, -v135, s19, v134
    v_fmac_f32 v168, v132, v134
    v_mul_f32 v133, s17, v129
    v_mul_f32 v132, s16, v129
    v_fract_f32 v133, v133
    v_exp_f32 v132, v132
    v_cos_f32 v134, v133
    v_sin_f32 v135, v133
    v_mul_f32 v134, s18, v134
    v_fma_f32 v134, -v135, s19, v134
    v_fmac_f32 v169, v132, v134
    v_mul_f32 v133, s17, v130
    v_mul_f32 v132, s16, v130
    v_fract_f32 v133, v133
    v_exp_f32 v132, v132
    v_cos_f32 v134, v133
    v_sin_f32 v135, v133
    v_mul_f32 v134, s18, v134
    v_fma_f32 v134, -v135, s19, v134
    v_fmac_f32 v170, v132, v134
    v_mul_f32 v133, s17, v131
    v_mul_f32 v132, s16, v131
    v_fract_f32 v133, v133
    v_exp_f32 v132, v132
    v_cos_f32 v134, v133
    v_sin_f32 v135, v133
    v_mul_f32 v134, s18, v134
    v_fma_f32 v134, -v135, s19, v134
    v_fmac_f32 v171, v132, v134
    s_add_u32 s20, s20, 1
    s_cmp_lt_u32 s20, 64
    s_cbranch_scc1 L_dloop5
    s_cmp_eq_u32 0, 0
    s_branch L_back2
L_fix3:
    v_mov_b32 v100, v168
    v_mov_b32 v101, v169
    v_mov_b32 v102, v170
    v_mov_b32 v103, v171
    s_branch L_back4
L_direct16:
    v_lshrrev_b32 v140, 4, v0
    v_and_b32 v141, 15, v0
    v_lshlrev_b32 v141, 3, v141
    v_lshlrev_b32 v140, 4, v140
    s_mov_b32 s16, 0x40000
    s_mov_b32 s17, 0x840080
    v_lshrrev_b64 v[132:133], v140, s[16:17]
    v_and_b32 v132, 0xffff, v132
    v_add_u32 v132, v132, v141
    v_cvt_f32_u32 v120, v132
    s_mov_b32 s16, 0x50001
    s_mov_b32 s17, 0x850081
    v_lshrrev_b64 v[132:133], v140, s[16:17]
    v_and_b32 v132, 0xffff, v132
    v_add_u32 v132, v132, v141
    v_cvt_f32_u32 v121, v132
    s_mov_b32 s16, 0x60002
    s_mov_b32 s17, 0x860082
    v_lshrrev_b64 v[132:133], v140, s[16:17]
    v_and_b32 v132, 0xffff, v132
    v_add_u32 v132, v132, v141
    v_cvt_f32_u32 v122, v132
    s_mov_b32 s16, 0x70003
    s_mov_b32 s17, 0x870083
    v_lshrrev_b64 v[132:133], v140, s[16:17]
    v_and_b32 v132, 0xffff, v132
    v_add_u32 v132, v132, v141
    v_cvt_f32_u32 v123, v132
    s_mov_b32 s16, 0x1800100
    s_mov_b32 s17, 0x3000200
    v_lshrrev_b64 v[132:133], v140, s[16:17]
    v_and_b32 v132, 0xffff, v132
    v_add_u32 v132, v132, v141
    v_cvt_f32_u32 v124, v132
    s_mov_b32 s16, 0x1820102
    s_mov_b32 s17, 0x3040204
    v_lshrrev_b64 v[132:133], v140, s[16:17]
    v_and_b32 v132, 0xffff, v132
    v_add_u32 v132, v132, v141
    v_cvt_f32_u32 v125, v132
    s_mov_b32 s16, 0x1840104
    s_mov_b32 s17, 0x3800280
    v_lshrrev_b64 v[132:133], v140, s[16:17]
    v_and_b32 v132, 0xffff, v132
    v_add_u32 v132, v132, v141
    v_cvt_f32_u32 v126, v132
    s_mov_b32 s16, 0x1860106
    s_mov_b32 s17, 0x3840284
    v_lshrrev_b64 v[132:133], v140, s[16:17]
    v_and_b32 v132, 0xffff, v132
    v_add_u32 v132, v132, v141
    v_cvt_f32_u32 v127, v132
    s_mov_b32 s16, 0x5000400
    s_mov_b32 s17, 0x7000600
    v_lshrrev_b64 v[132:133], v140, s[16:17]
    v_and_b32 v132, 0xffff, v132
    v_add_u32 v132, v132, v141
    v_cvt_f32_u32 v128, v132
    s_mov_b32 s16, 0x5800480
    s_mov_b32 s17, 0x7800680
    v_lshrrev_b64 v[132:133], v140, s[16:17]
    v_and_b32 v132, 0xffff, v132
    v_add_u32 v132, v132, v141
    v_cvt_f32_u32 v129, v132
    s_mov_b32 s16, 0x6000500
    s_mov_b32 s17, 0x8000700
    v_lshrrev_b64 v[132:133], v140, s[16:17]
    v_and_b32 v132, 0xffff, v132
    v_add_u32 v132, v132, v141
    v_cvt_f32_u32 v130, v132
    s_mov_b32 s16, 0x2000180
    s_mov_b32 s17, 0x4000300
    v_lshrrev_b64 v[132:133], v140, s[16:17]
    v_and_b32 v132, 0xffff, v132
    v_add_u32 v132, v132, v141
    v_cvt_f32_u32 v131, v132
    v_mov_b32 v248, 0
    v_mov_b32 v249, 0
    v_mov_b32 v250, 0
    v_mov_b32 v251, 0
    v_mov_b32 v252, 0
    v_mov_b32 v253, 0
    v_mov_b32 v254, 0
    v_mov_b32 v255, 0
    v_mov_b32 v168, 0
    v_mov_b32 v169, 0
    v_mov_b32 v170, 0
    v_mov_b32 v171, 0
    s_mov_b32 s20, 0
L_dloop20:
    v_readlane_b32 s16, v68, s20
    v_readlane_b32 s17, v70, s20
    v_readlane_b32 s18, v88, s20
    v_readlane_b32 s19, v90, s20
    s_nop 1
    v_mul_f32 v133, s17, v120
    v_mul_f32 v132, s16, v120
    v_fract_f32 v133, v133
    v_exp_f32 v132, v132
    v_cos_f32 v134, v133
    v_sin_f32 v135, v133
    v_mul_f32 v134, s18, v134
    v_fma_f32 v134, -v135, s19, v134
    v_fmac_f32 v248, v132, v134
    v_mul_f32 v133, s17, v121
    v_mul_f32 v132, s16, v121
    v_fract_f32 v133, v133
    v_exp_f32 v132, v132
    v_cos_f32 v134, v133
    v_sin_f32 v135, v133
    v_mul_f32 v134, s18, v134
    v_fma_f32 v134, -v135, s19, v134
    v_fmac_f32 v249, v132, v134
    v_mul_f32 v133, s17, v122
    v_mul_f32 v132, s16, v122
    v_fract_f32 v133, v133
    v_exp_f32 v132, v132
    v_cos_f32 v134, v133
    v_sin_f32 v135, v133
    v_mul_f32 v134, s18, v134
    v_fma_f32 v134, -v135, s19, v134
    v_fmac_f32 v250, v132, v134
    v_mul_f32 v133, s17, v123
    v_mul_f32 v132, s16, v123
    v_fract_f32 v133, v133
    v_exp_f32 v132, v132
    v_cos_f32 v134, v133
    v_sin_f32 v135, v133
    v_mul_f32 v134, s18, v134
    v_fma_f32 v134, -v135, s19, v134
    v_fmac_f32 v251, v132, v134
    v_mul_f32 v133, s17, v124
    v_mul_f32 v132, s16, v124
    v_fract_f32 v133, v133
    v_exp_f32 v132, v132
    v_cos_f32 v134, v133
    v_sin_f32 v135, v133
    v_mul_f32 v134, s18, v134
    v_fma_f32 v134, -v135, s19, v134
    v_fmac_f32 v252, v132, v134
    v_mul_f32 v133, s17, v125
    v_mul_f32 v132, s16, v125
    v_fract_f32 v133, v133
    v_exp_f32 v132, v132
    v_cos_f32 v134, v133
    v_sin_f32 v135, v133
    v_mul_f32 v134, s18, v134
    v_fma_f32 v134, -v135, s19, v134
    v_fmac_f32 v253, v132, v134
    v_mul_f32 v133, s17, v126
    v_mul_f32 v132, s16, v126
    v_fract_f32 v133, v133
    v_exp_f32 v132, v132
    v_cos_f32 v134, v133
    v_sin_f32 v135, v133
    v_mul_f32 v134, s18, v134
    v_fma_f32 v134, -v135, s19, v134
    v_fmac_f32 v254, v132, v134
    v_mul_f32 v133, s17, v127
    v_mul_f32 v132, s16, v127
    v_fract_f32 v133, v133
    v_exp_f32 v132, v132
    v_cos_f32 v134, v133
    v_sin_f32 v135, v133
    v_mul_f32 v134, s18, v134
    v_fma_f32 v134, -v135, s19, v134
    v_fmac_f32 v255, v132, v134
    v_mul_f32 v133, s17, v128
    v_mul_f32 v132, s16, v128
    v_fract_f32 v133, v133
    v_exp_f32 v132, v132
    v_cos_f32 v134, v133
    v_sin_f32 v135, v133
    v_mul_f32 v134, s18, v134
    v_fma_f32 v134, -v135, s19, v134
    v_fmac_f32 v168, v132, v134
    v_mul_f32 v133, s17, v129
    v_mul_f32 v132, s16, v129
    v_fract_f32 v133, v133
    v_exp_f32 v132, v132
    v_cos_f32 v134, v133
    v_sin_f32 v135, v133
    v_mul_f32 v134, s18, v134
    v_fma_f32 v134, -v135, s19, v134
    v_fmac_f32 v169, v132, v134
    v_mul_f32 v133, s17, v130
    v_mul_f32 v132, s16, v130
    v_fract_f32 v133, v133
    v_exp_f32 v132, v132
    v_cos_f32 v134, v133
    v_sin_f32 v135, v133
    v_mul_f32 v134, s18, v134
    v_fma_f32 v134, -v135, s19, v134
    v_fmac_f32 v170, v132, v134
    v_mul_f32 v133, s17, v131
    v_mul_f32 v132, s16, v131
    v_fract_f32 v133, v133
    v_exp_f32 v132, v132
    v_cos_f32 v134, v133
    v_sin_f32 v135, v133
    v_mul_f32 v134, s18, v134
    v_fma_f32 v134, -v135, s19, v134
    v_fmac_f32 v171, v132, v134
    v_readlane_b32 s16, v69, s20
    v_readlane_b32 s17, v71, s20
    v_readlane_b32 s18, v89, s20
    v_readlane_b32 s19, v91, s20
    s_nop 1
    v_mul_f32 v133, s17, v120
    v_mul_f32 v132, s16, v120
    v_fract_f32 v133, v133
    v_exp_f32 v132, v132
    v_cos_f32 v134, v133
    v_sin_f32 v135, v133
    v_mul_f32 v134, s18, v134
    v_fma_f32 v134, -v135, s19, v134
    v_fmac_f32 v248, v132, v134
    v_mul_f32 v133, s17, v121
    v_mul_f32 v132, s16, v121
    v_fract_f32 v133, v133
    v_exp_f32 v132, v132
    v_cos_f32 v134, v133
    v_sin_f32 v135, v133
    v_mul_f32 v134, s18, v134
    v_fma_f32 v134, -v135, s19, v134
    v_fmac_f32 v249, v132, v134
    v_mul_f32 v133, s17, v122
    v_mul_f32 v132, s16, v122
    v_fract_f32 v133, v133
    v_exp_f32 v132, v132
    v_cos_f32 v134, v133
    v_sin_f32 v135, v133
    v_mul_f32 v134, s18, v134
    v_fma_f32 v134, -v135, s19, v134
    v_fmac_f32 v250, v132, v134
    v_mul_f32 v133, s17, v123
    v_mul_f32 v132, s16, v123
    v_fract_f32 v133, v133
    v_exp_f32 v132, v132
    v_cos_f32 v134, v133
    v_sin_f32 v135, v133
    v_mul_f32 v134, s18, v134
    v_fma_f32 v134, -v135, s19, v134
    v_fmac_f32 v251, v132, v134
    v_mul_f32 v133, s17, v124
    v_mul_f32 v132, s16, v124
    v_fract_f32 v133, v133
    v_exp_f32 v132, v132
    v_cos_f32 v134, v133
    v_sin_f32 v135, v133
    v_mul_f32 v134, s18, v134
    v_fma_f32 v134, -v135, s19, v134
    v_fmac_f32 v252, v132, v134
    v_mul_f32 v133, s17, v125
    v_mul_f32 v132, s16, v125
    v_fract_f32 v133, v133
    v_exp_f32 v132, v132
    v_cos_f32 v134, v133
    v_sin_f32 v135, v133
    v_mul_f32 v134, s18, v134
    v_fma_f32 v134, -v135, s19, v134
    v_fmac_f32 v253, v132, v134
    v_mul_f32 v133, s17, v126
    v_mul_f32 v132, s16, v126
    v_fract_f32 v133, v133
    v_exp_f32 v132, v132
    v_cos_f32 v134, v133
    v_sin_f32 v135, v133
    v_mul_f32 v134, s18, v134
    v_fma_f32 v134, -v135, s19, v134
    v_fmac_f32 v254, v132, v134
    v_mul_f32 v133, s17, v127
    v_mul_f32 v132, s16, v127
    v_fract_f32 v133, v133
    v_exp_f32 v132, v132
    v_cos_f32 v134, v133
    v_sin_f32 v135, v133
    v_mul_f32 v134, s18, v134
    v_fma_f32 v134, -v135, s19, v134
    v_fmac_f32 v255, v132, v134
    v_mul_f32 v133, s17, v128
    v_mul_f32 v132, s16, v128
    v_fract_f32 v133, v133
    v_exp_f32 v132, v132
    v_cos_f32 v134, v133
    v_sin_f32 v135, v133
    v_mul_f32 v134, s18, v134
    v_fma_f32 v134, -v135, s19, v134
    v_fmac_f32 v168, v132, v134
    v_mul_f32 v133, s17, v129
    v_mul_f32 v132, s16, v129
    v_fract_f32 v133, v133
    v_exp_f32 v132, v132
    v_cos_f32 v134, v133
    v_sin_f32 v135, v133
    v_mul_f32 v134, s18, v134
    v_fma_f32 v134, -v135, s19, v134
    v_fmac_f32 v169, v132, v134
    v_mul_f32 v133, s17, v130
    v_mul_f32 v132, s16, v130
    v_fract_f32 v133, v133
    v_exp_f32 v132, v132
    v_cos_f32 v134, v133
    v_sin_f32 v135, v133
    v_mul_f32 v134, s18, v134
    v_fma_f32 v134, -v135, s19, v134
    v_fmac_f32 v170, v132, v134
    v_mul_f32 v133, s17, v131
    v_mul_f32 v132, s16, v131
    v_fract_f32 v133, v133
    v_exp_f32 v132, v132
    v_cos_f32 v134, v133
    v_sin_f32 v135, v133
    v_mul_f32 v134, s18, v134
    v_fma_f32 v134, -v135, s19, v134
    v_fmac_f32 v171, v132, v134
    s_add_u32 s20, s20, 1
    s_cmp_lt_u32 s20, 64
    s_cbranch_scc1 L_dloop20
    s_cmp_eq_u32 0, 0
    s_branch L_back17
L_fix18:
    v_mov_b32 v100, v168
    v_mov_b32 v101, v169
    v_mov_b32 v102, v170
    v_mov_b32 v103, v171
    s_branch L_back19
L_exit:
    s_endpgm
.section .rodata,"a"
.p2align 6
.amdhsa_kernel concat_heads__ssm_conv_s4__ssm_conv_h3__prompt_kernel
  .amdhsa_next_free_vgpr 256
  .amdhsa_next_free_sgpr 102
  .amdhsa_accum_offset 256
  .amdhsa_group_segment_fixed_size 0
  .amdhsa_kernarg_size 144
  .amdhsa_user_sgpr_count 2
  .amdhsa_user_sgpr_kernarg_segment_ptr 1
  .amdhsa_system_sgpr_workgroup_id_x 1
.end_amdhsa_kernel
```
